```python
import torch

def _softmax(x, axis=-1):
    return torch.softmax(x, dim=axis)
def _gelu(x):
    return torch.nn.functional.gelu(x, approximate="tanh")
def _silu(x):
    return torch.nn.functional.silu(x)
def _sigmoid(x):
    return torch.sigmoid(x)
def _layernorm(x, axis=-1, eps=1e-5):
    m = x.mean(dim=axis, keepdim=True)
    v = x.var(dim=axis, keepdim=True, unbiased=False)
    return (x - m) / torch.sqrt(v + eps)
def _scatter_add(tgt, idx, src, axis=0):
    return tgt.clone().index_add_(axis, idx, src)
def _segment_sum(src, seg, n):
    out = torch.zeros((n,) + src.shape[1:], dtype=src.dtype)
    return out.index_add_(0, seg, src)
def _pad(x, pw):
    flat = tuple(v for pair in reversed(pw) for v in pair)
    return torch.nn.functional.pad(x, flat)

kernel_name = 'standalone__modern_conv_block_replknet__vision'

def setup_inputs():

    _w = (lambda a: (lambda t: t.to(torch.bfloat16) if t.is_floating_point() else t)(torch.as_tensor(a)))
    H = W = 512
    C = 96
    K = 3
    return {
        "x": _w((lambda *s: torch.randn(*s, dtype=torch.bfloat16) * 0.05)(1, H, W, C)),
        "dw_large": _w((lambda *s: torch.randn(*s, dtype=torch.bfloat16) * 0.4)(K, K, C) * (1.0 / K)),
        "dw_small": _w((lambda *s: torch.randn(*s, dtype=torch.bfloat16) * 0.4)(5, 5, C) * 0.2),
        "w1": _w((lambda *s: torch.randn(*s, dtype=torch.bfloat16) * 0.4)(C, 4 * C) * (C ** -0.5)),
        "w2": _w((lambda *s: torch.randn(*s, dtype=torch.bfloat16) * 0.1)(4 * C, C) * ((4 * C) ** -0.5)),
    }

def reference(x, dw_large, dw_small, w1, w2):
    B, H, W, C = x.shape
    Kl = dw_large.shape[0]
    pl = (Kl - 1) // 2
    xpl = _pad(x, ((0,0),(pl,pl),(pl,pl),(0,0)))
    out = torch.zeros_like(x)
    for i in range(Kl):
        for j in range(Kl):
            out = out + xpl[:, i:i+H, j:j+W, :] * dw_large[i, j][None, None, None, :]
    Ks = dw_small.shape[0]
    ps = (Ks - 1) // 2
    xps = _pad(x, ((0,0),(ps,ps),(ps,ps),(0,0)))
    for i in range(Ks):
        for j in range(Ks):
            out = out + xps[:, i:i+H, j:j+W, :] * dw_small[i, j][None, None, None, :]
    h = _layernorm(out, axis=-1)
    h = _gelu(torch.einsum('bhwc,ce->bhwe', h, w1))
    h = torch.einsum('bhwe,ec->bhwc', h, w2)
    return x + h
```

```asm
; @launch grid=(256,1,1) block=(256,1,1) lds=163840
.amdgcn_target "amdgcn-amd-amdhsa--gfx950"
.text
.globl standalone__modern_conv_block_replknet__vision_kernel
.p2align 8
.type standalone__modern_conv_block_replknet__vision_kernel,@function
standalone__modern_conv_block_replknet__vision_kernel:
    s_cmp_ge_u32 s2, 256
    s_cbranch_scc1 L_end
    s_load_dwordx2 s[32:33], s[0:1], 24
    s_load_dwordx2 s[36:37], s[0:1], 32
    s_load_dwordx2 s[4:5], s[0:1], 0
    s_load_dwordx2 s[28:29], s[0:1], 16
    s_load_dwordx2 s[24:25], s[0:1], 8
    s_load_dwordx2 s[20:21], s[0:1], 40
    s_getpc_b64 s[60:61]
L_pc:
    s_lshr_b32 s42, s2, 3
    s_mul_i32 s66, s42, 10
    v_min_u32 v2, 9, v0
    v_add_lshl_u32 v2, v2, s66, 7
    v_min_u32 v2, L_fin-L_pc-4, v2
    v_mov_b32 v3, s61
    v_add_co_u32 v2, vcc, s60, v2
    v_lshrrev_b32 v4, 6, v0
    v_and_b32 v1, 63, v0
    v_addc_co_u32 v3, vcc, 0, v3, vcc
    global_load_dword v9, v[2:3], off
    v_readfirstlane_b32 s40, v4
    v_min_u32 v18, 17, v0
    v_lshlrev_b32 v18, 7, v18
    v_bfe_u32 v7, v1, 2, 2
    v_lshrrev_b32 v8, 5, v0
    v_xor_b32 v8, v8, v7
    v_and_b32 v8, 2, v8
    v_xor_b32 v8, v8, v1
    v_and_b32 v8, 3, v8
    v_mul_u32_u24 v7, 48, v7
    v_add_u32 v7, v7, v8
    v_lshrrev_b32 v8, 4, v1
    v_lshl_add_u32 v7, v8, 2, v7
    v_lshlrev_b32 v7, 4, v7
    v_xor_b32 v31, 32, v7
    s_lshr_b32 s42, s2, 3
    s_mul_i32 s69, s42, 2304
    s_mov_b32 s34, 73728
    s_mov_b32 s35, 0x00020000
    s_mov_b32 s38, 73728
    s_mov_b32 s39, 0x00020000
    s_mul_i32 s66, s40, 18432
    s_cmp_ge_u32 s40, 2
    s_cselect_b32 s3, 0, 118144
    s_add_u32 s3, s3, s66
    s_mov_b32 m0, s3
    s_add_u32 s6, s3, 12288
    s_cmp_eq_u32 s40, 3
    s_cselect_b32 s6, 155008, s6
    s_waitcnt lgkmcnt(0)
    buffer_load_dword v47, v18, s[32:35], s69 offen
    buffer_load_dword v19, v18, s[36:39], s69 offen
    buffer_load_dwordx4 v7, s[32:35], s66 offen offset:0 lds
    buffer_load_dwordx4 v7, s[32:35], s66 offen offset:3072 lds
    s_addk_i32 m0, 768
    s_nop 0
    buffer_load_dwordx4 v7, s[32:35], s66 offen offset:256 lds
    buffer_load_dwordx4 v7, s[32:35], s66 offen offset:3328 lds
    s_addk_i32 m0, 768
    v_lshlrev_b32 v203, 4, v1
    s_lshr_b32 s56, s42, 4
    s_sub_u32 s1, 0, s56
    s_and_b32 s0, s2, 6
    s_lshl_b32 s0, s0, 6
    s_add_u32 s0, s0, 64
    s_lshl_b32 s56, s56, 6
    s_sub_u32 s41, s0, s56
    s_add_u32 s0, s0, s1
    s_or_b32 s56, s1, 1
    s_mul_i32 s12, s56, 98304
    s_mul_i32 s13, s56, 196608
    s_mul_i32 s14, s56, 589824
    s_mul_i32 s15, s56, 786432
    s_and_b32 s42, s42, 15
    s_lshl_b32 s42, s42, 4
    s_and_b32 s56, s2, 1
    s_lshl_b32 s56, s56, 8
    s_add_u32 s42, s42, s56
    s_mul_i32 s56, s42, 192
    s_sub_u32 s56, s56, 384
    v_lshrrev_b32 v2, 2, v1
    v_and_b32 v2, 8, v2
    v_and_b32 v8, 7, v1
    v_add_u32 v2, v2, v8
    v_bfe_u32 v8, v1, 3, 2
    v_mul_u32_u24 v3, 240, v2
    v_lshl_add_u32 v207, v8, 2, v3
    v_lshl_add_u32 v2, v8, 4, v2
    v_mul_u32_u24 v2, 12, v2
    v_add_u32 v179, s56, v2
    v_add_u32 v183, 768, v179
    v_mul_u32_u24 v3, 1366, v0
    v_lshrrev_b32 v3, 16, v3
    v_mul_u32_u24 v4, 48, v3
    v_sub_u32 v4, v0, v4
    v_xor_b32 v6, s1, v3
    s_and_b32 s56, s1, 5
    v_add_u32 v6, s56, v6
    v_and_b32 v6, 7, v6
    v_mul_u32_u24 v5, 960, v6
    v_lshl_add_u32 v5, v4, 2, v5
    v_add_u32 v6, 7, v6
    v_and_b32 v6, 7, v6
    v_mul_u32_u24 v6, 576, v6
    v_lshl_add_u32 v6, v4, 2, v6
    s_mov_b32 s26, 1728
    s_mov_b32 s27, 0x00020000
    s_mov_b32 s30, 4800
    s_mov_b32 s31, 0x00020000
    s_mov_b32 s22, 50331648
    s_mov_b32 s23, 0x00020000
    s_movk_i32 s56, 768
    v_add_u32 v28, 0, v1
    v_mul_u32_u24 v28, 1366, v28
    v_lshrrev_b32 v28, 16, v28
    v_mad_u32_u24 v37, v28, s56, v203
    v_add_u32 v28, 64, v1
    v_mul_u32_u24 v28, 1366, v28
    v_lshrrev_b32 v28, 16, v28
    v_mad_u32_u24 v38, v28, s56, v203
    v_add_u32 v28, 128, v1
    v_mul_u32_u24 v28, 1366, v28
    v_lshrrev_b32 v28, 16, v28
    v_mad_u32_u24 v39, v28, s56, v203
    buffer_load_dword v10, v5, s[28:31], 0 offen offset:0
    s_mov_b32 s49, 0x5f00000
    s_mov_b32 s48, 0x44e944e9
    s_mov_b32 s50, 0x37803780
    s_mov_b32 s52, 0x3c2aaaab
    s_mov_b32 s51, 0x3727c5ac
    s_mov_b32 s53, 114
    buffer_load_dword v11, v5, s[28:31], 0 offen offset:192
    s_mov_b32 s99, -70912
    v_and_b32 v20, 3, v1
    v_bfe_u32 v21, v1, 2, 2
    v_bfe_u32 v22, v1, 4, 1
    v_lshrrev_b32 v23, 5, v1
    v_lshrrev_b32 v24, 4, v1
    v_and_b32 v25, 1, v1
    buffer_load_dword v12, v5, s[28:31], 0 offen offset:384
    v_bfe_u32 v26, v1, 1, 1
    s_and_b32 s59, s40, 1
    v_mov_b32 v30, 163840
    v_bfe_u32 v27, v1, 3, 1
    v_xor_b32 v27, v27, v22
    v_lshlrev_b32 v32, 6, v21
    v_lshl_add_u32 v32, v27, 5, v32
    buffer_load_dword v13, v5, s[28:31], 0 offen offset:576
    v_lshl_add_u32 v32, v20, 3, v32
    v_mul_u32_u24 v27, 6144, v24
    s_mul_i32 s56, s59, 1536
    s_add_u32 s56, s56, 118144
    v_add3_u32 v32, v32, v27, s56
    v_mul_u32_u24 v27, 118144, v23
    v_sub_u32 v33, v32, v27
    buffer_load_dword v14, v5, s[28:31], 0 offen offset:768
    v_add_u32 v33, 24576, v33
    v_and_b32 v27, v22, v23
    v_mul_u32_u24 v27, 87424, v27
    v_subrev_u32 v43, 68992, v32
    v_add_u32 v43, v43, v27
    v_xor_b32 v143, 32, v32
    v_xor_b32 v147, 32, v33
    buffer_load_dword v15, v6, s[24:27], 0 offen offset:0
    v_xor_b32 v151, 32, v43
    v_lshl_add_u32 v27, v23, 2, v21
    v_mul_u32_u24 v27, 192, v27
    v_lshl_add_u32 v27, v20, 4, v27
    v_mul_u32_u24 v28, 24584, v22
    s_mul_i32 s56, s59, 12288
    s_add_u32 s56, s56, 67592
    buffer_load_dword v16, v6, s[24:27], 0 offen offset:192
    v_add3_u32 v34, v27, v28, s56
    v_mul_u32_u24 v28, 12296, v22
    s_mul_i32 s56, s59, 6144
    s_add_u32 s56, s56, 139000
    v_add3_u32 v35, v27, v28, s56
    v_bfe_u32 v27, v1, 3, 2
    v_lshlrev_b32 v27, 6, v27
    buffer_load_dword v17, v6, s[24:27], 0 offen offset:384
    v_and_b32 v28, 7, v1
    v_lshl_add_u32 v27, v28, 2, v27
    v_xor_b32 v28, s59, v22
    v_lshl_add_u32 v27, v28, 5, v27
    v_mul_u32_u24 v28, 1536, v23
    v_add3_u32 v155, v27, v28, s3
    v_xor_b32 v111, 32, v155
    buffer_load_dwordx4 v7, s[32:35], s66 offen offset:512 lds
    v_add3_u32 v135, v27, v28, s6
    v_xor_b32 v135, 32, v135
    v_mov_b32 v115, 956315904
    v_mul_lo_u32 v159, v115, v25
    v_add_u32 v119, s3, v203
    v_add_u32 v139, s6, v203
    v_lshl_add_u32 v27, v20, 1, v23
    buffer_load_dwordx4 v7, s[32:35], s66 offen offset:3584 lds
    s_addk_i32 m0, 4608
    s_addk_i32 s66, 6144
    v_mul_u32_u24 v27, 3936, v27
    v_add_u32 v28, v21, v22
    v_lshl_add_u32 v27, v28, 4, v27
    s_mul_i32 s56, s40, 960
    s_add_u32 s56, s56, 70912
    v_add_u32 v250, s56, v27
    v_add_u32 v251, 7872, v250
    buffer_load_dwordx4 v31, s[32:35], s66 offen offset:0 lds
    v_add_u32 v252, 15744, v250
    v_lshl_add_u32 v27, v26, 2, v21
    v_lshlrev_b32 v27, 4, v27
    s_mul_i32 s56, s40, 7872
    s_add_u32 s56, s56, 5376
    v_add_u32 v27, s56, v27
    v_sub_u32 v28, v24, v25
    buffer_load_dwordx4 v31, s[32:35], s66 offen offset:3072 lds
    s_mul_i32 s43, s15, 7
    s_addk_i32 m0, 768
    v_cmp_gt_i32 vcc, 0, v28
    v_lshl_add_u32 v28, v28, 7, v27
    s_nop 0
    v_cndmask_b32 v253, v28, v30, vcc
    v_sub_u32 v28, v23, v25
    v_cmp_lt_i32 vcc, 0, v28
    v_add_u32 v28, 4, v28
    buffer_load_dwordx4 v31, s[32:35], s66 offen offset:256 lds
    v_lshl_add_u32 v28, v28, 7, v27
    v_lshl_add_u32 v28, v22, 3, v28
    v_cndmask_b32 v254, v28, v30, vcc
    v_mul_u32_u24 v27, 0x5555, v26
    v_add_u32 v175, 0x8888, v27
    s_mul_i32 s8, s40, 6144
    s_add_u32 s8, s8, 36864
    buffer_load_dwordx4 v31, s[32:35], s66 offen offset:3328 lds
    s_addk_i32 m0, 768
    s_mul_i32 s97, s40, 3072
    s_add_u32 s97, s97, 141760
    s_lshl_b32 s98, s40, 10
    s_add_u32 s98, s98, 61440
    s_xor_b32 s56, s40, 1
    s_mul_i32 s96, s56, 3072
    s_add_u32 s96, s96, 141760
    buffer_load_dwordx4 v31, s[32:35], s66 offen offset:512 lds
    s_lshl_b32 s56, s56, 9
    s_add_u32 s56, s56, 36864
    v_mul_u32_u24 v27, 1792, v24
    v_add3_u32 v255, v27, v203, s56
    s_and_b32 s58, s40, 2
    s_lshl_b32 s56, s58, 5
    v_xor_b32 v255, s56, v255
    buffer_load_dwordx4 v31, s[32:35], s66 offen offset:3584 lds
    s_mov_b32 m0, s6
    s_addk_i32 s66, 6144
    v_lshl_add_u32 v27, v24, 2, v21
    v_lshlrev_b32 v28, 1, v20
    v_xor_b32 v27, v27, v28
    v_lshl_add_u32 v27, v25, 4, v27
    v_lshl_add_u32 v27, v26, 6, v27
    v_lshl_add_u32 v207, v27, 20, v207
    v_lshl_add_u32 v27, v20, 2, v21
    buffer_load_dwordx4 v7, s[32:35], s66 offen offset:0 lds
    s_add_u32 s58, s58, s40
    v_mul_u32_u24 v28, 320, v24
    v_lshl_add_u32 v28, v27, 2, v28
    v_add_u32 v28, 72, v28
    v_lshl_add_u32 v175, v28, 16, v175
    v_mul_u32_u24 v28, 192, v27
    v_lshl_add_u32 v187, v24, 4, v28
    buffer_load_dwordx4 v7, s[32:35], s66 offen offset:3072 lds
    s_addk_i32 m0, 768
    s_sub_u32 s56, s58, 8
    s_mul_i32 s44, s56, s12
    s_lshl_b32 s56, s0, 9
    s_add_u32 s56, s56, s42
    s_mul_i32 s56, s56, 192
    s_add_u32 s44, s44, s56
    v_lshlrev_b32 v27, 4, v25
    buffer_load_dwordx4 v7, s[32:35], s66 offen offset:256 lds
    v_mov_b32 v28, 0x3f80
    v_lshlrev_b32 v27, v27, v28
    v_cmp_eq_u32 vcc, v21, v24
    s_nop 1
    v_cndmask_b32 v27, 0, v27, vcc
    v_cmp_eq_u32 vcc, 1, v26
    s_nop 1
    v_cndmask_b32 v245, 0, v27, vcc
    v_sub_u32 v244, v27, v245
    buffer_load_dwordx4 v7, s[32:35], s66 offen offset:3328 lds
    s_addk_i32 m0, 768
    v_mov_b32 v195, 0
    s_mov_b32 s7, 0
    v_lshlrev_b32 v27, 2, v1
    v_add_u32 v27, 5120, v27
    v_cmp_ne_u32 vcc, s40, v24
    s_nop 1
    v_cndmask_b32 v191, v27, v30, vcc
    ds_write_b32 v191, v195
    buffer_load_dwordx4 v7, s[32:35], s66 offen offset:512 lds
    s_mov_b32 s92, 0xbf7fdde7
    s_mov_b32 s94, 0x40088889
    v_mov_b32 v62, 0xc09d2a01
    v_lshlrev_b32 v63, 17, v0
    v_or_b32 v63, 0x8000, v63
    v_lshlrev_b32 v40, 2, v0
    v_add_u32 v41, 65536, v40
    buffer_load_dwordx4 v7, s[32:35], s66 offen offset:3584 lds
    v_add_u32 v208, 0x0, v63
    v_add_u32 v214, 0x2000000, v63
    v_add_u32 v209, 0x10000, v63
    v_add_u32 v215, 0x2010000, v63
    v_ldexp_f32 v208, v208, s53
    v_ldexp_f32 v214, v214, s53
    v_ldexp_f32 v209, v209, s53
    s_lshr_b32 s9, s40, 1
    s_and_b32 s10, s40, 1
    s_mul_i32 s66, s9, 36864
    s_mul_i32 s11, s10, 768
    s_add_u32 s66, s66, s11
    s_mul_i32 s9, s9, 12288
    s_mul_i32 s10, s10, 24584
    s_add_u32 s9, s9, s10
    s_add_u32 m0, s9, 67592
    s_nop 0
    buffer_load_dwordx4 v37, s[36:39], s66 offen offset:0 lds
    v_ldexp_f32 v215, v215, s53
    v_pk_mul_f32 v[210:211], v[208:209], v[208:209]
    v_pk_mul_f32 v[216:217], v[214:215], v[214:215]
    v_pk_fma_f32 v[210:211], v[210:211], s[92:93], v[62:63] op_sel_hi:[1,0,0]
    v_pk_fma_f32 v[216:217], v[216:217], s[92:93], v[62:63] op_sel_hi:[1,0,0]
    v_pk_mul_f32 v[210:211], v[210:211], v[208:209]
    buffer_load_dwordx4 v38, s[36:39], s66 offen offset:1024 lds
    v_pk_mul_f32 v[216:217], v[216:217], v[214:215]
    v_exp_f32 v210, v210
    v_exp_f32 v216, v216
    v_exp_f32 v211, v211
    v_exp_f32 v217, v217
    v_pk_mul_f32 v[208:209], v[208:209], s[94:95] op_sel_hi:[1,0]
    v_pk_mul_f32 v[214:215], v[214:215], s[94:95] op_sel_hi:[1,0]
    buffer_load_dwordx4 v39, s[36:39], s66 offen offset:2048 lds
    s_add_u32 s66, s66, 6144
    s_add_u32 m0, m0, 3072
    v_pk_add_f32 v[212:213], v[210:211], 1.0 op_sel_hi:[1,0]
    v_pk_add_f32 v[218:219], v[216:217], 1.0 op_sel_hi:[1,0]
    v_rcp_f32 v212, v212
    v_rcp_f32 v218, v218
    v_rcp_f32 v213, v213
    v_rcp_f32 v219, v219
    v_pk_mul_f32 v[212:213], v[208:209], v[212:213]
    buffer_load_dwordx4 v37, s[36:39], s66 offen offset:0 lds
    v_pk_mul_f32 v[218:219], v[214:215], v[218:219]
    v_pk_mul_f32 v[210:211], v[212:213], v[210:211] neg_lo:[1,0] neg_hi:[1,0]
    v_pk_mul_f32 v[216:217], v[218:219], v[216:217] neg_lo:[1,0] neg_hi:[1,0]
    v_cvt_pk_bf16_f32 v20, v212, v213
    v_cvt_pk_bf16_f32 v21, v218, v219
    v_cvt_pk_bf16_f32 v25, v210, v211
    v_cvt_pk_bf16_f32 v26, v216, v217
    buffer_load_dwordx4 v38, s[36:39], s66 offen offset:1024 lds
    v_add_u32 v208, 0x4000000, v63
    v_add_u32 v214, 0x6000000, v63
    v_add_u32 v209, 0x4010000, v63
    v_add_u32 v215, 0x6010000, v63
    v_ldexp_f32 v208, v208, s53
    v_ldexp_f32 v214, v214, s53
    v_ldexp_f32 v209, v209, s53
    buffer_load_dwordx4 v39, s[36:39], s66 offen offset:2048 lds
    s_add_u32 s66, s66, 6144
    s_add_u32 m0, m0, 3072
    v_ldexp_f32 v215, v215, s53
    v_pk_mul_f32 v[210:211], v[208:209], v[208:209]
    v_pk_mul_f32 v[216:217], v[214:215], v[214:215]
    v_pk_fma_f32 v[210:211], v[210:211], s[92:93], v[62:63] op_sel_hi:[1,0,0]
    v_pk_fma_f32 v[216:217], v[216:217], s[92:93], v[62:63] op_sel_hi:[1,0,0]
    v_pk_mul_f32 v[210:211], v[210:211], v[208:209]
    s_mov_b32 s60, 0xffff0000
    buffer_load_dwordx4 v37, s[36:39], s66 offen offset:0 lds
    s_waitcnt vmcnt(28)
    v_lshlrev_b32 v48, 16, v10
    s_waitcnt vmcnt(27)
    v_lshlrev_b32 v49, 16, v11
    s_waitcnt vmcnt(26)
    v_lshlrev_b32 v50, 16, v12
    s_waitcnt vmcnt(25)
    v_lshlrev_b32 v51, 16, v13
    s_waitcnt vmcnt(24)
    v_lshlrev_b32 v52, 16, v14
    s_waitcnt vmcnt(23)
    v_lshlrev_b32 v53, 16, v15
    v_add_f32 v49, v49, v53
    buffer_load_dwordx4 v38, s[36:39], s66 offen offset:1024 lds
    s_waitcnt vmcnt(23)
    v_lshlrev_b32 v53, 16, v16
    v_add_f32 v50, v50, v53
    s_waitcnt vmcnt(22)
    v_lshlrev_b32 v53, 16, v17
    v_add_f32 v51, v51, v53
    v_cvt_pk_bf16_f32 v64, v48, v49
    v_cvt_pk_bf16_f32 v65, v50, v51
    v_cvt_pk_bf16_f32 v66, v52, 0
    buffer_load_dwordx4 v39, s[36:39], s66 offen offset:2048 lds
    s_add_u32 s66, s66, 6144
    s_add_u32 m0, m0, 3072
    v_mov_b32 v67, 0
    v_cvt_pk_bf16_f32 v68, 0, v48
    v_cvt_pk_bf16_f32 v69, v49, v50
    v_cvt_pk_bf16_f32 v70, v51, v52
    v_mov_b32 v71, 0
    v_mov_b32 v72, 0
    v_mov_b32 v76, 0
    buffer_load_dwordx4 v37, s[36:39], s66 offen offset:0 lds
    v_mov_b32 v73, v64
    v_mov_b32 v77, v68
    v_mov_b32 v74, v65
    v_mov_b32 v78, v69
    v_mov_b32 v75, v66
    v_mov_b32 v79, v70
    v_and_b32 v48, s60, v10
    buffer_load_dwordx4 v38, s[36:39], s66 offen offset:1024 lds
    v_and_b32 v49, s60, v11
    s_mul_i32 s45, s40, 11808
    v_and_b32 v50, s60, v12
    v_and_b32 v51, s60, v13
    v_and_b32 v52, s60, v14
    v_and_b32 v53, s60, v15
    v_add_f32 v49, v49, v53
    v_and_b32 v53, s60, v16
    buffer_load_dwordx4 v39, s[36:39], s66 offen offset:2048 lds
    v_add_f32 v50, v50, v53
    v_and_b32 v53, s60, v17
    v_add_f32 v51, v51, v53
    v_cvt_pk_bf16_f32 v80, v48, v49
    v_cvt_pk_bf16_f32 v81, v50, v51
    v_cvt_pk_bf16_f32 v82, v52, 0
    v_mov_b32 v83, 0
    v_cvt_pk_bf16_f32 v84, 0, v48
    v_cvt_pk_bf16_f32 v85, v49, v50
    v_cvt_pk_bf16_f32 v86, v51, v52
    v_mov_b32 v87, 0
    v_mov_b32 v88, 0
    v_mov_b32 v92, 0
    v_mov_b32 v89, v80
    v_mov_b32 v93, v84
    v_mov_b32 v90, v81
    v_mov_b32 v94, v85
    v_mov_b32 v91, v82
    v_mov_b32 v95, v86
    v_mul_u32_u24 v42, 656, v4
    v_lshl_add_u32 v42, v3, 7, v42
    v_add_u32 v42, 5376, v42
    v_cmp_lt_u32 vcc, 4, v3
    s_nop 1
    v_cndmask_b32 v42, v42, v30, vcc
    v_pk_mul_f32 v[216:217], v[216:217], v[214:215]
    v_exp_f32 v210, v210
    v_exp_f32 v216, v216
    v_exp_f32 v211, v211
    v_exp_f32 v217, v217
    v_pk_mul_f32 v[208:209], v[208:209], s[94:95] op_sel_hi:[1,0]
    v_pk_mul_f32 v[214:215], v[214:215], s[94:95] op_sel_hi:[1,0]
    v_pk_add_f32 v[212:213], v[210:211], 1.0 op_sel_hi:[1,0]
    v_pk_add_f32 v[218:219], v[216:217], 1.0 op_sel_hi:[1,0]
    v_rcp_f32 v212, v212
    v_rcp_f32 v218, v218
    v_rcp_f32 v213, v213
    v_rcp_f32 v219, v219
    v_pk_mul_f32 v[212:213], v[208:209], v[212:213]
    s_mul_i32 s67, s40, 3
    s_sub_u32 s67, s67, 2
    v_pk_mul_f32 v[218:219], v[214:215], v[218:219]
    s_mul_i32 s67, s67, s12
    s_mul_i32 s68, s0, 98304
    s_add_u32 s67, s67, s68
    s_add_u32 s16, s4, s67
    s_addc_u32 s17, s5, 0
    s_mov_b32 s18, 98304
    s_mov_b32 s19, 0x00020000
    buffer_load_dwordx3 v[108:110], v179, s[16:19], 0 offen nt
    s_waitcnt vmcnt(13)
    ds_read_b128 v[96:99], v119 offset:0
    v_pk_mul_f32 v[210:211], v[212:213], v[210:211] neg_lo:[1,0] neg_hi:[1,0]
    v_cvt_pk_bf16_f32 v22, v212, v213
    v_add_u32 v208, 0x8000000, v63
    ds_read_b128 v[100:103], v119 offset:1024
    ds_read_b128 v[104:107], v119 offset:2048
    ds_read_b128 v[226:229], v119 offset:3072
    ds_read_b128 v[230:233], v119 offset:4096
    ds_read_b128 v[234:237], v119 offset:5120
    ds_read_b128 v[238:241], v119 offset:6144
    ds_read_b128 v[54:57], v119 offset:7168
    ds_read_b128 v[58:61], v119 offset:8192
    v_add_u32 v209, 0x8010000, v63
    buffer_load_dwordx3 v[112:114], v183, s[16:19], 0 offen offset:0 nt
    v_mov_b64 v[242:243], 0
    s_waitcnt lgkmcnt(8)
    v_and_b32 v127, 0x7fff, v96
    v_and_b32 v131, 0x7fff, v97
    v_max_u32 v127, v127, v131
    v_and_b32 v131, 0x7fff, v98
    v_max_u32 v127, v127, v131
    v_and_b32 v131, 0x7fff, v99
    v_max_u32 v127, v127, v131
    s_mov_b32 s61, 0x3a80
    v_cmp_le_u32 s[100:101], s61, v127
    buffer_load_dwordx3 v[116:118], v183, s[16:19], 0 offen offset:768 nt
    v_or3_b32 v123, v96, v97, v98
    s_waitcnt lgkmcnt(7)
    v_or3_b32 v123, v123, v99, v100
    s_bcnt1_i32_b64 s61, s[100:101]
    s_sub_u32 s61, s61, 32
    v_or3_b32 v123, v123, v101, s61
    v_or3_b32 v123, v123, v102, v103
    s_waitcnt lgkmcnt(6)
    v_or3_b32 v123, v123, v104, v105
    v_or3_b32 v123, v123, v106, v107
    s_waitcnt lgkmcnt(5)
    v_or3_b32 v123, v123, v226, v227
    buffer_load_dwordx3 v[120:122], v183, s[16:19], 0 offen offset:1536 nt
    v_or3_b32 v123, v123, v228, v229
    s_waitcnt lgkmcnt(4)
    v_or3_b32 v123, v123, v230, v231
    v_or3_b32 v123, v123, v232, v233
    ds_read_b128 v[96:99], v119 offset:9216
    ds_read_b128 v[100:103], v119 offset:10240
    ds_read_b128 v[104:107], v119 offset:11264
    ds_read_b128 v[226:229], v139 offset:0
    ds_read_b128 v[230:233], v139 offset:1024
    s_waitcnt lgkmcnt(8)
    v_or3_b32 v123, v123, v234, v235
    buffer_load_dwordx3 v[124:126], v183, s[16:19], 0 offen offset:2304 nt
    v_or3_b32 v123, v123, v236, v237
    s_waitcnt lgkmcnt(7)
    v_or3_b32 v123, v123, v238, v239
    v_or3_b32 v123, v123, v240, v241
    s_waitcnt lgkmcnt(6)
    v_or3_b32 v123, v123, v54, v55
    v_or3_b32 v123, v123, v56, v57
    s_waitcnt lgkmcnt(5)
    v_or3_b32 v123, v123, v58, v59
    v_or3_b32 v123, v123, v60, v61
    ds_read_b128 v[234:237], v139 offset:2048
    ds_read_b128 v[238:241], v139 offset:3072
    ds_read_b128 v[54:57], v139 offset:4096
    s_add_u32 s16, s16, s12
    s_addc_u32 s17, s17, s1
    buffer_load_dwordx3 v[128:130], v179, s[16:19], 0 offen nt
    ds_read_b128 v[58:61], v139 offset:5120
    ds_add_u32 v111, v159 offset:512
    ds_add_u32 v111, v159 offset:3584
    ds_add_u32 v155, v159 offset:6656
    ds_add_u32 v155, v159 offset:9728
    ds_add_u32 v135, v159 offset:512
    ds_add_u32 v135, v159 offset:3584
    ds_add_u32 v111, v159 offset:1280
    ds_add_u32 v111, v159 offset:4352
    buffer_load_dwordx3 v[132:134], v183, s[16:19], 0 offen offset:0 nt
    ds_add_u32 v155, v159 offset:7424
    ds_add_u32 v155, v159 offset:10496
    ds_add_u32 v135, v159 offset:1280
    ds_add_u32 v135, v159 offset:4352
    s_waitcnt lgkmcnt(15)
    v_or3_b32 v123, v123, v96, v97
    v_or3_b32 v123, v123, v98, v99
    v_or3_b32 v123, v123, v100, v101
    v_or3_b32 v123, v123, v102, v103
    v_or3_b32 v123, v123, v104, v105
    buffer_load_dwordx3 v[136:138], v183, s[16:19], 0 offen offset:768 nt
    v_or3_b32 v123, v123, v106, v107
    v_or3_b32 v123, v123, v226, v227
    v_or3_b32 v123, v123, v228, v229
    v_or3_b32 v123, v123, v230, v231
    v_or3_b32 v123, v123, v232, v233
    v_or3_b32 v123, v123, v234, v235
    v_or3_b32 v123, v123, v236, v237
    s_waitcnt lgkmcnt(14)
    v_or3_b32 v123, v123, v238, v239
    v_or3_b32 v123, v123, v240, v241
    buffer_load_dwordx3 v[140:142], v183, s[16:19], 0 offen offset:1536 nt
    s_waitcnt lgkmcnt(13)
    v_or3_b32 v123, v123, v54, v55
    v_or3_b32 v123, v123, v56, v57
    s_waitcnt lgkmcnt(12)
    v_or3_b32 v123, v123, v58, v59
    v_or3_b32 v123, v123, v60, v61
    v_and_b32 v123, 0x40004000, v123
    v_cmp_ne_u32 s[100:101], 0, v123
    v_add_u32 v127, 158464, v191
    s_nop 0
    s_bcnt1_i32_b64 s61, s[100:101]
    v_mov_b32 v123, s61
    ds_write_b32 v127, v123
    v_lshlrev_b32 v127, 2, v1
    buffer_load_dwordx3 v[144:146], v183, s[16:19], 0 offen offset:2304 nt
    s_add_u32 s45, s45, 70912
    s_add_u32 s16, s16, s12
    s_addc_u32 s17, s17, s1
    v_cvt_pk_bf16_f32 v23, v218, v219
    buffer_load_dwordx3 v[148:150], v179, s[16:19], 0 offen nt
    v_ldexp_f32 v208, v208, s53
    s_waitcnt vmcnt(11) lgkmcnt(0)
    s_barrier
    ds_read_b64_tr_b16 a[10:11], v43 offset:3072
    ds_read_b64_tr_b16 a[206:207], v34 offset:7752
    s_and_b32 s67, s40, 1
    ds_read_b64_tr_b16 a[172:173], v34 offset:3080
    buffer_load_dwordx3 v[152:154], v183, s[16:19], 0 offen offset:0 nt
    buffer_load_dwordx3 v[156:158], v183, s[16:19], 0 offen offset:768 nt
    ds_read_b64_tr_b16 a[226:227], v34 offset:10816
    ds_read_b64_tr_b16 a[216:217], v34 offset:9216
    ds_read_b64_tr_b16 a[170:171], v34 offset:4608
    ds_read_b64_tr_b16 a[152:153], v34 offset:64
    s_add_u32 s67, s67, s40
    ds_read_b64_tr_b16 a[212:213], v34 offset:6280
    ds_read_b64_tr_b16 a[186:187], v34 offset:4736
    ds_read_b64_tr_b16 a[156:157], v34 offset:72
    ds_read_b64_tr_b16 a[220:221], v34 offset:9224
    buffer_load_dwordx3 v[160:162], v183, s[16:19], 0 offen offset:1536 nt
    s_sub_u32 s67, 10, s67
    s_mul_i32 s67, s67, s12
    ds_read_b64_tr_b16 a[224:225], v34 offset:9280
    ds_read_b64_tr_b16 a[230:231], v34 offset:10824
    ds_read_b64_tr_b16 a[182:183], v34 offset:4680
    ds_read_b64_tr_b16 a[196:197], v34 offset:6152
    v_ldexp_f32 v209, v209, s53
    buffer_load_dwordx3 v[164:166], v183, s[16:19], 0 offen offset:2304 nt
    ds_read_b64_tr_b16 a[174:175], v34 offset:4616
    s_add_u32 s16, s16, s67
    ds_read_b64_tr_b16 a[14:15], v143 offset:3072
    ds_read_b64_tr_b16 a[198:199], v34 offset:7688
    ds_read_b64_tr_b16 a[188:189], v34 offset:3208
    v_add_u32 v127, 163584, v127
    ds_read_b64_tr_b16 a[150:151], v34 offset:1544
    s_addc_u32 s17, s17, s1
    ds_read_b64_tr_b16 a[214:215], v34 offset:7816
    ds_read_b64_tr_b16 a[162:163], v34 offset:1664
    s_and_b32 s46, s40, 2
    ds_read_b64_tr_b16 a[164:165], v34 offset:136
    ds_read_b64_tr_b16 a[190:191], v34 offset:4744
    ds_read_b64_tr_b16 a[166:167], v34 offset:1672
    s_add_u32 s46, s46, s40
    s_add_u32 s46, s46, 12
    s_add_u32 s67, s41, 64
    ds_read_b64_tr_b16 a[200:201], v34 offset:6208
    ds_read_b64_tr_b16 a[146:147], v34 offset:1536
    s_and_b32 s67, s67, 0x180
    s_cselect_b32 s54, 2, 0
    ds_read_b64_tr_b16 a[168:169], v34 offset:3072
    ds_read_b64_tr_b16 a[204:205], v34 offset:6216
    ds_read_b64_tr_b16 a[158:159], v34 offset:1608
    ds_read_b64_tr_b16 a[12:13], v143 offset:0
    s_add_u32 s54, s54, 66
    ds_read_b64_tr_b16 a[42:43], v147 offset:3328
    ds_read_b64_tr_b16 a[30:31], v33 offset:3328
    s_lshr_b32 s9, s40, 1
    ds_read_b64_tr_b16 a[178:179], v34 offset:4672
    ds_read_b64_tr_b16 a[210:211], v34 offset:7808
    ds_read_b32 v123, v127
    ds_read_b64_tr_b16 a[238:239], v34 offset:10888
    ds_read_b64_tr_b16 a[234:235], v34 offset:10880
    s_and_b32 s10, s40, 1
    ds_read_b64_tr_b16 a[148:149], v34 offset:8
    ds_read_b64_tr_b16 a[176:177], v34 offset:3136
    ds_read_b64_tr_b16 a[232:233], v34 offset:9344
    ds_read_b64_tr_b16 a[160:161], v34 offset:128
    s_mul_i32 s66, s9, 36864
    ds_read_b64_tr_b16 a[192:193], v34 offset:6144
    ds_read_b64_tr_b16 a[208:209], v34 offset:6272
    s_mul_i32 s11, s10, 768
    ds_read_b64_tr_b16 a[40:41], v147 offset:256
    ds_read_b64_tr_b16 a[184:185], v34 offset:3200
    ds_read_b64_tr_b16 a[32:33], v43 offset:256
    ds_read_b64_tr_b16 a[194:195], v34 offset:7680
    v_cvt_pk_bf16_f32 v27, v210, v211
    ds_read_b64_tr_b16 a[228:229], v34 offset:9288
    ds_read_b64_tr_b16 a[144:145], v34 offset:0
    ds_read_b64_tr_b16 a[154:155], v34 offset:1600
    v_pk_mul_f32 v[210:211], v[208:209], v[208:209]
    ds_read_b64_tr_b16 a[222:223], v34 offset:10760
    ds_read_b64_tr_b16 a[202:203], v34 offset:7744
    s_add_u32 s66, s66, s11
    ds_read_b64_tr_b16 a[236:237], v34 offset:9352
    s_mul_i32 s9, s9, 6144
    s_add_u32 s66, s66, 24576
    ds_read_b64_tr_b16 a[218:219], v34 offset:10752
    ds_read_b64_tr_b16 a[180:181], v34 offset:3144
    s_waitcnt lgkmcnt(15)
    v_cmp_ne_u32 s[100:101], 0, v123
    s_mul_i32 s10, s10, 12296
    ds_read_b64_tr_b16 a[6:7], v33 offset:3072
    ds_read_b64_tr_b16 a[0:1], v32 offset:0
    ds_read_b64_tr_b16 a[28:29], v33 offset:256
    ds_read_b64_tr_b16 a[34:35], v43 offset:3328
    s_add_u32 s9, s9, s10
    s_add_u32 m0, s9, 139000
    ds_read_b64_tr_b16 a[26:27], v32 offset:3328
    ds_read_b64_tr_b16 a[22:23], v151 offset:3072
    ds_read_b64_tr_b16 a[20:21], v151 offset:0
    ds_read_b64_tr_b16 a[2:3], v32 offset:3072
    s_cmp_lg_u64 s[100:101], 0
    ds_read_b64_tr_b16 a[4:5], v33 offset:0
    v_pk_fma_f32 v[210:211], v[210:211], s[92:93], v[62:63] op_sel_hi:[1,0,0]
    ds_read_b64_tr_b16 a[18:19], v147 offset:3072
    ds_read_b64_tr_b16 a[38:39], v143 offset:3328
    ds_read_b64_tr_b16 a[8:9], v43 offset:0
    ds_read_b64_tr_b16 a[16:17], v147 offset:0
    s_cbranch_scc1 L_slow
    ds_read_b64_tr_b16 a[36:37], v143 offset:256
    ds_read_b64_tr_b16 a[24:25], v32 offset:256
    s_waitcnt lgkmcnt(15)
    s_barrier
    ds_write_b128 v42, v[72:75] offset:32
    s_and_b32 s56, s40, 2
    ds_write_b128 v42, v[88:91] offset:96
    v_pk_mul_f32 v[210:211], v[210:211], v[208:209]
    ds_write_b128 v42, v[68:71] offset:16
    ds_write_b128 v42, v[80:83] offset:64
    v_add_u32_sdwa v31, s45, v207 dst_sel:DWORD dst_unused:UNUSED_PAD src0_sel:DWORD src1_sel:WORD_0
    s_add_u32 s56, s56, s40
    ds_write_b128 v42, v[64:67] offset:0
    v_add_u32 v171, s98, v203
    ds_write_b128 v42, v[92:95] offset:112
    ds_write_b128 v42, v[84:87] offset:80
    ds_write_b128 v42, v[76:79] offset:48
    v_exp_f32 v210, v210
    s_mul_i32 s45, s56, 3936
    ds_read_b64_tr_b16 a[52:53], v33 offset:512
    ds_read_b64_tr_b16 a[94:95], v151 offset:3840
    ds_read_b64_tr_b16 a[108:109], v143 offset:1024
    s_waitcnt vmcnt(10)
    ds_write_b32 v31, v126 offset:224
    ds_read_b64_tr_b16 a[66:67], v147 offset:3584
    ds_read_b64_tr_b16 a[54:55], v33 offset:3584
    ds_write2_b32 v31, v118, v120 offset0:48 offset1:12
    v_pk_mul_f32 v[216:217], v[218:219], v[216:217] neg_lo:[1,0] neg_hi:[1,0]
    ds_read_b64_tr_b16 a[112:113], v147 offset:1024
    ds_read_b64_tr_b16 a[114:115], v147 offset:4096
    ds_write2_b32 v31, v108, v109 offset0:0 offset1:20
    ds_read_b64_tr_b16 a[90:91], v147 offset:3840
    ds_read_b64_tr_b16 a[106:107], v43 offset:4096
    ds_write2_b32 v31, v110, v112 offset0:40 offset1:4
    ds_read_b64_tr_b16 a[132:133], v143 offset:1280
    ds_read_b64_tr_b16 a[136:137], v147 offset:1280
    ds_write2_b32 v31, v113, v114 offset0:24 offset1:44
    ds_read_b64_tr_b16 a[88:89], v147 offset:768
    ds_read_b64_tr_b16 a[78:79], v33 offset:3840
    ds_write2_b32 v31, v116, v117 offset0:8 offset1:28
    ds_read_b64_tr_b16 a[118:119], v151 offset:4096
    ds_read_b64_tr_b16 a[86:87], v143 offset:3840
    ds_write2_b32 v31, v124, v125 offset0:16 offset1:36
    ds_read_b64_tr_b16 a[98:99], v32 offset:4096
    ds_read_b64_tr_b16 a[48:49], v32 offset:512
    ds_write2_b32 v31, v121, v122 offset0:32 offset1:52
    v_add_u32 v31, 3936, v31
    ds_read_b64_tr_b16 a[104:105], v43 offset:1024
    ds_read_b64_tr_b16 a[44:45], v151 offset:256
    s_waitcnt vmcnt(8)
    ds_write2_b32 v31, v130, v132 offset0:40 offset1:4
    ds_read_b64_tr_b16 a[110:111], v143 offset:4096
    ds_read_b64_tr_b16 a[138:139], v147 offset:4352
    s_waitcnt vmcnt(7)
    ds_write2_b32 v31, v136, v137 offset0:8 offset1:28
    ds_read_b64_tr_b16 a[100:101], v33 offset:1024
    ds_read_b64_tr_b16 a[62:63], v143 offset:3584
    ds_write2_b32 v31, v128, v129 offset0:0 offset1:20
    ds_read_b64_tr_b16 a[116:117], v151 offset:1024
    ds_read_b64_tr_b16 a[46:47], v151 offset:3328
    ds_write2_b32 v31, v133, v134 offset0:24 offset1:44
    v_pk_mul_f32 v[208:209], v[208:209], s[94:95] op_sel_hi:[1,0]
    s_add_u32 s45, s45, 47488
    ds_read_b64_tr_b16 a[128:129], v43 offset:1280
    ds_read_b64_tr_b16 a[126:127], v33 offset:4352
    s_waitcnt vmcnt(5)
    ds_write2_b32 v31, v144, v145 offset0:16 offset1:36
    ds_read_b64_tr_b16 a[80:81], v43 offset:768
    ds_read_b64_tr_b16 a[82:83], v43 offset:3840
    ds_write2_b32 v31, v141, v142 offset0:32 offset1:52
    s_add_u32 s55, s45, 7872
    ds_read_b64_tr_b16 a[122:123], v32 offset:4352
    ds_read_b64_tr_b16 a[120:121], v32 offset:1280
    ds_write_b32 v31, v146 offset:224
    ds_read_b64_tr_b16 a[60:61], v143 offset:512
    ds_read_b64_tr_b16 a[70:71], v151 offset:3584
    ds_write2_b32 v31, v138, v140 offset0:48 offset1:12
    v_add_u32 v31, 3936, v31
    ds_read_b64_tr_b16 a[140:141], v151 offset:1280
    ds_read_b64_tr_b16 a[142:143], v151 offset:4352
    s_waitcnt vmcnt(2)
    ds_write2_b32 v31, v156, v157 offset0:8 offset1:28
    ds_read_b64_tr_b16 a[76:77], v33 offset:768
    ds_read_b64_tr_b16 a[56:57], v43 offset:512
    ds_write2_b32 v31, v150, v152 offset0:40 offset1:4
    ds_read_b64_tr_b16 a[124:125], v33 offset:1280
    ds_read_b64_tr_b16 a[74:75], v32 offset:3840
    ds_write2_b32 v31, v153, v154 offset0:24 offset1:44
    ds_read_b64_tr_b16 a[64:65], v147 offset:512
    ds_read_b64_tr_b16 a[58:59], v43 offset:3584
    ds_write2_b32 v31, v148, v149 offset0:0 offset1:20
    ds_read_b64_tr_b16 a[84:85], v143 offset:768
    ds_read_b64_tr_b16 a[50:51], v32 offset:3584
    ds_read_b64_tr_b16 a[102:103], v33 offset:4096
    s_waitcnt vmcnt(0)
    ds_write_b32 v31, v166 offset:224
    ds_read_b64_tr_b16 a[134:135], v143 offset:4352
    ds_read_b64_tr_b16 a[130:131], v43 offset:4352
    ds_write2_b32 v31, v161, v162 offset0:32 offset1:52
    ds_read_b64_tr_b16 a[96:97], v32 offset:1024
    ds_read_b64_tr_b16 a[68:69], v151 offset:512
    ds_write2_b32 v31, v158, v160 offset0:48 offset1:12
    ds_read_b64_tr_b16 a[92:93], v151 offset:768
    ds_read_b64_tr_b16 a[72:73], v32 offset:768
    ds_write2_b32 v31, v164, v165 offset0:16 offset1:36
    v_exp_f32_e64 v211, v211
    v_mfma_f32_32x32x8_bf16 v[120:135], v[242:243], v[242:243], 0
    s_waitcnt lgkmcnt(0)
    s_barrier
    ds_read_b128 v[12:15], v253 offset:0
    s_sub_u32 s56, s55, 70912
    buffer_load_dwordx4 v37, s[36:39], s66 offen offset:0 lds
    s_min_u32 s55, s55, s56
    ds_read_b128 v[50:53], v251 offset:80
    ds_read_b64 v[16:17], v254 offset:0
    s_add_u32 s45, s45, 70656
    ds_read_b128 v[58:61], v253 offset:656
    v_pk_add_f32 v[212:213], v[210:211], 1.0 op_sel_hi:[1,0]
    v_cvt_pk_bf16_f32 v28, v216, v217
    ds_read_b128 v[4:7], v251 offset:0
    ds_read_b128 v[8:11], v252 offset:0
    ds_read_b128 v[46:49], v250 offset:80
    s_add_u32 s55, s55, 70656
    buffer_load_dwordx4 v38, s[36:39], s66 offen offset:1024 lds
    buffer_load_dwordx4 v39, s[36:39], s66 offen offset:2048 lds
    v_rcp_f32_e64 v212, v212
    ds_read_b128 v[0:3], v250 offset:0
    ds_read_b128 v[104:107], v252 offset:160
    ds_read_b128 v[108:111], v253 offset:1312
    v_rcp_f32_e64 v213, v213
    v_mfma_f32_32x32x8_bf16 v[136:151], v[242:243], v[242:243], 0
    ds_read_b128 v[54:57], v252 offset:80
    s_add_u32 s66, s66, 6144
    s_add_u32 m0, m0, 3072
    s_nop 0
    buffer_load_dwordx4 v37, s[36:39], s66 offen offset:0 lds
    ds_read_b64 v[62:63], v254 offset:656
    ds_read_b64 v[112:113], v254 offset:1312
    v_pk_mul_f32 v[212:213], v[208:209], v[212:213]
    buffer_load_dwordx4 v38, s[36:39], s66 offen offset:1024 lds
    s_cmp_lt_u32 s46, s54
    ds_read_b128 v[100:103], v251 offset:160
    ds_read_b128 v[96:99], v250 offset:160
    v_cvt_pk_bf16_f32 v24, v212, v213
    ds_read_b64 v[224:225], v254 offset:1968
    v_pk_mul_f32 v[210:211], v[212:213], v[210:211] neg_lo:[1,0] neg_hi:[1,0]
    buffer_load_dwordx4 v39, s[36:39], s66 offen offset:2048 lds
    s_waitcnt lgkmcnt(8)
    v_smfmac_f32_16x16x64_bf16 v[120:123], v[12:15], v[0:7], v175
    ds_read_b128 v[0:3], v250 offset:320
    ds_read_b128 v[216:219], v252 offset:240
    s_cselect_b32 s18, 98304, 0
    s_nop 2
    v_smfmac_f32_16x16x32_bf16 v[120:123], v[16:17], v[8:11], v175
    ds_read_b128 v[212:215], v251 offset:240
    v_cvt_pk_bf16_f32 v29, v210, v211
    ds_read_b128 v[12:15], v253 offset:2624
    v_smfmac_f32_16x16x64_bf16 v[124:127], v[58:61], v[46:53], v175
    s_waitcnt lgkmcnt(8)
    ds_read_b128 v[4:7], v251 offset:320
    ds_read_b128 v[208:211], v250 offset:240
    s_nop 2
    v_smfmac_f32_16x16x32_bf16 v[124:127], v[62:63], v[54:57], v175
    s_waitcnt lgkmcnt(7)
    ds_read_b128 v[220:223], v253 offset:1968
    v_mfma_f32_32x32x8_bf16 v[152:167], v[242:243], v[242:243], 0
    ds_read_b128 v[54:57], v252 offset:400
    ds_read_b128 v[58:61], v253 offset:3280
    buffer_load_dwordx3 v[168:170], v179, s[16:19], 0 offen nt
    ds_read_b64 v[16:17], v254 offset:2624
    v_smfmac_f32_16x16x64_bf16 v[128:131], v[108:111], v[96:103], v175
    ds_read_b128 v[50:53], v251 offset:400
    ds_read_b128 v[8:11], v252 offset:320
    ds_read_b128 v[96:99], v250 offset:480
    buffer_load_dwordx3 v[172:174], v183, s[16:19], 0 offen offset:0 nt
    v_pk_mul_f32 v[248:249], v[120:121], v[120:121]
    v_pk_add_f32 v[246:247], v[120:121], v[122:123]
    ds_read_b128 v[100:103], v251 offset:480
    ds_read_b128 v[108:111], v253 offset:3936
    v_pk_fma_f32 v[248:249], v[122:123], v[122:123], v[248:249]
    v_pk_add_f32 v[246:247], v[246:247], v[124:125]
    buffer_load_dwordx3 v[176:178], v183, s[16:19], 0 offen offset:768 nt
    ds_read_b64 v[62:63], v254 offset:3280
    ds_read_b128 v[46:49], v250 offset:400
    v_pk_fma_f32 v[248:249], v[124:125], v[124:125], v[248:249]
    v_pk_add_f32 v[246:247], v[246:247], v[126:127]
    v_smfmac_f32_16x16x32_bf16 v[128:131], v[112:113], v[104:107], v175
    s_waitcnt lgkmcnt(10)
    buffer_load_dwordx3 v[180:182], v183, s[16:19], 0 offen offset:1536 nt
    ds_read_b128 v[104:107], v252 offset:480
    v_smfmac_f32_16x16x64_bf16 v[132:135], v[220:223], v[208:215], v175
    ds_read_b128 v[208:211], v250 offset:560
    ds_read_b64 v[112:113], v254 offset:3936
    v_smfmac_f32_16x16x64_bf16 v[136:139], v[12:15], v[0:7], v175
    ds_read_b128 v[220:223], v253 offset:4592
    ds_read_b128 v[212:215], v251 offset:560
    v_pk_add_f32 v[246:247], v[246:247], v[128:129]
    v_pk_fma_f32 v[248:249], v[126:127], v[126:127], v[248:249]
    v_pk_fma_f32 v[248:249], v[128:129], v[128:129], v[248:249]
    v_pk_fma_f32 v[248:249], v[130:131], v[130:131], v[248:249]
    v_pk_add_f32 v[246:247], v[246:247], v[130:131]
    v_smfmac_f32_16x16x32_bf16 v[132:135], v[224:225], v[216:219], v175
    s_waitcnt lgkmcnt(10)
    buffer_load_dwordx3 v[184:186], v183, s[16:19], 0 offen offset:2304 nt
    ds_read_b128 v[12:15], v253 offset:5248
    ds_read_b128 v[0:3], v250 offset:640
    ds_read_b128 v[4:7], v251 offset:640
    s_add_u32 s16, s16, s13
    s_addc_u32 s17, s17, s1
    ds_read_b128 v[216:219], v252 offset:560
    v_pk_fma_f32 v[248:249], v[132:133], v[132:133], v[248:249]
    v_pk_fma_f32 v[248:249], v[134:135], v[134:135], v[248:249]
    v_pk_add_f32 v[246:247], v[246:247], v[132:133]
    v_smfmac_f32_16x16x32_bf16 v[136:139], v[16:17], v[8:11], v175
    s_waitcnt lgkmcnt(9)
    ds_read_b64 v[16:17], v254 offset:5248
    s_add_u32 s46, s46, 2
    v_smfmac_f32_16x16x64_bf16 v[140:143], v[58:61], v[46:53], v175
    ds_read_b64 v[224:225], v254 offset:4592
    ds_read_b128 v[58:61], v253 offset:5904
    s_cmp_lt_u32 s46, s54
    s_cselect_b32 s18, 98304, 0
    ds_read_b128 v[8:11], v252 offset:640
    v_pk_fma_f32 v[248:249], v[136:137], v[136:137], v[248:249]
    v_pk_add_f32 v[246:247], v[246:247], v[134:135]
    v_pk_fma_f32 v[248:249], v[138:139], v[138:139], v[248:249]
    v_pk_add_f32 v[246:247], v[246:247], v[136:137]
    v_smfmac_f32_16x16x32_bf16 v[140:143], v[62:63], v[54:57], v175
    s_waitcnt lgkmcnt(8)
    buffer_load_dwordx3 v[188:190], v179, s[16:19], 0 offen nt
    ds_read_b128 v[46:49], v250 offset:720
    v_smfmac_f32_16x16x64_bf16 v[148:151], v[220:223], v[208:215], v175
    ds_read_b128 v[50:53], v251 offset:720
    ds_read_b128 v[212:215], v251 offset:880
    v_smfmac_f32_16x16x64_bf16 v[144:147], v[108:111], v[96:103], v175
    ds_read_b128 v[208:211], v250 offset:880
    ds_read_b128 v[220:223], v253 offset:7216
    ds_read_b128 v[100:103], v251 offset:800
    v_pk_add_f32 v[246:247], v[246:247], v[138:139]
    v_pk_fma_f32 v[248:249], v[140:141], v[140:141], v[248:249]
    v_pk_add_f32 v[246:247], v[246:247], v[140:141]
    v_pk_add_f32 v[246:247], v[246:247], v[142:143]
    v_pk_fma_f32 v[248:249], v[142:143], v[142:143], v[248:249]
    v_smfmac_f32_16x16x32_bf16 v[144:147], v[112:113], v[104:107], v175
    s_waitcnt lgkmcnt(8)
    ds_read_b128 v[96:99], v250 offset:800
    buffer_load_dwordx3 v[192:194], v183, s[16:19], 0 offen offset:0 nt
    v_smfmac_f32_16x16x32_bf16 v[148:151], v[224:225], v[216:219], v175
    ds_read_b128 v[108:111], v253 offset:6560
    ds_read_b128 v[54:57], v252 offset:720
    buffer_load_dwordx3 v[196:198], v183, s[16:19], 0 offen offset:768 nt
    v_smfmac_f32_16x16x64_bf16 v[152:155], v[12:15], v[0:7], v175
    s_waitcnt lgkmcnt(9)
    ds_read_b64 v[62:63], v254 offset:5904
    ds_read_b64 v[112:113], v254 offset:6560
    ds_read_b128 v[104:107], v252 offset:800
    v_pk_add_f32 v[246:247], v[246:247], v[144:145]
    v_pk_fma_f32 v[248:249], v[144:145], v[144:145], v[248:249]
    v_pk_fma_f32 v[248:249], v[146:147], v[146:147], v[248:249]
    v_pk_add_f32 v[246:247], v[246:247], v[146:147]
    v_pk_add_f32 v[246:247], v[246:247], v[148:149]
    v_pk_add_f32 v[246:247], v[246:247], v[150:151]
    v_smfmac_f32_16x16x32_bf16 v[152:155], v[16:17], v[8:11], v175
    s_waitcnt lgkmcnt(10)
    ds_read_b128 v[216:219], v252 offset:880
    ds_read_b64 v[224:225], v254 offset:7216
    v_smfmac_f32_16x16x64_bf16 v[156:159], v[58:61], v[46:53], v175
    s_waitcnt lgkmcnt(9)
    ds_write2st64_b32 v41, v27, v28 offset0:8 offset1:12
    v_pk_fma_f32 v[248:249], v[148:149], v[148:149], v[248:249]
    v_pk_fma_f32 v[248:249], v[150:151], v[150:151], v[248:249]
    v_pk_fma_f32 v[248:249], v[152:153], v[152:153], v[248:249]
    v_pk_fma_f32 v[248:249], v[154:155], v[154:155], v[248:249]
    v_pk_add_f32 v[246:247], v[246:247], v[152:153]
    v_pk_add_f32 v[246:247], v[246:247], v[154:155]
    v_smfmac_f32_16x16x64_bf16 v[164:167], v[220:223], v[208:215], v175
    s_waitcnt lgkmcnt(7)
    v_smfmac_f32_16x16x64_bf16 v[160:163], v[108:111], v[96:103], v175
    s_waitcnt lgkmcnt(5)
    ds_write2st64_b32 v40, v20, v21 offset0:0 offset1:4
    v_smfmac_f32_16x16x32_bf16 v[156:159], v[62:63], v[54:57], v175
    s_waitcnt lgkmcnt(4)
    s_nop 1
    v_smfmac_f32_16x16x32_bf16 v[160:163], v[112:113], v[104:107], v175
    s_waitcnt lgkmcnt(2)
    ds_write_b32 v41, v29 offset:4096
    v_smfmac_f32_16x16x32_bf16 v[164:167], v[224:225], v[216:219], v175
    s_waitcnt lgkmcnt(0)
    ds_write2st64_b32 v40, v22, v23 offset0:8 offset1:12
    v_pk_add_f32 v[246:247], v[246:247], v[156:157]
    v_pk_fma_f32 v[248:249], v[156:157], v[156:157], v[248:249]
    v_pk_fma_f32 v[248:249], v[158:159], v[158:159], v[248:249]
    v_pk_add_f32 v[246:247], v[246:247], v[158:159]
    v_pk_add_f32 v[246:247], v[246:247], v[160:161]
    v_pk_fma_f32 v[248:249], v[160:161], v[160:161], v[248:249]
    v_pk_fma_f32 v[248:249], v[162:163], v[162:163], v[248:249]
    v_pk_add_f32 v[246:247], v[246:247], v[162:163]
    v_pk_add_f32 v[246:247], v[246:247], v[164:165]
    v_pk_fma_f32 v[248:249], v[164:165], v[164:165], v[248:249]
    v_pk_add_f32 v[246:247], v[246:247], v[166:167]
    v_pk_fma_f32 v[248:249], v[166:167], v[166:167], v[248:249]
    ds_write_b128 v171, v[246:249]
    ds_write2st64_b32 v41, v25, v26 offset0:0 offset1:4
    v_mul_hi_u32_u24 v224, 39147, v250
    ds_write_b32 v40, v24 offset:4096
    s_waitcnt vmcnt(8) lgkmcnt(2)
    s_barrier
    ds_read_b128 v[212:215], v203 offset:62464
    ds_read_b128 v[208:211], v203 offset:61440
    ds_read_b128 v[220:223], v203 offset:64512
    ds_read_b128 v[216:219], v203 offset:63488
    ds_read_b64_tr_b16 v[88:89], v35 offset:3200
    buffer_load_dwordx3 v[200:202], v183, s[16:19], 0 offen offset:1536 nt
    v_add_u32 v250, 31488, v250
    v_add_u32_sdwa v171, s8, v207 dst_sel:DWORD dst_unused:UNUSED_PAD src0_sel:DWORD src1_sel:WORD_1
    ds_read_b64_tr_b16 v[86:87], v35 offset:4680
    v_mad_i32_i24 v250, v224, s99, v250
    v_mul_hi_u32_u24 v224, 39147, v251
    v_add_u32 v251, 31488, v251
    ds_read_b64_tr_b16 a[244:245], v35 offset:8
    buffer_load_dwordx3 v[204:206], v183, s[16:19], 0 offen offset:2304 nt
    ds_read_b64_tr_b16 v[234:235], v35 offset:3072
    ds_read_b64_tr_b16 a[250:251], v35 offset:1600
    ds_read_b64_tr_b16 v[90:91], v35 offset:4736
    s_add_u32 s16, s16, s14
    ds_read_b64_tr_b16 v[236:237], v35 offset:4608
    ds_read_b64_tr_b16 v[228:229], v35 offset:1664
    s_addc_u32 s17, s17, s1
    ds_read_b64_tr_b16 v[232:233], v35 offset:1672
    ds_read_b64_tr_b16 v[80:81], v35 offset:3136
    s_waitcnt lgkmcnt(12)
    v_pk_add_f32 v[210:211], v[210:211], v[214:215]
    v_pk_add_f32 v[208:209], v[208:209], v[212:213]
    ds_read_b64_tr_b16 a[240:241], v35 offset:0
    ds_read_b64_tr_b16 a[252:253], v35 offset:72
    ds_read_b64_tr_b16 v[230:231], v35 offset:136
    ds_read_b64_tr_b16 a[246:247], v35 offset:1544
    ds_read_b64_tr_b16 v[82:83], v35 offset:4672
    s_waitcnt lgkmcnt(15)
    v_pk_add_f32 v[218:219], v[218:219], v[222:223]
    v_pk_add_f32 v[216:217], v[216:217], v[220:221]
    v_pk_add_f32 v[248:249], v[210:211], v[218:219]
    ds_read_b64_tr_b16 v[84:85], v35 offset:3144
    ds_read_b64_tr_b16 a[242:243], v35 offset:1536
    ds_read_b64_tr_b16 v[92:93], v35 offset:3208
    ds_read_b64_tr_b16 v[226:227], v35 offset:128
    v_pk_add_f32 v[246:247], v[208:209], v[216:217]
    v_pk_mul_f32 v[246:247], s[52:53], v[246:247] op_sel_hi:[0,1]
    v_pk_mul_f32 v[248:249], s[52:53], v[248:249] op_sel_hi:[0,1]
    v_pk_fma_f32 v[248:249], v[246:247], v[246:247], v[248:249] neg_lo:[1,0,0] neg_hi:[1,0,0]
    v_max_f32_e64 v248, 0, v248
    ds_read_b64_tr_b16 v[240:241], v35 offset:4616
    ds_read_b64_tr_b16 a[254:255], v35 offset:1608
    ds_read_b64_tr_b16 a[248:249], v35 offset:64
    ds_read_b64_tr_b16 v[94:95], v35 offset:4744
    ds_read_b64_tr_b16 v[238:239], v35 offset:3080
    v_add_f32_e64 v248, s51, v248
    v_max_f32_e64 v249, 0, v249
    v_add_f32_e64 v249, s51, v249
    v_rsq_f32_e64 v249, v249
    v_rsq_f32_e64 v248, v248
    v_mul_f32_e64 v249, s49, v249
    v_mul_f32_e64 v247, -v247, v249
    v_mul_f32_e64 v248, s49, v248
    v_mul_f32_e64 v246, -v246, v248
    v_pk_fma_f32 v[132:133], v[132:133], v[248:249], v[246:247]
    v_pk_fma_f32 v[138:139], v[138:139], v[248:249], v[246:247]
    v_pk_fma_f32 v[122:123], v[122:123], v[248:249], v[246:247]
    v_pk_fma_f32 v[124:125], v[124:125], v[248:249], v[246:247]
    v_pk_fma_f32 v[128:129], v[128:129], v[248:249], v[246:247]
    v_pk_fma_f32 v[126:127], v[126:127], v[248:249], v[246:247]
    v_pk_fma_f32 v[134:135], v[134:135], v[248:249], v[246:247]
    v_pk_fma_f32 v[120:121], v[120:121], v[248:249], v[246:247]
    v_pk_fma_f32 v[130:131], v[130:131], v[248:249], v[246:247]
    v_cvt_pk_bf16_f32 v120, v120, v122
    v_cvt_pk_bf16_f32 v122, v128, v130
    v_cvt_pk_bf16_f32 v128, v121, v123
    v_cvt_pk_bf16_f32 v123, v132, v134
    v_cvt_pk_bf16_f32 v121, v124, v126
    ds_write_b128 v171, v[120:123] offset:0
    v_pk_fma_f32 v[140:141], v[140:141], v[248:249], v[246:247]
    v_cvt_pk_bf16_f32 v130, v129, v131
    v_cvt_pk_bf16_f32 v131, v133, v135
    v_pk_fma_f32 v[136:137], v[136:137], v[248:249], v[246:247]
    v_cvt_pk_bf16_f32 v136, v136, v138
    v_cvt_pk_bf16_f32 v129, v125, v127
    v_pk_fma_f32 v[148:149], v[148:149], v[248:249], v[246:247]
    v_pk_fma_f32 v[146:147], v[146:147], v[248:249], v[246:247]
    ds_write_b128 v171, v[128:131] offset:512
    v_pk_fma_f32 v[150:151], v[150:151], v[248:249], v[246:247]
    v_pk_fma_f32 v[144:145], v[144:145], v[248:249], v[246:247]
    v_pk_fma_f32 v[142:143], v[142:143], v[248:249], v[246:247]
    v_cvt_pk_bf16_f32 v138, v144, v146
    v_cvt_pk_bf16_f32 v146, v145, v147
    v_cvt_pk_bf16_f32 v145, v141, v143
    v_cvt_pk_bf16_f32 v147, v149, v151
    v_cvt_pk_bf16_f32 v144, v137, v139
    ds_write_b128 v171, v[144:147] offset:2560
    v_pk_fma_f32 v[166:167], v[166:167], v[248:249], v[246:247]
    v_pk_fma_f32 v[152:153], v[152:153], v[248:249], v[246:247]
    v_cvt_pk_bf16_f32 v139, v148, v150
    v_cvt_pk_bf16_f32 v137, v140, v142
    v_pk_fma_f32 v[160:161], v[160:161], v[248:249], v[246:247]
    v_pk_fma_f32 v[162:163], v[162:163], v[248:249], v[246:247]
    v_pk_fma_f32 v[154:155], v[154:155], v[248:249], v[246:247]
    v_pk_fma_f32 v[158:159], v[158:159], v[248:249], v[246:247]
    s_add_u32 s46, s46, 6
    s_add_u32 s43, s43, s44
    ds_write_b128 v171, v[136:139] offset:2048
    v_pk_fma_f32 v[156:157], v[156:157], v[248:249], v[246:247]
    v_pk_fma_f32 v[164:165], v[164:165], v[248:249], v[246:247]
    v_cvt_pk_bf16_f32 v152, v152, v154
    v_cvt_pk_bf16_f32 v154, v160, v162
    v_cvt_pk_bf16_f32 v160, v153, v155
    v_cvt_pk_bf16_f32 v153, v156, v158
    v_cvt_pk_bf16_f32 v155, v164, v166
    ds_write_b128 v171, v[152:155] offset:4096
    v_cvt_pk_bf16_f32 v162, v161, v163
    v_mad_i32_i24 v251, v224, s99, v251
    v_cvt_pk_bf16_f32 v161, v157, v159
    v_cvt_pk_bf16_f32 v163, v165, v167
    v_mul_hi_u32_u24 v224, 39147, v252
    s_mov_b32 m0, 0
    v_add_u32 v252, 31488, v252
    ds_write_b128 v171, v[160:163] offset:4608
    v_mad_i32_i24 v252, v224, s99, v252
    s_waitcnt lgkmcnt(0)
    s_barrier
.p2align 3
    ds_read_b128 v[96:99], v255 offset:0
    v_add_u32_sdwa v224, s45, v207 dst_sel:DWORD dst_unused:UNUSED_PAD src0_sel:DWORD src1_sel:WORD_0
    ds_read_b128 v[100:103], v255 offset:8192
    ds_read_b128 v[104:107], v255 offset:16384
    s_waitcnt vmcnt(6)
    ds_write2_b32 v224, v178, v180 offset0:48 offset1:12
    s_cmp_ge_u32 s45, 109716
    s_waitcnt vmcnt(5)
    ds_write_b32 v224, v186 offset:224
    s_cselect_b32 s56, s99, 0
    v_xor_b32 v255, 288, v255
    ds_read_b128 v[116:119], v255 offset:16384
    ds_write2_b32 v224, v168, v169 offset0:0 offset1:20
    s_add_u32 s45, s45, s56
    ds_write2_b32 v224, v176, v177 offset0:8 offset1:28
    ds_write2_b32 v224, v173, v174 offset0:24 offset1:44
    s_waitcnt lgkmcnt(8)
    v_mfma_f32_16x16x32_bf16 v[48:51], a[0:3], v[96:99], 0
    s_waitcnt lgkmcnt(7)
    ds_write2_b32 v224, v170, v172 offset0:40 offset1:4
    v_mfma_f32_16x16x32_bf16 v[48:51], a[4:7], v[100:103], v[48:51]
    s_waitcnt lgkmcnt(7)
    s_add_u32 s45, s45, 31488
    ds_write2_b32 v224, v181, v182 offset0:32 offset1:52
    v_mfma_f32_16x16x32_bf16 v[48:51], a[8:11], v[104:107], v[48:51]
    s_cmp_ge_u32 s55, 109716
    ds_write2_b32 v224, v184, v185 offset0:16 offset1:36
    v_add_u32_sdwa v224, s55, v207 dst_sel:DWORD dst_unused:UNUSED_PAD src0_sel:DWORD src1_sel:WORD_0
    v_mfma_f32_16x16x32_bf16 v[52:55], a[20:23], v[104:107], 0
    s_waitcnt vmcnt(4)
    ds_write2_b32 v224, v188, v189 offset0:0 offset1:20
    v_add_u32_e64 v195, 1, v195
    v_mfma_f32_16x16x32_bf16 v[52:55], a[16:19], v[100:103], v[52:55]
    s_waitcnt vmcnt(2)
    ds_write2_b32 v224, v196, v197 offset0:8 offset1:28
    v_lshlrev_b32_sdwa v49, 1, v49 dst_sel:DWORD dst_unused:UNUSED_PAD src0_sel:DWORD src1_sel:WORD_1
    v_mfma_f32_16x16x32_bf16 v[52:55], a[12:15], v[96:99], v[52:55]
    s_waitcnt vmcnt(0)
    ds_write2_b32 v224, v204, v205 offset0:16 offset1:36
    v_lshlrev_b32_sdwa v50, 1, v50 dst_sel:DWORD dst_unused:UNUSED_PAD src0_sel:DWORD src1_sel:WORD_1
    v_mfma_f32_16x16x32_bf16 v[56:59], a[24:27], v[96:99], 0
    ds_write2_b32 v224, v190, v192 offset0:40 offset1:4
    v_mfma_f32_16x16x32_bf16 v[56:59], a[28:31], v[100:103], v[56:59]
    ds_write2_b32 v224, v193, v194 offset0:24 offset1:44
    v_mfma_f32_16x16x32_bf16 v[56:59], a[32:35], v[104:107], v[56:59]
    s_cselect_b32 s56, s99, 0
    ds_read_u16 v50, v50 offset:0
    v_mfma_f32_16x16x32_bf16 v[60:63], a[44:47], v[104:107], 0
    s_nop 0
    ds_write2_b32 v224, v201, v202 offset0:32 offset1:52
    v_lshlrev_b32_sdwa v51, 1, v51 dst_sel:DWORD dst_unused:UNUSED_PAD src0_sel:DWORD src1_sel:WORD_1
    v_mfma_f32_16x16x32_bf16 v[60:63], a[40:43], v[100:103], v[60:63]
    ds_write2_b32 v224, v198, v200 offset0:48 offset1:12
    v_lshlrev_b32_sdwa v54, 1, v54 dst_sel:DWORD dst_unused:UNUSED_PAD src0_sel:DWORD src1_sel:WORD_1
    v_mfma_f32_16x16x32_bf16 v[60:63], a[36:39], v[96:99], v[60:63]
    s_add_u32 s55, s55, s56
    ds_read_u16_d16_hi v49, v49 offset:0
    ds_write_b32 v224, v206 offset:224
    v_lshlrev_b32_sdwa v53, 1, v53 dst_sel:DWORD dst_unused:UNUSED_PAD src0_sel:DWORD src1_sel:WORD_1
    v_mfma_f32_16x16x32_bf16 v[64:67], a[48:51], v[96:99], 0
    s_nop 0
    ds_write_b32 v191, v195
    v_mfma_f32_16x16x32_bf16 v[64:67], a[52:55], v[100:103], v[64:67]
    ds_read_u16_d16_hi v53, v53 offset:0
    v_lshlrev_b32_sdwa v60, 1, v60 dst_sel:DWORD dst_unused:UNUSED_PAD src0_sel:DWORD src1_sel:WORD_1
    v_mfma_f32_16x16x32_bf16 v[64:67], a[56:59], v[104:107], v[64:67]
    s_add_u32 s55, s55, 31488
    ds_read_b128 v[220:223], v253 offset:0
    v_mov_b64_e64 v[224:225], 0
    v_mfma_f32_16x16x32_bf16 v[68:71], a[68:71], v[104:107], 0
    ds_read_u16_d16_hi v51, v51 offset:0
    v_lshlrev_b32_sdwa v48, 1, v48 dst_sel:DWORD dst_unused:UNUSED_PAD src0_sel:DWORD src1_sel:WORD_1
    v_lshlrev_b32_sdwa v55, 1, v55 dst_sel:DWORD dst_unused:UNUSED_PAD src0_sel:DWORD src1_sel:WORD_1
    v_lshlrev_b32_sdwa v61, 1, v61 dst_sel:DWORD dst_unused:UNUSED_PAD src0_sel:DWORD src1_sel:WORD_1
    v_mfma_f32_16x16x32_bf16 v[68:71], a[64:67], v[100:103], v[68:71]
    ds_read_u16 v48, v48 offset:0
    s_cmp_lt_u32 s46, s54
    v_lshlrev_b32_sdwa v57, 1, v57 dst_sel:DWORD dst_unused:UNUSED_PAD src0_sel:DWORD src1_sel:WORD_1
    ds_read_u16 v54, v54 offset:0
    v_lshlrev_b32_sdwa v56, 1, v56 dst_sel:DWORD dst_unused:UNUSED_PAD src0_sel:DWORD src1_sel:WORD_1
    v_lshlrev_b32_sdwa v52, 1, v52 dst_sel:DWORD dst_unused:UNUSED_PAD src0_sel:DWORD src1_sel:WORD_1
    v_mfma_f32_16x16x32_bf16 v[68:71], a[60:63], v[96:99], v[68:71]
    s_nop 0
    v_lshlrev_b32_sdwa v58, 1, v58 dst_sel:DWORD dst_unused:UNUSED_PAD src0_sel:DWORD src1_sel:WORD_1
    ds_read_u16_d16_hi v55, v55 offset:0
    ds_read_u16 v52, v52 offset:0
    v_mfma_f32_32x32x8_bf16 v[136:151], v[224:225], v[224:225], 0
    v_lshlrev_b32_sdwa v63, 1, v63 dst_sel:DWORD dst_unused:UNUSED_PAD src0_sel:DWORD src1_sel:WORD_1
    s_cselect_b32 s18, 98304, 0
    v_lshlrev_b32_sdwa v66, 1, v66 dst_sel:DWORD dst_unused:UNUSED_PAD src0_sel:DWORD src1_sel:WORD_1
    s_nop 0
    v_cvt_pk_f16_f32 v242, v70, v71
    v_mfma_f32_32x32x8_bf16 v[120:135], v[224:225], v[224:225], 0
    ds_read_u16_d16_hi v61, v61 offset:0
    ds_read_u16 v60, v60 offset:0
    v_lshlrev_b32_sdwa v59, 1, v59 dst_sel:DWORD dst_unused:UNUSED_PAD src0_sel:DWORD src1_sel:WORD_1
    v_mfma_f32_32x32x8_bf16 v[152:167], v[224:225], v[224:225], 0
    buffer_load_dwordx3 v[168:170], v179, s[16:19], 0 offen nt
    v_lshlrev_b32_sdwa v62, 1, v62 dst_sel:DWORD dst_unused:UNUSED_PAD src0_sel:DWORD src1_sel:WORD_1
    v_lshlrev_b32_sdwa v67, 1, v67 dst_sel:DWORD dst_unused:UNUSED_PAD src0_sel:DWORD src1_sel:WORD_1
    ds_read_addtid_b32 v199 offset:5120
    ds_read_u16_d16_hi v57, v57 offset:0
    ds_read_u16 v58, v58 offset:0
    v_pk_fma_f16 v243, v242, v242, s48
    v_mfma_f32_16x16x32_bf16 v[72:75], a[72:75], v[96:99], 0
    s_nop 0
    v_lshlrev_b32_sdwa v69, 1, v69 dst_sel:DWORD dst_unused:UNUSED_PAD src0_sel:DWORD src1_sel:WORD_1
    v_lshlrev_b32_sdwa v65, 1, v65 dst_sel:DWORD dst_unused:UNUSED_PAD src0_sel:DWORD src1_sel:WORD_1
    v_mfma_f32_16x16x32_bf16 v[72:75], a[76:79], v[100:103], v[72:75]
    buffer_load_dwordx3 v[172:174], v183, s[16:19], 0 offen offset:0 nt
    v_mfma_f32_16x16x32_bf16 v[72:75], a[80:83], v[104:107], v[72:75]
    ds_read_u16_d16_hi v59, v59 offset:0
    ds_read_u16_d16_hi v69, v69 offset:0
    v_lshlrev_b32_sdwa v68, 1, v68 dst_sel:DWORD dst_unused:UNUSED_PAD src0_sel:DWORD src1_sel:WORD_1
    v_pk_mul_f16 v243, v242, v243 neg_lo:[1,0] neg_hi:[1,0]
    v_mfma_f32_16x16x32_bf16 v[76:79], a[92:95], v[104:107], 0
    s_waitcnt lgkmcnt(7)
    ds_read_u16 v56, v56 offset:0
    v_or_b32 v51, v50, v51
    v_lshlrev_b32_sdwa v64, 1, v64 dst_sel:DWORD dst_unused:UNUSED_PAD src0_sel:DWORD src1_sel:WORD_1
    v_or_b32 v52, v52, v53
    v_or_b32 v50, v48, v49
    v_or_b32_e64 v53, v54, v55
    v_mfma_f32_16x16x32_bf16 v[76:79], a[88:91], v[100:103], v[76:79]
    ds_read_u16 v62, v62 offset:0
    v_mfma_f32_16x16x32_bf16 v[76:79], a[84:87], v[96:99], v[76:79]
    s_waitcnt lgkmcnt(6)
    ds_read_b64 v[224:225], v254 offset:0
    v_cmp_lt_u32 vcc, v199, v195
    v_mfma_f32_16x16x32_bf16 v[0:3], a[144:147], v[50:53], 0
    ds_read_u16_d16_hi v63, v63 offset:0
    v_mfma_f32_16x16x32_bf16 v[4:7], a[148:151], v[50:53], 0
    v_lshlrev_b32_sdwa v74, 1, v74 dst_sel:DWORD dst_unused:UNUSED_PAD src0_sel:DWORD src1_sel:WORD_1
    v_mfma_f32_16x16x32_bf16 v[8:11], a[152:155], v[50:53], 0
    s_cbranch_vccnz L_retry4
L_back4:
    ds_read_b128 v[216:219], v252 offset:0
    ds_read_b128 v[212:215], v251 offset:0
    ds_read_b128 v[208:211], v250 offset:0
    v_mfma_f32_16x16x32_bf16 v[12:15], a[156:159], v[50:53], 0
    s_nop 0
    v_exp_f16_sdwa v243, v243 dst_sel:WORD_0 dst_unused:UNUSED_PRESERVE src0_sel:WORD_0
    v_lshlrev_b32_sdwa v77, 1, v77 dst_sel:DWORD dst_unused:UNUSED_PAD src0_sel:DWORD src1_sel:WORD_1
    v_mfma_f32_16x16x32_bf16 v[16:19], a[160:163], v[50:53], 0
    ds_read_u16_d16_hi v65, v65 offset:0
    buffer_load_dwordx3 v[176:178], v183, s[16:19], 0 offen offset:768 nt
    v_mfma_f32_16x16x32_bf16 v[20:23], a[164:167], v[50:53], 0
    v_exp_f16_sdwa v243, v243 dst_sel:WORD_1 dst_unused:UNUSED_PRESERVE src0_sel:WORD_1
    v_mfma_f32_16x16x32_bf16 v[48:51], a[96:99], v[96:99], 0
    ds_read_u16 v66, v66 offset:0
    ds_read_u16_d16_hi v67, v67 offset:0
    v_mfma_f32_16x16x32_bf16 v[48:51], a[100:103], v[100:103], v[48:51]
    v_mfma_f32_16x16x32_bf16 v[48:51], a[104:107], v[104:107], v[48:51]
    v_mfma_f32_16x16x32_bf16 v[52:55], a[116:119], v[104:107], 0
    ds_read_u16 v68, v68 offset:0
    v_pk_fma_f16 v243, v243, s50, s50
    ds_read_u16_d16_hi v77, v77 offset:0
    v_mfma_f32_16x16x32_bf16 v[52:55], a[112:115], v[100:103], v[52:55]
    v_or_b32_e64 v60, v60, v61
    v_rcp_f16_sdwa v243, v243 dst_sel:WORD_0 dst_unused:UNUSED_PRESERVE src0_sel:WORD_0
    v_mfma_f32_16x16x32_bf16 v[52:55], a[108:111], v[96:99], v[52:55]
    s_waitcnt lgkmcnt(5)
    ds_read_b128 v[108:111], v255 offset:0
    v_or_b32 v59, v58, v59
    v_smfmac_f32_16x16x64_bf16 v[120:123], v[220:223], v[208:215], v175
    ds_read_b128 v[220:223], v253 offset:656
    v_or_b32_e64 v61, v62, v63
    ds_read_b128 v[208:211], v250 offset:80
    ds_read_b128 v[212:215], v251 offset:80
    buffer_load_dwordx3 v[180:182], v183, s[16:19], 0 offen offset:1536 nt
    v_lshlrev_b32_sdwa v76, 1, v76 dst_sel:DWORD dst_unused:UNUSED_PAD src0_sel:DWORD src1_sel:WORD_1
    v_or_b32_e64 v58, v56, v57
    v_lshlrev_b32_sdwa v78, 1, v78 dst_sel:DWORD dst_unused:UNUSED_PAD src0_sel:DWORD src1_sel:WORD_1
    v_smfmac_f32_16x16x32_bf16 v[120:123], v[224:225], v[216:219], v175
    ds_read_b128 v[112:115], v255 offset:8192
    ds_read_u16 v64, v64 offset:0
    v_lshlrev_b32_sdwa v75, 1, v75 dst_sel:DWORD dst_unused:UNUSED_PAD src0_sel:DWORD src1_sel:WORD_1
    v_lshlrev_b32_sdwa v51, 1, v51 dst_sel:DWORD dst_unused:UNUSED_PAD src0_sel:DWORD src1_sel:WORD_1
    v_mfma_f32_16x16x32_bf16 v[0:3], a[168:171], v[58:61], v[0:3]
    v_lshlrev_b32_sdwa v73, 1, v73 dst_sel:DWORD dst_unused:UNUSED_PAD src0_sel:DWORD src1_sel:WORD_1
    v_lshlrev_b32_sdwa v54, 1, v54 dst_sel:DWORD dst_unused:UNUSED_PAD src0_sel:DWORD src1_sel:WORD_1
    v_mfma_f32_16x16x32_bf16 v[4:7], a[172:175], v[58:61], v[4:7]
    ds_read_b128 v[216:219], v252 offset:80
    ds_read_u16 v74, v74 offset:0
    v_rcp_f16_sdwa v243, v243 dst_sel:WORD_1 dst_unused:UNUSED_PRESERVE src0_sel:WORD_1
    v_lshlrev_b32_sdwa v48, 1, v48 dst_sel:DWORD dst_unused:UNUSED_PAD src0_sel:DWORD src1_sel:WORD_1
    v_pk_mul_f32 v[248:249], v[120:121], v[120:121]
    v_mfma_f32_16x16x32_bf16 v[8:11], a[176:179], v[58:61], v[8:11]
    ds_read_u16_d16_hi v75, v75 offset:0
    ds_read_b64 v[224:225], v254 offset:656
    v_mfma_f32_16x16x32_bf16 v[12:15], a[180:183], v[58:61], v[12:15]
    v_fma_mix_f32 v71, v71, v243, 0 op_sel:[0,1,0] op_sel_hi:[0,1,0]
    v_add_u32_e64 v195, 1, v195
    v_mfma_f32_16x16x32_bf16 v[16:19], a[184:187], v[58:61], v[16:19]
    ds_read_u16 v76, v76 offset:0
    v_fma_mix_f32 v70, v70, v243, 0 op_sel:[0,0,0] op_sel_hi:[0,1,0]
    v_mfma_f32_16x16x32_bf16 v[20:23], a[188:191], v[58:61], v[20:23]
    s_waitcnt lgkmcnt(7)
    v_or_b32 v68, v68, v69
    v_smfmac_f32_16x16x64_bf16 v[124:127], v[220:223], v[208:215], v175
    ds_read_u16_d16_hi v73, v73 offset:0
    v_lshlrev_b32_sdwa v79, 1, v79 dst_sel:DWORD dst_unused:UNUSED_PAD src0_sel:DWORD src1_sel:WORD_1
    v_lshlrev_b32_sdwa v53, 1, v53 dst_sel:DWORD dst_unused:UNUSED_PAD src0_sel:DWORD src1_sel:WORD_1
    v_mfma_f32_16x16x32_bf16 v[56:59], a[120:123], v[96:99], 0
    ds_read_b128 v[208:211], v250 offset:160
    v_lshlrev_b32_sdwa v72, 1, v72 dst_sel:DWORD dst_unused:UNUSED_PAD src0_sel:DWORD src1_sel:WORD_1
    v_mfma_f32_16x16x32_bf16 v[56:59], a[124:127], v[100:103], v[56:59]
    ds_read_b128 v[212:215], v251 offset:160
    buffer_load_dwordx3 v[184:186], v183, s[16:19], 0 offen offset:2304 nt
    v_mfma_f32_16x16x32_bf16 v[56:59], a[128:131], v[104:107], v[56:59]
    ds_read_b128 v[220:223], v253 offset:1312
    v_or_b32_e64 v67, v66, v67
    v_mfma_f32_16x16x32_bf16 v[60:63], a[140:143], v[104:107], 0
    s_add_u32 s16, s16, s13
    ds_read_u16_d16_hi v79, v79 offset:0
    ds_read_u16 v78, v78 offset:0
    v_mfma_f32_16x16x32_bf16 v[60:63], a[136:139], v[100:103], v[60:63]
    v_mfma_f32_16x16x32_bf16 v[60:63], a[132:135], v[96:99], v[60:63]
    s_waitcnt lgkmcnt(7)
    v_cvt_pk_bf16_f32 v69, v70, v71
    v_smfmac_f32_16x16x32_bf16 v[124:127], v[224:225], v[216:219], v175
    ds_read_b64 v[224:225], v254 offset:1312
    ds_read_b128 v[216:219], v252 offset:160
    ds_read_u16 v54, v54 offset:0
    v_lshlrev_b32_sdwa v55, 1, v55 dst_sel:DWORD dst_unused:UNUSED_PAD src0_sel:DWORD src1_sel:WORD_1
    v_add_u32 v171, s96, v203
    v_or_b32 v66, v64, v65
    v_pk_add_f32 v[246:247], v[120:121], v[122:123]
    v_pk_fma_f32 v[248:249], v[122:123], v[122:123], v[248:249]
    v_mfma_f32_16x16x32_bf16 v[0:3], a[192:195], v[66:69], v[0:3]
    ds_read_u16_d16_hi v55, v55 offset:0
    v_lshlrev_b32_sdwa v59, 1, v59 dst_sel:DWORD dst_unused:UNUSED_PAD src0_sel:DWORD src1_sel:WORD_1
    v_mfma_f32_16x16x32_bf16 v[4:7], a[196:199], v[66:69], v[4:7]
    s_addc_u32 s17, s17, s1
    ds_read_u16 v72, v72 offset:0
    v_lshlrev_b32_sdwa v57, 1, v57 dst_sel:DWORD dst_unused:UNUSED_PAD src0_sel:DWORD src1_sel:WORD_1
    v_mfma_f32_16x16x32_bf16 v[8:11], a[200:203], v[66:69], v[8:11]
    s_add_u32 s46, s46, 2
    ds_read_u16_d16_hi v59, v59 offset:0
    v_cvt_pk_f16_f32 v242, v62, v63
    v_mfma_f32_16x16x32_bf16 v[12:15], a[204:207], v[66:69], v[12:15]
    s_waitcnt lgkmcnt(8)
    v_lshlrev_b32_sdwa v52, 1, v52 dst_sel:DWORD dst_unused:UNUSED_PAD src0_sel:DWORD src1_sel:WORD_1
    v_or_b32 v75, v74, v75
    v_smfmac_f32_16x16x64_bf16 v[128:131], v[220:223], v[208:215], v175
    ds_read_b128 v[220:223], v253 offset:1968
    ds_read_b128 v[212:215], v251 offset:240
    v_mfma_f32_16x16x32_bf16 v[16:19], a[208:211], v[66:69], v[16:19]
    v_lshlrev_b32_sdwa v58, 1, v58 dst_sel:DWORD dst_unused:UNUSED_PAD src0_sel:DWORD src1_sel:WORD_1
    v_or_b32 v76, v76, v77
    s_cmp_lt_u32 s46, s54
    ds_read_b128 v[208:211], v250 offset:240
    v_pk_add_f32 v[246:247], v[246:247], v[124:125]
    v_pk_fma_f32 v[248:249], v[124:125], v[124:125], v[248:249]
    v_mfma_f32_16x16x32_bf16 v[20:23], a[212:215], v[66:69], v[20:23]
    s_waitcnt lgkmcnt(7)
    ds_read_u16 v52, v52 offset:0
    v_lshlrev_b32_sdwa v56, 1, v56 dst_sel:DWORD dst_unused:UNUSED_PAD src0_sel:DWORD src1_sel:WORD_1
    v_pk_fma_f16 v243, v242, v242, s48
    v_smfmac_f32_16x16x32_bf16 v[128:131], v[224:225], v[216:219], v175
    s_nop 0
    ds_read_b64 v[224:225], v254 offset:1968
    ds_read_b128 v[216:219], v252 offset:240
    v_lshlrev_b32_sdwa v49, 1, v49 dst_sel:DWORD dst_unused:UNUSED_PAD src0_sel:DWORD src1_sel:WORD_1
    v_mfma_f32_16x16x32_bf16 v[64:67], a[0:3], v[108:111], 0
    ds_read_u16_d16_hi v51, v51 offset:0
    v_pk_mul_f16 v243, v242, v243 neg_lo:[1,0] neg_hi:[1,0]
    v_mfma_f32_16x16x32_bf16 v[64:67], a[4:7], v[112:115], v[64:67]
    v_or_b32_e64 v77, v78, v79
    v_mfma_f32_16x16x32_bf16 v[64:67], a[8:11], v[116:119], v[64:67]
    s_waitcnt lgkmcnt(8)
    ds_read_u16_d16_hi v57, v57 offset:0
    v_or_b32 v74, v72, v73
    s_cselect_b32 s18, 98304, 0
    v_lshlrev_b32_sdwa v50, 1, v50 dst_sel:DWORD dst_unused:UNUSED_PAD src0_sel:DWORD src1_sel:WORD_1
    v_pk_add_f32 v[246:247], v[246:247], v[126:127]
    v_pk_add_f32 v[246:247], v[246:247], v[128:129]
    v_mfma_f32_16x16x32_bf16 v[68:71], a[20:23], v[116:119], 0
    ds_read_u16_d16_hi v53, v53 offset:0
    v_lshlrev_b32_sdwa v61, 1, v61 dst_sel:DWORD dst_unused:UNUSED_PAD src0_sel:DWORD src1_sel:WORD_1
    v_mfma_f32_16x16x32_bf16 v[68:71], a[16:19], v[112:115], v[68:71]
    buffer_load_dwordx3 v[192:194], v183, s[16:19], 0 offen offset:0 nt
    ds_read_u16 v58, v58 offset:0
    v_mfma_f32_16x16x32_bf16 v[68:71], a[12:15], v[108:111], v[68:71]
    s_waitcnt lgkmcnt(7)
    v_exp_f16_sdwa v243, v243 dst_sel:WORD_0 dst_unused:UNUSED_PRESERVE src0_sel:WORD_0
    v_smfmac_f32_16x16x64_bf16 v[132:135], v[220:223], v[208:215], v175
    s_nop 0
    ds_read_u16 v50, v50 offset:0
    v_lshlrev_b32_sdwa v64, 1, v64 dst_sel:DWORD dst_unused:UNUSED_PAD src0_sel:DWORD src1_sel:WORD_1
    v_mfma_f32_16x16x32_bf16 v[0:3], a[216:219], v[74:77], v[0:3]
    ds_read_b128 v[212:215], v251 offset:320
    buffer_load_dwordx3 v[188:190], v179, s[16:19], 0 offen nt
    v_mfma_f32_16x16x32_bf16 v[4:7], a[220:223], v[74:77], v[4:7]
    ds_read_b128 v[208:211], v250 offset:320
    ds_read_b128 v[220:223], v253 offset:2624
    v_mfma_f32_16x16x32_bf16 v[8:11], a[224:227], v[74:77], v[8:11]
    v_exp_f16_sdwa v243, v243 dst_sel:WORD_1 dst_unused:UNUSED_PRESERVE src0_sel:WORD_1
    v_mfma_f32_16x16x32_bf16 v[12:15], a[228:231], v[74:77], v[12:15]
    ds_read_u16 v48, v48 offset:0
    v_lshlrev_b32_sdwa v67, 1, v67 dst_sel:DWORD dst_unused:UNUSED_PAD src0_sel:DWORD src1_sel:WORD_1
    v_mfma_f32_16x16x32_bf16 v[16:19], a[232:235], v[74:77], v[16:19]
    ds_read_u16_d16_hi v49, v49 offset:0
    v_lshlrev_b32_sdwa v60, 1, v60 dst_sel:DWORD dst_unused:UNUSED_PAD src0_sel:DWORD src1_sel:WORD_1
    v_mfma_f32_16x16x32_bf16 v[20:23], a[236:239], v[74:77], v[20:23]
    s_waitcnt lgkmcnt(10)
    ds_read_u16_d16_hi v61, v61 offset:0
    v_lshlrev_b32_sdwa v69, 1, v69 dst_sel:DWORD dst_unused:UNUSED_PAD src0_sel:DWORD src1_sel:WORD_1
    v_pk_fma_f16 v243, v243, s50, s50
    v_smfmac_f32_16x16x32_bf16 v[132:135], v[224:225], v[216:219], v175
    s_nop 0
    ds_read_b128 v[216:219], v252 offset:320
    v_lshlrev_b32_sdwa v71, 1, v71 dst_sel:DWORD dst_unused:UNUSED_PAD src0_sel:DWORD src1_sel:WORD_1
    v_rcp_f16_sdwa v243, v243 dst_sel:WORD_0 dst_unused:UNUSED_PRESERVE src0_sel:WORD_0
    ds_read_b64 v[224:225], v254 offset:2624
    ds_read_u16 v60, v60 offset:0
    v_pk_fma_f32 v[248:249], v[126:127], v[126:127], v[248:249]
    v_pk_fma_f32 v[248:249], v[128:129], v[128:129], v[248:249]
    v_pk_fma_f32 v[248:249], v[130:131], v[130:131], v[248:249]
    v_pk_add_f32 v[246:247], v[246:247], v[130:131]
    v_mfma_f32_16x16x32_bf16 v[72:75], a[24:27], v[108:111], 0
    v_rcp_f16_sdwa v243, v243 dst_sel:WORD_1 dst_unused:UNUSED_PRESERVE src0_sel:WORD_1
    v_lshlrev_b32_sdwa v66, 1, v66 dst_sel:DWORD dst_unused:UNUSED_PAD src0_sel:DWORD src1_sel:WORD_1
    v_mfma_f32_16x16x32_bf16 v[72:75], a[28:31], v[112:115], v[72:75]
    s_waitcnt lgkmcnt(6)
    ds_read_u16_d16_hi v67, v67 offset:0
    v_or_b32 v52, v52, v53
    v_smfmac_f32_16x16x64_bf16 v[136:139], v[220:223], v[208:215], v175
    ds_read_b128 v[220:223], v253 offset:3280
    ds_read_u16 v56, v56 offset:0
    v_mfma_f32_16x16x32_bf16 v[72:75], a[32:35], v[116:119], v[72:75]
    v_mfma_f32_16x16x32_bf16 v[76:79], a[44:47], v[116:119], 0
    ds_read_b128 v[212:215], v251 offset:400
    v_lshlrev_b32_sdwa v65, 1, v65 dst_sel:DWORD dst_unused:UNUSED_PAD src0_sel:DWORD src1_sel:WORD_1
    v_mfma_f32_16x16x32_bf16 v[76:79], a[40:43], v[112:115], v[76:79]
    ds_read_b128 v[208:211], v250 offset:400
    ds_read_u16_d16_hi v69, v69 offset:0
    v_or_b32_e64 v51, v50, v51
    v_xor_b32 v255, 800, v255
    v_or_b32_e64 v53, v54, v55
    v_pk_add_f32 v[246:247], v[246:247], v[132:133]
    v_pk_fma_f32 v[248:249], v[132:133], v[132:133], v[248:249]
    v_mfma_f32_16x16x32_bf16 v[76:79], a[36:39], v[108:111], v[76:79]
    s_waitcnt lgkmcnt(7)
    ds_read_u16 v64, v64 offset:0
    v_lshlrev_b32_sdwa v68, 1, v68 dst_sel:DWORD dst_unused:UNUSED_PAD src0_sel:DWORD src1_sel:WORD_1
    v_or_b32 v50, v48, v49
    v_or_b32_e64 v59, v58, v59
    v_lshlrev_b32_sdwa v74, 1, v74 dst_sel:DWORD dst_unused:UNUSED_PAD src0_sel:DWORD src1_sel:WORD_1
    v_pk_add_f32 v[246:247], v[246:247], v[134:135]
    v_smfmac_f32_16x16x32_bf16 v[136:139], v[224:225], v[216:219], v175
    ds_read_b128 v[216:219], v252 offset:400
    ds_read_u16 v68, v68 offset:0
    v_lshlrev_b32_sdwa v79, 1, v79 dst_sel:DWORD dst_unused:UNUSED_PAD src0_sel:DWORD src1_sel:WORD_1
    v_mfma_f32_16x16x32_bf16 v[0:3], a[240:243], v[50:53], v[0:3]
    v_lshlrev_b32_sdwa v76, 1, v76 dst_sel:DWORD dst_unused:UNUSED_PAD src0_sel:DWORD src1_sel:WORD_1
    v_mfma_f32_16x16x32_bf16 v[4:7], a[244:247], v[50:53], v[4:7]
    ds_read_u16 v66, v66 offset:0
    buffer_load_dwordx3 v[196:198], v183, s[16:19], 0 offen offset:768 nt
    v_mfma_f32_16x16x32_bf16 v[8:11], a[248:251], v[50:53], v[8:11]
    ds_read_b64 v[224:225], v254 offset:3280
    v_fma_mix_f32 v63, v63, v243, 0 op_sel:[0,1,0] op_sel_hi:[0,1,0]
    v_mfma_f32_16x16x32_bf16 v[12:15], a[252:255], v[50:53], v[12:15]
    v_fma_mix_f32 v62, v62, v243, 0 op_sel:[0,0,0] op_sel_hi:[0,1,0]
    v_lshlrev_b32_sdwa v75, 1, v75 dst_sel:DWORD dst_unused:UNUSED_PAD src0_sel:DWORD src1_sel:WORD_1
    v_mfma_f32_16x16x32_bf16 v[16:19], v[226:229], v[50:53], v[16:19]
    ds_read_b128 v[104:107], v255 offset:16384
    ds_read_b128 v[96:99], v255 offset:0
    v_mfma_f32_16x16x32_bf16 v[20:23], v[230:233], v[50:53], v[20:23]
    s_waitcnt lgkmcnt(8)
    v_lshlrev_b32_sdwa v73, 1, v73 dst_sel:DWORD dst_unused:UNUSED_PAD src0_sel:DWORD src1_sel:WORD_1
    v_lshlrev_b32_sdwa v70, 1, v70 dst_sel:DWORD dst_unused:UNUSED_PAD src0_sel:DWORD src1_sel:WORD_1
    v_smfmac_f32_16x16x64_bf16 v[140:143], v[220:223], v[208:215], v175
    ds_read_b128 v[208:211], v250 offset:480
    ds_read_b128 v[212:215], v251 offset:480
    v_mfma_f32_16x16x32_bf16 v[48:51], a[48:51], v[108:111], 0
    v_or_b32 v58, v56, v57
    v_mfma_f32_16x16x32_bf16 v[48:51], a[52:55], v[112:115], v[48:51]
    ds_read_b128 v[220:223], v253 offset:3936
    v_lshlrev_b32_sdwa v78, 1, v78 dst_sel:DWORD dst_unused:UNUSED_PAD src0_sel:DWORD src1_sel:WORD_1
    v_mfma_f32_16x16x32_bf16 v[48:51], a[56:59], v[116:119], v[48:51]
    ds_read_u16 v76, v76 offset:0
    ds_read_u16_d16_hi v65, v65 offset:0
    v_mfma_f32_16x16x32_bf16 v[52:55], a[68:71], v[116:119], 0
    v_or_b32_e64 v60, v60, v61
    v_lshlrev_b32_sdwa v72, 1, v72 dst_sel:DWORD dst_unused:UNUSED_PAD src0_sel:DWORD src1_sel:WORD_1
    v_mfma_f32_16x16x32_bf16 v[52:55], a[64:67], v[112:115], v[52:55]
    v_mfma_f32_16x16x32_bf16 v[52:55], a[60:63], v[108:111], v[52:55]
    s_waitcnt lgkmcnt(7)
    ds_read_b128 v[100:103], v255 offset:8192
    ds_read_u16_d16_hi v75, v75 offset:0
    v_cvt_pk_bf16_f32 v61, v62, v63
    v_smfmac_f32_16x16x32_bf16 v[140:143], v[224:225], v[216:219], v175
    s_nop 0
    buffer_load_dwordx3 v[200:202], v183, s[16:19], 0 offen offset:1536 nt
    v_lshlrev_b32_sdwa v77, 1, v77 dst_sel:DWORD dst_unused:UNUSED_PAD src0_sel:DWORD src1_sel:WORD_1
    v_mfma_f32_16x16x32_bf16 v[0:3], v[234:237], v[58:61], v[0:3]
    ds_read_b128 v[216:219], v252 offset:480
    ds_read_b64 v[224:225], v254 offset:3936
    v_mfma_f32_16x16x32_bf16 v[4:7], v[238:241], v[58:61], v[4:7]
    ds_read_u16_d16_hi v79, v79 offset:0
    ds_read_u16 v70, v70 offset:0
    v_or_b32_e64 v68, v68, v69
    v_lshlrev_b32_sdwa v52, 1, v52 dst_sel:DWORD dst_unused:UNUSED_PAD src0_sel:DWORD src1_sel:WORD_1
    v_lshlrev_b32_sdwa v50, 1, v50 dst_sel:DWORD dst_unused:UNUSED_PAD src0_sel:DWORD src1_sel:WORD_1
    v_pk_fma_f32 v[248:249], v[134:135], v[134:135], v[248:249]
    v_pk_fma_f32 v[248:249], v[136:137], v[136:137], v[248:249]
    v_lshlrev_b32_sdwa v48, 1, v48 dst_sel:DWORD dst_unused:UNUSED_PAD src0_sel:DWORD src1_sel:WORD_1
    v_pk_add_f32 v[246:247], v[246:247], v[136:137]
    v_pk_fma_f32 v[248:249], v[138:139], v[138:139], v[248:249]
    v_mfma_f32_16x16x32_bf16 v[8:11], v[80:83], v[58:61], v[8:11]
    ds_read_u16_d16_hi v71, v71 offset:0
    v_lshlrev_b32_sdwa v51, 1, v51 dst_sel:DWORD dst_unused:UNUSED_PAD src0_sel:DWORD src1_sel:WORD_1
    v_or_b32_e64 v67, v66, v67
    v_mfma_f32_16x16x32_bf16 v[12:15], v[84:87], v[58:61], v[12:15]
    s_waitcnt lgkmcnt(7)
    ds_read_u16_d16_hi v77, v77 offset:0
    v_or_b32 v66, v64, v65
    v_mfma_f32_16x16x32_bf16 v[16:19], v[88:91], v[58:61], v[16:19]
    v_cvt_pk_bf16_f32 v0, v0, v1
    v_cvt_pk_bf16_f32 v1, v2, v3
    v_cvt_pk_bf16_f32 v8, v8, v9
    v_smfmac_f32_16x16x64_bf16 v[144:147], v[220:223], v[208:215], v175
    ds_read_b128 v[208:211], v250 offset:560
    ds_read_b128 v[220:223], v253 offset:4592
    ds_read_b128 v[212:215], v251 offset:560
    v_cvt_pk_f16_f32 v242, v54, v55
    v_cvt_pk_bf16_f32 v3, v6, v7
    v_cvt_pk_bf16_f32 v2, v4, v5
    v_pk_add_f32 v[246:247], v[246:247], v[138:139]
    v_pk_fma_f32 v[248:249], v[140:141], v[140:141], v[248:249]
    v_mfma_f32_16x16x32_bf16 v[20:23], v[92:95], v[58:61], v[20:23]
    s_waitcnt lgkmcnt(7)
    ds_read_u16 v78, v78 offset:0
    v_lshlrev_b32_sdwa v53, 1, v53 dst_sel:DWORD dst_unused:UNUSED_PAD src0_sel:DWORD src1_sel:WORD_1
    v_cvt_pk_bf16_f32 v9, v10, v11
    v_smfmac_f32_16x16x32_bf16 v[144:147], v[224:225], v[216:219], v175
    s_nop 0
    ds_read_b128 v[216:219], v252 offset:560
    ds_read_b64 v[224:225], v254 offset:4592
    v_pk_fma_f16 v243, v242, v242, s48
    v_mfma_f32_16x16x32_bf16 v[56:59], a[72:75], v[108:111], 0
    buffer_load_dwordx3 v[204:206], v183, s[16:19], 0 offen offset:2304 nt
    ds_read_u16 v74, v74 offset:0
    v_mfma_f32_16x16x32_bf16 v[56:59], a[76:79], v[112:115], v[56:59]
    s_waitcnt lgkmcnt(8)
    v_pk_mul_f16 v243, v242, v243 neg_lo:[1,0] neg_hi:[1,0]
    v_or_b32 v69, v70, v71
    v_mfma_f32_16x16x32_bf16 v[56:59], a[80:83], v[116:119], v[56:59]
    ds_read_u16 v52, v52 offset:0
    v_mfma_f32_16x16x32_bf16 v[60:63], a[92:95], v[116:119], 0
    ds_write_b128 v171, v[0:3] offset:0
    v_cvt_pk_bf16_f32 v16, v16, v17
    v_lshlrev_b32_sdwa v49, 1, v49 dst_sel:DWORD dst_unused:UNUSED_PAD src0_sel:DWORD src1_sel:WORD_1
    v_mfma_f32_16x16x32_bf16 v[60:63], a[88:91], v[112:115], v[60:63]
    v_exp_f16_sdwa v243, v243 dst_sel:WORD_0 dst_unused:UNUSED_PRESERVE src0_sel:WORD_0
    v_mfma_f32_16x16x32_bf16 v[60:63], a[84:87], v[108:111], v[60:63]
    s_waitcnt lgkmcnt(6)
    ds_read_u16_d16_hi v73, v73 offset:0
    v_exp_f16_sdwa v243, v243 dst_sel:WORD_1 dst_unused:UNUSED_PRESERVE src0_sel:WORD_1
    v_smfmac_f32_16x16x64_bf16 v[148:151], v[220:223], v[208:215], v175
    s_nop 0
    ds_read_b128 v[208:211], v250 offset:640
    ds_read_b128 v[212:215], v251 offset:640
    v_cvt_pk_bf16_f32 v11, v14, v15
    v_mfma_f32_16x16x32_bf16 v[24:27], a[144:147], v[66:69], 0
    ds_read_b128 v[220:223], v253 offset:5248
    ds_read_u16 v72, v72 offset:0
    v_lshlrev_b32_sdwa v58, 1, v58 dst_sel:DWORD dst_unused:UNUSED_PAD src0_sel:DWORD src1_sel:WORD_1
    v_or_b32_e64 v76, v76, v77
    v_pk_fma_f16 v243, v243, s50, s50
    v_cvt_pk_bf16_f32 v17, v18, v19
    v_pk_fma_f32 v[248:249], v[142:143], v[142:143], v[248:249]
    v_mfma_f32_16x16x32_bf16 v[28:31], a[148:151], v[66:69], 0
    s_waitcnt lgkmcnt(8)
    v_lshlrev_b32_sdwa v63, 1, v63 dst_sel:DWORD dst_unused:UNUSED_PAD src0_sel:DWORD src1_sel:WORD_1
    v_rcp_f16_sdwa v243, v243 dst_sel:WORD_0 dst_unused:UNUSED_PRESERVE src0_sel:WORD_0
    v_smfmac_f32_16x16x32_bf16 v[148:151], v[224:225], v[216:219], v175
    s_add_u32 s16, s16, s14
    ds_read_b64 v[224:225], v254 offset:5248
    ds_read_b128 v[216:219], v252 offset:640
    ds_read_u16 v48, v48 offset:0
    v_lshlrev_b32_sdwa v57, 1, v57 dst_sel:DWORD dst_unused:UNUSED_PAD src0_sel:DWORD src1_sel:WORD_1
    v_lshlrev_b32_sdwa v60, 1, v60 dst_sel:DWORD dst_unused:UNUSED_PAD src0_sel:DWORD src1_sel:WORD_1
    v_pk_add_f32 v[246:247], v[246:247], v[140:141]
    v_pk_add_f32 v[246:247], v[246:247], v[142:143]
    v_pk_fma_f32 v[248:249], v[144:145], v[144:145], v[248:249]
    v_pk_fma_f32 v[248:249], v[146:147], v[146:147], v[248:249]
    v_pk_add_f32 v[246:247], v[246:247], v[144:145]
    v_mfma_f32_16x16x32_bf16 v[32:35], a[152:155], v[66:69], 0
    ds_read_u16_d16_hi v51, v51 offset:0
    ds_read_u16_d16_hi v53, v53 offset:0
    v_mfma_f32_16x16x32_bf16 v[36:39], a[156:159], v[66:69], 0
    v_lshlrev_b32_sdwa v59, 1, v59 dst_sel:DWORD dst_unused:UNUSED_PAD src0_sel:DWORD src1_sel:WORD_1
    v_xor_b32 v255, 288, v255
    v_mfma_f32_16x16x32_bf16 v[40:43], a[160:163], v[66:69], 0
    ds_read_u16_d16_hi v49, v49 offset:0
    v_mfma_f32_16x16x32_bf16 v[44:47], a[164:167], v[66:69], 0
    s_waitcnt lgkmcnt(7)
    v_cvt_pk_bf16_f32 v10, v12, v13
    v_or_b32 v75, v74, v75
    v_smfmac_f32_16x16x64_bf16 v[152:155], v[220:223], v[208:215], v175
    ds_read_b128 v[220:223], v253 offset:5904
    ds_read_u16 v50, v50 offset:0
    v_mfma_f32_16x16x32_bf16 v[64:67], a[96:99], v[108:111], 0
    v_lshlrev_b32_sdwa v56, 1, v56 dst_sel:DWORD dst_unused:UNUSED_PAD src0_sel:DWORD src1_sel:WORD_1
    v_or_b32_e64 v77, v78, v79
    v_mfma_f32_16x16x32_bf16 v[64:67], a[100:103], v[112:115], v[64:67]
    ds_read_u16_d16_hi v63, v63 offset:0
    v_lshlrev_b32_sdwa v62, 1, v62 dst_sel:DWORD dst_unused:UNUSED_PAD src0_sel:DWORD src1_sel:WORD_1
    v_mfma_f32_16x16x32_bf16 v[64:67], a[104:107], v[116:119], v[64:67]
    v_rcp_f16_sdwa v243, v243 dst_sel:WORD_1 dst_unused:UNUSED_PRESERVE src0_sel:WORD_1
    v_mfma_f32_16x16x32_bf16 v[68:71], a[116:119], v[116:119], 0
    ds_read_u16 v58, v58 offset:0
    v_mfma_f32_16x16x32_bf16 v[68:71], a[112:115], v[112:115], v[68:71]
    ds_write_b128 v171, v[8:11] offset:1024
    v_pk_fma_f32 v[248:249], v[148:149], v[148:149], v[248:249]
    v_mfma_f32_16x16x32_bf16 v[68:71], a[108:111], v[108:111], v[68:71]
    s_waitcnt lgkmcnt(9)
    v_cvt_pk_bf16_f32 v18, v20, v21
    v_or_b32 v74, v72, v73
    v_smfmac_f32_16x16x32_bf16 v[152:155], v[224:225], v[216:219], v175
    ds_read_b128 v[212:215], v251 offset:720
    ds_read_b128 v[208:211], v250 offset:720
    v_mfma_f32_16x16x32_bf16 v[24:27], a[168:171], v[74:77], v[24:27]
    ds_read_u16_d16_hi v59, v59 offset:0
    v_lshlrev_b32_sdwa v61, 1, v61 dst_sel:DWORD dst_unused:UNUSED_PAD src0_sel:DWORD src1_sel:WORD_1
    v_mfma_f32_16x16x32_bf16 v[28:31], a[172:175], v[74:77], v[28:31]
    ds_read_b64 v[224:225], v254 offset:5904
    v_mfma_f32_16x16x32_bf16 v[32:35], a[176:179], v[74:77], v[32:35]
    ds_read_u16_d16_hi v61, v61 offset:0
    v_lshlrev_b32_sdwa v64, 1, v64 dst_sel:DWORD dst_unused:UNUSED_PAD src0_sel:DWORD src1_sel:WORD_1
    v_mfma_f32_16x16x32_bf16 v[36:39], a[180:183], v[74:77], v[36:39]
    s_addc_u32 s17, s17, s1
    ds_read_b128 v[216:219], v252 offset:720
    v_fma_mix_f32 v54, v54, v243, 0 op_sel:[0,0,0] op_sel_hi:[0,1,0]
    v_mfma_f32_16x16x32_bf16 v[40:43], a[184:187], v[74:77], v[40:43]
    s_nop 0
    ds_read_u16 v56, v56 offset:0
    v_lshlrev_b32_sdwa v69, 1, v69 dst_sel:DWORD dst_unused:UNUSED_PAD src0_sel:DWORD src1_sel:WORD_1
    v_mfma_f32_16x16x32_bf16 v[44:47], a[188:191], v[74:77], v[44:47]
    v_lshlrev_b32_sdwa v71, 1, v71 dst_sel:DWORD dst_unused:UNUSED_PAD src0_sel:DWORD src1_sel:WORD_1
    v_cvt_pk_bf16_f32 v19, v22, v23
    v_mfma_f32_16x16x32_bf16 v[72:75], a[120:123], v[108:111], 0
    ds_read_u16 v60, v60 offset:0
    v_fma_mix_f32 v55, v55, v243, 0 op_sel:[0,1,0] op_sel_hi:[0,1,0]
    v_lshlrev_b32_sdwa v67, 1, v67 dst_sel:DWORD dst_unused:UNUSED_PAD src0_sel:DWORD src1_sel:WORD_1
    v_mfma_f32_16x16x32_bf16 v[72:75], a[124:127], v[112:115], v[72:75]
    ds_write_b128 v171, v[16:19] offset:2048
    v_pk_fma_f32 v[248:249], v[150:151], v[150:151], v[248:249]
    v_pk_add_f32 v[246:247], v[246:247], v[146:147]
    v_mfma_f32_16x16x32_bf16 v[72:75], a[128:131], v[116:119], v[72:75]
    s_waitcnt lgkmcnt(7)
    v_or_b32 v51, v50, v51
    v_lshlrev_b32_sdwa v68, 1, v68 dst_sel:DWORD dst_unused:UNUSED_PAD src0_sel:DWORD src1_sel:WORD_1
    v_smfmac_f32_16x16x64_bf16 v[156:159], v[220:223], v[208:215], v175
    ds_read_b128 v[220:223], v253 offset:6560
    ds_read_b128 v[208:211], v250 offset:800
    v_mfma_f32_16x16x32_bf16 v[76:79], a[140:143], v[116:119], 0
    s_add_u32 s46, s46, 6
    v_lshlrev_b32_sdwa v75, 1, v75 dst_sel:DWORD dst_unused:UNUSED_PAD src0_sel:DWORD src1_sel:WORD_1
    v_lshlrev_b32_sdwa v66, 1, v66 dst_sel:DWORD dst_unused:UNUSED_PAD src0_sel:DWORD src1_sel:WORD_1
    v_mfma_f32_16x16x32_bf16 v[76:79], a[136:139], v[112:115], v[76:79]
    ds_read_u16 v62, v62 offset:0
    v_or_b32 v50, v48, v49
    v_mfma_f32_16x16x32_bf16 v[76:79], a[132:135], v[108:111], v[76:79]
    s_waitcnt lgkmcnt(6)
    ds_read_b128 v[212:215], v251 offset:800
    ds_read_u16_d16_hi v67, v67 offset:0
    v_or_b32 v52, v52, v53
    v_smfmac_f32_16x16x32_bf16 v[156:159], v[224:225], v[216:219], v175
    ds_read_u16_d16_hi v57, v57 offset:0
    v_cvt_pk_bf16_f32 v53, v54, v55
    v_add_u32_e64 v171, s98, v203
    v_cvt_pk_f16_f32 v242, v78, v79
    v_lshlrev_b32_sdwa v76, 1, v76 dst_sel:DWORD dst_unused:UNUSED_PAD src0_sel:DWORD src1_sel:WORD_1
    v_pk_fma_f32 v[248:249], v[152:153], v[152:153], v[248:249]
    v_pk_add_f32 v[246:247], v[246:247], v[148:149]
    v_pk_add_f32 v[246:247], v[246:247], v[150:151]
    v_pk_add_f32 v[246:247], v[246:247], v[152:153]
    v_pk_fma_f32 v[248:249], v[154:155], v[154:155], v[248:249]
    v_mfma_f32_16x16x32_bf16 v[24:27], a[192:195], v[50:53], v[24:27]
    ds_read_b128 v[216:219], v252 offset:800
    ds_read_u16_d16_hi v71, v71 offset:0
    v_mfma_f32_16x16x32_bf16 v[28:31], a[196:199], v[50:53], v[28:31]
    ds_read_b64 v[224:225], v254 offset:6560
    v_or_b32_e64 v59, v58, v59
    v_mfma_f32_16x16x32_bf16 v[32:35], a[200:203], v[50:53], v[32:35]
    v_lshlrev_b32_sdwa v70, 1, v70 dst_sel:DWORD dst_unused:UNUSED_PAD src0_sel:DWORD src1_sel:WORD_1
    v_lshlrev_b32_sdwa v65, 1, v65 dst_sel:DWORD dst_unused:UNUSED_PAD src0_sel:DWORD src1_sel:WORD_1
    v_mfma_f32_16x16x32_bf16 v[36:39], a[204:207], v[50:53], v[36:39]
    ds_read_u16 v66, v66 offset:0
    v_pk_fma_f16 v243, v242, v242, s48
    v_mfma_f32_16x16x32_bf16 v[40:43], a[208:211], v[50:53], v[40:43]
    s_add_u32 s44, s44, s15
    ds_read_u16_d16_hi v65, v65 offset:0
    v_pk_mul_f16 v243, v242, v243 neg_lo:[1,0] neg_hi:[1,0]
    v_mfma_f32_16x16x32_bf16 v[44:47], a[212:215], v[50:53], v[44:47]
    s_waitcnt lgkmcnt(7)
    v_lshlrev_b32_sdwa v72, 1, v72 dst_sel:DWORD dst_unused:UNUSED_PAD src0_sel:DWORD src1_sel:WORD_1
    v_lshlrev_b32_sdwa v77, 1, v77 dst_sel:DWORD dst_unused:UNUSED_PAD src0_sel:DWORD src1_sel:WORD_1
    v_smfmac_f32_16x16x64_bf16 v[160:163], v[220:223], v[208:215], v175
    ds_read_b128 v[116:119], v255 offset:16384
    ds_read_b128 v[208:211], v250 offset:880
    v_mfma_f32_16x16x32_bf16 v[48:51], a[0:3], v[96:99], 0
    v_exp_f16_sdwa v243, v243 dst_sel:WORD_0 dst_unused:UNUSED_PRESERVE src0_sel:WORD_0
    v_mfma_f32_16x16x32_bf16 v[48:51], a[4:7], v[100:103], v[48:51]
    ds_read_u16_d16_hi v69, v69 offset:0
    v_or_b32_e64 v60, v60, v61
    v_mfma_f32_16x16x32_bf16 v[48:51], a[8:11], v[104:107], v[48:51]
    ds_read_b128 v[212:215], v251 offset:880
    ds_read_u16 v68, v68 offset:0
    v_mfma_f32_16x16x32_bf16 v[52:55], a[20:23], v[104:107], 0
    v_lshlrev_b32_sdwa v73, 1, v73 dst_sel:DWORD dst_unused:UNUSED_PAD src0_sel:DWORD src1_sel:WORD_1
    v_exp_f16_sdwa v243, v243 dst_sel:WORD_1 dst_unused:UNUSED_PRESERVE src0_sel:WORD_1
    v_mfma_f32_16x16x32_bf16 v[52:55], a[16:19], v[100:103], v[52:55]
    v_or_b32_e64 v61, v62, v63
    v_mfma_f32_16x16x32_bf16 v[52:55], a[12:15], v[96:99], v[52:55]
    s_waitcnt lgkmcnt(7)
    ds_read_b128 v[108:111], v255 offset:0
    ds_read_b128 v[220:223], v253 offset:7216
    v_or_b32 v58, v56, v57
    v_smfmac_f32_16x16x32_bf16 v[160:163], v[224:225], v[216:219], v175
    ds_read_b128 v[216:219], v252 offset:880
    v_lshlrev_b32_sdwa v50, 1, v50 dst_sel:DWORD dst_unused:UNUSED_PAD src0_sel:DWORD src1_sel:WORD_1
    v_lshlrev_b32_sdwa v51, 1, v51 dst_sel:DWORD dst_unused:UNUSED_PAD src0_sel:DWORD src1_sel:WORD_1
    v_mfma_f32_16x16x32_bf16 v[24:27], a[216:219], v[58:61], v[24:27]
    ds_read_u16 v64, v64 offset:0
    v_lshlrev_b32_sdwa v48, 1, v48 dst_sel:DWORD dst_unused:UNUSED_PAD src0_sel:DWORD src1_sel:WORD_1
    v_lshlrev_b32_sdwa v74, 1, v74 dst_sel:DWORD dst_unused:UNUSED_PAD src0_sel:DWORD src1_sel:WORD_1
    v_mfma_f32_16x16x32_bf16 v[28:31], a[220:223], v[58:61], v[28:31]
    ds_read_b64 v[224:225], v254 offset:7216
    v_pk_fma_f16 v243, v243, s50, s50
    v_mfma_f32_16x16x32_bf16 v[32:35], a[224:227], v[58:61], v[32:35]
    ds_read_u16_d16_hi v75, v75 offset:0
    v_lshlrev_b32_sdwa v49, 1, v49 dst_sel:DWORD dst_unused:UNUSED_PAD src0_sel:DWORD src1_sel:WORD_1
    v_mfma_f32_16x16x32_bf16 v[36:39], a[228:231], v[58:61], v[36:39]
    ds_read_u16_d16_hi v73, v73 offset:0
    ds_read_u16 v74, v74 offset:0
    v_rcp_f16_sdwa v243, v243 dst_sel:WORD_0 dst_unused:UNUSED_PRESERVE src0_sel:WORD_0
    v_lshlrev_b32_sdwa v52, 1, v52 dst_sel:DWORD dst_unused:UNUSED_PAD src0_sel:DWORD src1_sel:WORD_1
    v_pk_add_f32 v[246:247], v[246:247], v[154:155]
    v_pk_add_f32 v[246:247], v[246:247], v[156:157]
    v_pk_add_f32 v[246:247], v[246:247], v[158:159]
    v_pk_fma_f32 v[248:249], v[156:157], v[156:157], v[248:249]
    v_pk_fma_f32 v[248:249], v[158:159], v[158:159], v[248:249]
    v_pk_fma_f32 v[248:249], v[160:161], v[160:161], v[248:249]
    v_pk_add_f32 v[246:247], v[246:247], v[160:161]
    v_pk_fma_f32 v[248:249], v[162:163], v[162:163], v[248:249]
    v_mfma_f32_16x16x32_bf16 v[40:43], a[232:235], v[58:61], v[40:43]
    ds_read_u16 v70, v70 offset:0
    ds_read_u16 v76, v76 offset:0
    v_mfma_f32_16x16x32_bf16 v[44:47], a[236:239], v[58:61], v[44:47]
    s_waitcnt lgkmcnt(8)
    v_or_b32 v67, v66, v67
    v_lshlrev_b32_sdwa v53, 1, v53 dst_sel:DWORD dst_unused:UNUSED_PAD src0_sel:DWORD src1_sel:WORD_1
    v_smfmac_f32_16x16x64_bf16 v[164:167], v[220:223], v[208:215], v175
    ds_read_u16_d16_hi v77, v77 offset:0
    v_lshlrev_b32_sdwa v54, 1, v54 dst_sel:DWORD dst_unused:UNUSED_PAD src0_sel:DWORD src1_sel:WORD_1
    v_mfma_f32_16x16x32_bf16 v[56:59], a[24:27], v[96:99], 0
    s_waitcnt lgkmcnt(6)
    ds_read_b128 v[112:115], v255 offset:8192
    v_or_b32 v66, v64, v65
    v_or_b32_e64 v68, v68, v69
    v_smfmac_f32_16x16x32_bf16 v[164:167], v[224:225], v[216:219], v175
    v_mul_hi_u32_u24 v224, 39147, v250
    v_add_u32_sdwa v225, s45, v175 dst_sel:DWORD dst_unused:UNUSED_PAD src0_sel:DWORD src1_sel:WORD_1
    v_add_u32 v250, 31488, v250
    v_mfma_f32_16x16x32_bf16 v[56:59], a[28:31], v[100:103], v[56:59]
    ds_read2_b32 v[212:213], v225 offset0:0 offset1:20
    v_lshlrev_b32_sdwa v55, 1, v55 dst_sel:DWORD dst_unused:UNUSED_PAD src0_sel:DWORD src1_sel:WORD_1
    v_mfma_f32_16x16x32_bf16 v[56:59], a[32:35], v[104:107], v[56:59]
    ds_read2_b32 v[214:215], v225 offset0:40 offset1:60
    ds_read_u16 v72, v72 offset:0
    ds_read_u16_d16_hi v51, v51 offset:0
    v_add_u32 v225, 1280, v225
    v_mad_i32_i24 v250, v224, s99, v250
    v_pk_fma_f32 v[248:249], v[164:165], v[164:165], v[248:249]
    v_pk_add_f32 v[246:247], v[246:247], v[162:163]
    v_pk_add_f32 v[246:247], v[246:247], v[164:165]
    v_pk_add_f32 v[246:247], v[246:247], v[166:167]
    v_pk_fma_f32 v[248:249], v[166:167], v[166:167], v[248:249]
    v_mfma_f32_16x16x32_bf16 v[60:63], a[44:47], v[104:107], 0
    s_waitcnt lgkmcnt(7)
    ds_write_b128 v171, v[246:249]
    v_or_b32 v69, v70, v71
    v_lshlrev_b32_sdwa v57, 1, v57 dst_sel:DWORD dst_unused:UNUSED_PAD src0_sel:DWORD src1_sel:WORD_1
    v_mfma_f32_16x16x32_bf16 v[60:63], a[40:43], v[100:103], v[60:63]
    s_add_u32 s47, s44, s13
    v_or_b32 v75, v74, v75
    v_lshlrev_b32_sdwa v56, 1, v56 dst_sel:DWORD dst_unused:UNUSED_PAD src0_sel:DWORD src1_sel:WORD_1
    v_mul_hi_u32_u24 v224, 39147, v251
    v_mfma_f32_16x16x32_bf16 v[60:63], a[36:39], v[96:99], v[60:63]
    ds_read2_b32 v[216:217], v225 offset0:0 offset1:20
    ds_write_b32 v191, v195
    v_mfma_f32_16x16x32_bf16 v[24:27], a[240:243], v[66:69], v[24:27]
    ds_read2_b32 v[218:219], v225 offset0:40 offset1:60
    v_add_u32 v251, 31488, v251
    v_mfma_f32_16x16x32_bf16 v[28:31], a[244:247], v[66:69], v[28:31]
    ds_read_u16 v50, v50 offset:0
    ds_read_u16_d16_hi v55, v55 offset:0
    v_mfma_f32_16x16x32_bf16 v[32:35], a[248:251], v[66:69], v[32:35]
    v_mad_i32_i24 v251, v224, s99, v251
    v_rcp_f16_sdwa v243, v243 dst_sel:WORD_1 dst_unused:UNUSED_PRESERVE src0_sel:WORD_1
    v_mfma_f32_16x16x32_bf16 v[36:39], a[252:255], v[66:69], v[36:39]
    s_waitcnt lgkmcnt(7)
    v_or_b32 v74, v72, v73
    v_lshlrev_b32_sdwa v60, 1, v60 dst_sel:DWORD dst_unused:UNUSED_PAD src0_sel:DWORD src1_sel:WORD_1
    v_mfma_f32_16x16x32_bf16 v[40:43], v[226:229], v[66:69], v[40:43]
    ds_read_u16 v52, v52 offset:0
    v_fma_mix_f32 v78, v78, v243, 0 op_sel:[0,0,0] op_sel_hi:[0,1,0]
    v_mfma_f32_16x16x32_bf16 v[44:47], v[230:233], v[66:69], v[44:47]
    ds_read_u16 v48, v48 offset:0
    v_or_b32_e64 v76, v76, v77
    v_mfma_f32_16x16x32_bf16 v[64:67], a[48:51], v[96:99], 0
    ds_read_u16_d16_hi v53, v53 offset:0
    v_lshlrev_b32_sdwa v62, 1, v62 dst_sel:DWORD dst_unused:UNUSED_PAD src0_sel:DWORD src1_sel:WORD_1
    v_lshlrev_b32_sdwa v61, 1, v61 dst_sel:DWORD dst_unused:UNUSED_PAD src0_sel:DWORD src1_sel:WORD_1
    v_fma_mix_f32 v79, v79, v243, 0 op_sel:[0,1,0] op_sel_hi:[0,1,0]
    v_mfma_f32_16x16x32_bf16 v[64:67], a[52:55], v[100:103], v[64:67]
    v_add_u32_e64 v171, s97, v203
    v_add_u32 v225, 1280, v225
    v_mfma_f32_16x16x32_bf16 v[64:67], a[56:59], v[104:107], v[64:67]
    s_cmp_ge_u32 s45, 109716
    ds_read2_b32 v[220:221], v225 offset0:0 offset1:20
    ds_read2_b32 v[222:223], v225 offset0:40 offset1:60
    v_mul_hi_u32_u24 v224, 39147, v252
    v_cvt_pk_bf16_f32 v77, v78, v79
    v_mfma_f32_16x16x32_bf16 v[68:71], a[68:71], v[104:107], 0
    ds_read_u16 v56, v56 offset:0
    v_add_u32 v252, 31488, v252
    v_lshlrev_b32_sdwa v58, 1, v58 dst_sel:DWORD dst_unused:UNUSED_PAD src0_sel:DWORD src1_sel:WORD_1
    v_lshlrev_b32_sdwa v66, 1, v66 dst_sel:DWORD dst_unused:UNUSED_PAD src0_sel:DWORD src1_sel:WORD_1
    v_lshlrev_b32_sdwa v63, 1, v63 dst_sel:DWORD dst_unused:UNUSED_PAD src0_sel:DWORD src1_sel:WORD_1
    v_mfma_f32_16x16x32_bf16 v[68:71], a[64:67], v[100:103], v[68:71]
    ds_read_u16 v54, v54 offset:0
    v_lshlrev_b32_sdwa v64, 1, v64 dst_sel:DWORD dst_unused:UNUSED_PAD src0_sel:DWORD src1_sel:WORD_1
    v_mfma_f32_16x16x32_bf16 v[68:71], a[60:63], v[96:99], v[68:71]
    ds_read_addtid_b32 v199 offset:5120
    v_lshlrev_b32_sdwa v67, 1, v67 dst_sel:DWORD dst_unused:UNUSED_PAD src0_sel:DWORD src1_sel:WORD_1
    v_mad_i32_i24 v252, v224, s99, v252
    v_mfma_f32_16x16x32_bf16 v[24:27], v[234:237], v[74:77], v[24:27]
    ds_read_u16_d16_hi v49, v49 offset:0
    v_lshlrev_b32_sdwa v59, 1, v59 dst_sel:DWORD dst_unused:UNUSED_PAD src0_sel:DWORD src1_sel:WORD_1
    v_mfma_f32_16x16x32_bf16 v[28:31], v[238:241], v[74:77], v[28:31]
    s_waitcnt lgkmcnt(10)
    ds_read_u16_d16_hi v57, v57 offset:0
    ds_read_u16_d16_hi v63, v63 offset:0
    v_lshlrev_b32_sdwa v69, 1, v69 dst_sel:DWORD dst_unused:UNUSED_PAD src0_sel:DWORD src1_sel:WORD_1
    v_mfma_f32_16x16x16_bf16 v[12:15], v[244:245], v[218:219], 0
    v_cvt_pk_bf16_f32 v24, v24, v25
    v_add_u32_sdwa v225, s55, v175 dst_sel:DWORD dst_unused:UNUSED_PAD src0_sel:DWORD src1_sel:WORD_1
    v_cvt_pk_f16_f32 v242, v70, v71
    v_or_b32 v51, v50, v51
    v_mfma_f32_16x16x16_bf16 v[4:7], v[244:245], v[214:215], 0
    ds_read_u16 v58, v58 offset:0
    v_pk_fma_f16 v243, v242, v242, s48
    v_mfma_f32_16x16x16_bf16 v[0:3], v[244:245], v[212:213], 0
    v_add_u32_sdwa v224, s45, v207 dst_sel:DWORD dst_unused:UNUSED_PAD src0_sel:DWORD src1_sel:WORD_0
    v_cvt_pk_bf16_f32 v25, v26, v27
    v_pk_mul_f16 v243, v242, v243 neg_lo:[1,0] neg_hi:[1,0]
    v_exp_f16_sdwa v243, v243 dst_sel:WORD_0 dst_unused:UNUSED_PRESERVE src0_sel:WORD_0
    v_mfma_f32_16x16x32_bf16 v[32:35], v[80:83], v[74:77], v[32:35]
    ds_read_u16_d16_hi v59, v59 offset:0
    v_cvt_pk_bf16_f32 v26, v28, v29
    v_mfma_f32_16x16x32_bf16 v[36:39], v[84:87], v[74:77], v[36:39]
    ds_read_u16 v66, v66 offset:0
    v_cvt_pk_bf16_f32 v27, v30, v31
    v_mfma_f32_16x16x32_bf16 v[40:43], v[88:91], v[74:77], v[40:43]
    s_waitcnt lgkmcnt(6)
    v_cmp_lt_u32 vcc, v199, v195
    v_lshlrev_b32_sdwa v68, 1, v68 dst_sel:DWORD dst_unused:UNUSED_PAD src0_sel:DWORD src1_sel:WORD_1
    v_mfma_f32_16x16x32_bf16 v[44:47], v[92:95], v[74:77], v[44:47]
    s_waitcnt lgkmcnt(5)
    ds_read_u16_d16_hi v67, v67 offset:0
    ds_read_u16_d16_hi v61, v61 offset:0
    v_cvt_pk_bf16_f32 v32, v32, v33
    v_mfma_f32_16x16x16_bf16 v[20:23], v[244:245], v[222:223], 0
    v_cvt_pk_bf16_f32 v40, v40, v41
    v_or_b32 v52, v52, v53
    v_or_b32_e64 v50, v48, v49
    v_mfma_f32_16x16x16_bf16 v[8:11], v[244:245], v[216:217], 0
    s_cbranch_vccnz L_retry5
L_back5:
    v_mfma_f32_16x16x16_bf16 v[16:19], v[244:245], v[220:221], 0
    ds_read_b128 v[216:219], v203 offset:63488
    ds_read_b128 v[212:215], v203 offset:62464
    ds_read_b128 v[208:211], v203 offset:61440
    v_or_b32 v53, v54, v55
    v_mfma_f32_16x16x32_bf16 v[72:75], a[72:75], v[96:99], 0
    ds_read_b128 v[220:223], v203 offset:64512
    v_cvt_pk_bf16_f32 v33, v34, v35
    v_mfma_f32_16x16x32_bf16 v[72:75], a[76:79], v[100:103], v[72:75]
    v_exp_f16_sdwa v243, v243 dst_sel:WORD_1 dst_unused:UNUSED_PRESERVE src0_sel:WORD_1
    v_mfma_f32_16x16x32_bf16 v[72:75], a[80:83], v[104:107], v[72:75]
    ds_read_u16 v60, v60 offset:0
    s_waitcnt vmcnt(5)
    ds_write2_b32 v224, v168, v169 offset0:0 offset1:20
    v_mfma_f32_16x16x32_bf16 v[76:79], a[92:95], v[104:107], 0
    s_cselect_b32 s56, s99, 0
    v_pk_fma_f16 v243, v243, s50, s50
    v_cvt_pk_bf16_f32 v41, v42, v43
    v_mfma_f32_16x16x32_bf16 v[76:79], a[88:91], v[100:103], v[76:79]
    s_add_u32 s45, s45, s56
    ds_read_u16 v68, v68 offset:0
    v_rcp_f16_sdwa v243, v243 dst_sel:WORD_0 dst_unused:UNUSED_PRESERVE src0_sel:WORD_0
    v_mfma_f32_16x16x32_bf16 v[76:79], a[84:87], v[96:99], v[76:79]
    s_add_u32 s45, s45, 31488
    ds_write2_b32 v224, v176, v177 offset0:8 offset1:28
    v_lshlrev_b32_sdwa v75, 1, v75 dst_sel:DWORD dst_unused:UNUSED_PAD src0_sel:DWORD src1_sel:WORD_1
    v_mfma_f32_16x16x32_bf16 v[0:3], a[144:147], v[50:53], v[0:3]
    s_nop 0
    ds_write2_b32 v224, v173, v174 offset0:24 offset1:44
    v_lshlrev_b32_sdwa v73, 1, v73 dst_sel:DWORD dst_unused:UNUSED_PAD src0_sel:DWORD src1_sel:WORD_1
    v_mfma_f32_16x16x32_bf16 v[4:7], a[148:151], v[50:53], v[4:7]
    ds_read_u16_d16_hi v75, v75 offset:0
    ds_read_u16 v62, v62 offset:0
    v_mfma_f32_16x16x32_bf16 v[8:11], a[152:155], v[50:53], v[8:11]
    s_waitcnt lgkmcnt(7)
    ds_write2_b32 v224, v170, v172 offset0:40 offset1:4
    v_lshlrev_b32_sdwa v77, 1, v77 dst_sel:DWORD dst_unused:UNUSED_PAD src0_sel:DWORD src1_sel:WORD_1
    v_lshlrev_b32_sdwa v78, 1, v78 dst_sel:DWORD dst_unused:UNUSED_PAD src0_sel:DWORD src1_sel:WORD_1
    v_pk_add_f32 v[208:209], v[208:209], v[212:213]
    v_pk_add_f32 v[216:217], v[216:217], v[220:221]
    v_pk_add_f32 v[218:219], v[218:219], v[222:223]
    v_pk_add_f32 v[246:247], v[208:209], v[216:217]
    v_pk_mul_f32 v[246:247], s[52:53], v[246:247] op_sel_hi:[0,1]
    v_pk_add_f32 v[210:211], v[210:211], v[214:215]
    v_pk_add_f32 v[248:249], v[210:211], v[218:219]
    v_mfma_f32_16x16x32_bf16 v[12:15], a[156:159], v[50:53], v[12:15]
    s_nop 0
    ds_read_b128 v[212:215], v171 offset:1024
    v_lshlrev_b32_sdwa v72, 1, v72 dst_sel:DWORD dst_unused:UNUSED_PAD src0_sel:DWORD src1_sel:WORD_1
    v_mfma_f32_16x16x32_bf16 v[16:19], a[160:163], v[50:53], v[16:19]
    ds_read_b128 v[208:211], v171 offset:0
    v_or_b32_e64 v59, v58, v59
    v_mfma_f32_16x16x32_bf16 v[20:23], a[164:167], v[50:53], v[20:23]
    ds_write_b128 v171, v[24:27] offset:0
    v_cvt_pk_bf16_f32 v35, v38, v39
    v_cvt_pk_bf16_f32 v34, v36, v37
    v_pk_mul_f32 v[248:249], s[52:53], v[248:249] op_sel_hi:[0,1]
    v_pk_fma_f32 v[248:249], v[246:247], v[246:247], v[248:249] neg_lo:[1,0,0] neg_hi:[1,0,0]
    v_cvt_pk_bf16_f32 v43, v46, v47
    v_max_f32 v249, 0, v249
    v_max_f32 v248, 0, v248
    v_mfma_f32_16x16x32_bf16 v[48:51], a[96:99], v[96:99], 0
    ds_read_b128 v[216:219], v171 offset:2048
    ds_write_b128 v171, v[32:35] offset:1024
    v_add_f32 v248, s51, v248
    v_or_b32 v58, v56, v57
    v_add_f32_e64 v249, s51, v249
    v_mfma_f32_16x16x32_bf16 v[48:51], a[100:103], v[100:103], v[48:51]
    v_rsq_f32_e64 v248, v248
    v_mfma_f32_16x16x32_bf16 v[48:51], a[104:107], v[104:107], v[48:51]
    s_waitcnt lgkmcnt(3)
    ds_read2_b32 v[220:221], v225 offset0:0 offset1:20
    ds_read2_b32 v[222:223], v225 offset0:40 offset1:60
    ds_read_u16 v64, v64 offset:0
    v_or_b32 v60, v60, v61
    v_mfma_f32_16x16x16_bf16 v[0:3], v[244:245], v[208:209], v[0:3]
    v_rsq_f32_e64 v249, v249
    v_lshlrev_b32_sdwa v74, 1, v74 dst_sel:DWORD dst_unused:UNUSED_PAD src0_sel:DWORD src1_sel:WORD_1
    v_mfma_f32_16x16x16_bf16 v[8:11], v[244:245], v[212:213], v[8:11]
    v_mul_f32_e64 v248, s49, v248
    v_add_u32 v225, 1280, v225
    v_lshlrev_b32_sdwa v65, 1, v65 dst_sel:DWORD dst_unused:UNUSED_PAD src0_sel:DWORD src1_sel:WORD_1
    v_cvt_pk_bf16_f32 v42, v44, v45
    v_mul_f32_e64 v246, -v246, v248
    v_mfma_f32_16x16x32_bf16 v[52:55], a[116:119], v[104:107], 0
    ds_read_u16_d16_hi v77, v77 offset:0
    ds_read_u16_d16_hi v69, v69 offset:0
    v_mfma_f32_16x16x32_bf16 v[52:55], a[112:115], v[100:103], v[52:55]
    v_or_b32 v67, v66, v67
    v_mul_f32 v249, s49, v249
    v_mfma_f32_16x16x32_bf16 v[52:55], a[108:111], v[96:99], v[52:55]
    s_waitcnt lgkmcnt(6)
    ds_write_b128 v171, v[40:43] offset:2048
    v_lshlrev_b32_sdwa v50, 1, v50 dst_sel:DWORD dst_unused:UNUSED_PAD src0_sel:DWORD src1_sel:WORD_1
    v_mul_f32_e64 v247, -v247, v249
    v_pk_fma_f32 v[146:147], v[146:147], v[248:249], v[246:247]
    v_mfma_f32_16x16x16_bf16 v[4:7], v[244:245], v[210:211], v[4:7]
    v_lshlrev_b32_sdwa v48, 1, v48 dst_sel:DWORD dst_unused:UNUSED_PAD src0_sel:DWORD src1_sel:WORD_1
    v_rcp_f16_sdwa v243, v243 dst_sel:WORD_1 dst_unused:UNUSED_PRESERVE src0_sel:WORD_1
    v_mfma_f32_16x16x16_bf16 v[20:23], v[244:245], v[218:219], v[20:23]
    ds_read2_b32 v[210:211], v225 offset0:40 offset1:60
    ds_read_u16_d16_hi v65, v65 offset:0
    v_mfma_f32_16x16x16_bf16 v[16:19], v[244:245], v[216:217], v[16:19]
    ds_write2_b32 v224, v178, v180 offset0:48 offset1:12
    v_mfma_f32_16x16x16_bf16 v[12:15], v[244:245], v[214:215], v[12:15]
    v_lshlrev_b32_sdwa v49, 1, v49 dst_sel:DWORD dst_unused:UNUSED_PAD src0_sel:DWORD src1_sel:WORD_1
    v_or_b32 v61, v62, v63
    v_lshlrev_b32_sdwa v54, 1, v54 dst_sel:DWORD dst_unused:UNUSED_PAD src0_sel:DWORD src1_sel:WORD_1
    v_fma_mix_f32 v71, v71, v243, 0 op_sel:[0,1,0] op_sel_hi:[0,1,0]
    v_mfma_f32_16x16x32_bf16 v[0:3], a[168:171], v[58:61], v[0:3]
    ds_read_u16 v74, v74 offset:0
    v_add_u32_sdwa v171, s8, v207 dst_sel:DWORD dst_unused:UNUSED_PAD src0_sel:DWORD src1_sel:WORD_1
    v_mfma_f32_16x16x32_bf16 v[4:7], a[172:175], v[58:61], v[4:7]
    ds_read2_b32 v[208:209], v225 offset0:0 offset1:20
    ds_write2_b32 v224, v181, v182 offset0:32 offset1:52
    v_lshlrev_b32_sdwa v79, 1, v79 dst_sel:DWORD dst_unused:UNUSED_PAD src0_sel:DWORD src1_sel:WORD_1
    v_pk_fma_f32 v[130:131], v[130:131], v[248:249], v[246:247]
    v_lshlrev_b32_sdwa v76, 1, v76 dst_sel:DWORD dst_unused:UNUSED_PAD src0_sel:DWORD src1_sel:WORD_1
    v_pk_fma_f32 v[150:151], v[150:151], v[248:249], v[246:247]
    v_pk_fma_f32 v[128:129], v[128:129], v[248:249], v[246:247]
    v_pk_fma_f32 v[166:167], v[166:167], v[248:249], v[246:247]
    v_pk_fma_f32 v[138:139], v[138:139], v[248:249], v[246:247]
    v_add_u32 v225, 1280, v225
    v_pk_fma_f32 v[132:133], v[132:133], v[248:249], v[246:247]
    v_pk_fma_f32 v[134:135], v[134:135], v[248:249], v[246:247]
    v_pk_fma_f32 v[124:125], v[124:125], v[248:249], v[246:247]
    v_pk_fma_f32 v[126:127], v[126:127], v[248:249], v[246:247]
    v_mfma_f32_16x16x32_bf16 v[8:11], a[176:179], v[58:61], v[8:11]
    ds_read_u16_d16_hi v73, v73 offset:0
    ds_read2_b32 v[214:215], v225 offset0:40 offset1:60
    ds_write2_b32 v224, v184, v185 offset0:16 offset1:36
    v_pk_fma_f32 v[136:137], v[136:137], v[248:249], v[246:247]
    v_pk_fma_f32 v[120:121], v[120:121], v[248:249], v[246:247]
    v_pk_fma_f32 v[148:149], v[148:149], v[248:249], v[246:247]
    v_pk_fma_f32 v[144:145], v[144:145], v[248:249], v[246:247]
    v_pk_fma_f32 v[122:123], v[122:123], v[248:249], v[246:247]
    v_mfma_f32_16x16x32_bf16 v[12:15], a[180:183], v[58:61], v[12:15]
    s_waitcnt lgkmcnt(7)
    v_or_b32 v66, v64, v65
    v_cvt_pk_bf16_f32 v136, v136, v138
    v_cvt_pk_bf16_f32 v120, v120, v122
    v_mfma_f32_16x16x32_bf16 v[16:19], a[184:187], v[58:61], v[16:19]
    ds_read_u16 v76, v76 offset:0
    v_cvt_pk_bf16_f32 v122, v128, v130
    v_fma_mix_f32 v70, v70, v243, 0 op_sel:[0,0,0] op_sel_hi:[0,1,0]
    v_mfma_f32_16x16x32_bf16 v[20:23], a[188:191], v[58:61], v[20:23]
    ds_read_u16 v78, v78 offset:0
    ds_read_u16 v48, v48 offset:0
    v_lshlrev_b32_sdwa v55, 1, v55 dst_sel:DWORD dst_unused:UNUSED_PAD src0_sel:DWORD src1_sel:WORD_1
    v_mfma_f32_16x16x32_bf16 v[56:59], a[120:123], v[96:99], 0
    ds_write_b32 v224, v186 offset:224
    v_cvt_pk_bf16_f32 v128, v121, v123
    v_mfma_f32_16x16x32_bf16 v[56:59], a[124:127], v[100:103], v[56:59]
    ds_read2_b32 v[212:213], v225 offset0:0 offset1:20
    v_cvt_pk_bf16_f32 v130, v129, v131
    v_mfma_f32_16x16x32_bf16 v[56:59], a[128:131], v[104:107], v[56:59]
    ds_read_u16 v54, v54 offset:0
    v_or_b32_e64 v68, v68, v69
    v_mfma_f32_16x16x32_bf16 v[60:63], a[140:143], v[104:107], 0
    v_cvt_pk_bf16_f32 v123, v132, v134
    v_lshlrev_b32_sdwa v52, 1, v52 dst_sel:DWORD dst_unused:UNUSED_PAD src0_sel:DWORD src1_sel:WORD_1
    v_mfma_f32_16x16x32_bf16 v[60:63], a[136:139], v[100:103], v[60:63]
    s_cmp_ge_u32 s55, 109716
    ds_read_u16_d16_hi v49, v49 offset:0
    v_cvt_pk_bf16_f32 v121, v124, v126
    v_cvt_pk_bf16_f32 v138, v144, v146
    v_mfma_f32_16x16x32_bf16 v[60:63], a[132:135], v[96:99], v[60:63]
    ds_write_b128 v171, v[120:123] offset:0
    v_add_u32_sdwa v224, s55, v207 dst_sel:DWORD dst_unused:UNUSED_PAD src0_sel:DWORD src1_sel:WORD_0
    v_pk_fma_f32 v[142:143], v[142:143], v[248:249], v[246:247]
    v_cvt_pk_bf16_f32 v69, v70, v71
    v_lshlrev_b32_sdwa v51, 1, v51 dst_sel:DWORD dst_unused:UNUSED_PAD src0_sel:DWORD src1_sel:WORD_1
    v_pk_fma_f32 v[160:161], v[160:161], v[248:249], v[246:247]
    v_pk_fma_f32 v[154:155], v[154:155], v[248:249], v[246:247]
    v_pk_fma_f32 v[156:157], v[156:157], v[248:249], v[246:247]
    v_mfma_f32_16x16x32_bf16 v[0:3], a[192:195], v[66:69], v[0:3]
    ds_read_u16_d16_hi v79, v79 offset:0
    ds_read_u16 v50, v50 offset:0
    v_mfma_f32_16x16x32_bf16 v[4:7], a[196:199], v[66:69], v[4:7]
    v_cvt_pk_bf16_f32 v131, v133, v135
    v_cvt_pk_bf16_f32 v129, v125, v127
    v_mfma_f32_16x16x32_bf16 v[8:11], a[200:203], v[66:69], v[8:11]
    ds_write_b128 v171, v[128:131] offset:512
    v_pk_fma_f32 v[152:153], v[152:153], v[248:249], v[246:247]
    v_pk_fma_f32 v[140:141], v[140:141], v[248:249], v[246:247]
    v_pk_fma_f32 v[158:159], v[158:159], v[248:249], v[246:247]
    v_mfma_f32_16x16x32_bf16 v[12:15], a[204:207], v[66:69], v[12:15]
    v_lshlrev_b32_sdwa v53, 1, v53 dst_sel:DWORD dst_unused:UNUSED_PAD src0_sel:DWORD src1_sel:WORD_1
    v_cvt_pk_bf16_f32 v152, v152, v154
    v_mfma_f32_16x16x32_bf16 v[16:19], a[208:211], v[66:69], v[16:19]
    ds_read_u16_d16_hi v51, v51 offset:0
    ds_read_u16 v72, v72 offset:0
    v_mfma_f32_16x16x32_bf16 v[20:23], a[212:215], v[66:69], v[20:23]
    s_waitcnt vmcnt(0) lgkmcnt(12)
    ds_write2_b32 v224, v190, v192 offset0:40 offset1:4
    v_mfma_f32_16x16x16_bf16 v[28:31], v[244:245], v[222:223], 0
    v_lshlrev_b32_sdwa v59, 1, v59 dst_sel:DWORD dst_unused:UNUSED_PAD src0_sel:DWORD src1_sel:WORD_1
    v_cvt_pk_bf16_f32 v146, v145, v147
    v_cvt_pk_bf16_f32 v144, v137, v139
    v_lshlrev_b32_sdwa v56, 1, v56 dst_sel:DWORD dst_unused:UNUSED_PAD src0_sel:DWORD src1_sel:WORD_1
    v_mfma_f32_16x16x16_bf16 v[44:47], v[244:245], v[214:215], 0
    ds_read_u16_d16_hi v55, v55 offset:0
    ds_read_u16_d16_hi v53, v53 offset:0
    v_mfma_f32_16x16x16_bf16 v[32:35], v[244:245], v[208:209], 0
    v_cvt_pk_f16_f32 v242, v62, v63
    v_lshlrev_b32_sdwa v58, 1, v58 dst_sel:DWORD dst_unused:UNUSED_PAD src0_sel:DWORD src1_sel:WORD_1
    v_pk_fma_f16 v243, v242, v242, s48
    v_or_b32 v76, v76, v77
    v_mfma_f32_16x16x32_bf16 v[64:67], a[0:3], v[108:111], 0
    ds_write2_b32 v224, v188, v189 offset0:0 offset1:20
    v_mfma_f32_16x16x32_bf16 v[64:67], a[4:7], v[112:115], v[64:67]
    v_lshlrev_b32_sdwa v57, 1, v57 dst_sel:DWORD dst_unused:UNUSED_PAD src0_sel:DWORD src1_sel:WORD_1
    v_cvt_pk_bf16_f32 v139, v148, v150
    v_cvt_pk_bf16_f32 v137, v140, v142
    v_mfma_f32_16x16x32_bf16 v[64:67], a[8:11], v[116:119], v[64:67]
    s_cselect_b32 s56, s99, 0
    ds_read_u16 v56, v56 offset:0
    v_or_b32 v75, v74, v75
    v_mfma_f32_16x16x32_bf16 v[68:71], a[20:23], v[116:119], 0
    ds_write_b128 v171, v[136:139] offset:2048
    v_pk_fma_f32 v[162:163], v[162:163], v[248:249], v[246:247]
    v_pk_fma_f32 v[164:165], v[164:165], v[248:249], v[246:247]
    v_cvt_pk_bf16_f32 v145, v141, v143
    v_mfma_f32_16x16x32_bf16 v[68:71], a[16:19], v[112:115], v[68:71]
    v_xor_b32 v255, 800, v255
    v_lshlrev_b32_sdwa v64, 1, v64 dst_sel:DWORD dst_unused:UNUSED_PAD src0_sel:DWORD src1_sel:WORD_1
    v_mfma_f32_16x16x32_bf16 v[68:71], a[12:15], v[108:111], v[68:71]
    s_waitcnt lgkmcnt(6)
    ds_read_u16 v52, v52 offset:0
    ds_read_u16_d16_hi v59, v59 offset:0
    ds_write2_b32 v224, v193, v194 offset0:24 offset1:44
    v_mfma_f32_16x16x16_bf16 v[24:27], v[244:245], v[220:221], 0
    v_or_b32 v77, v78, v79
    v_or_b32_e64 v51, v50, v51
    v_cvt_pk_bf16_f32 v154, v160, v162
    v_mfma_f32_16x16x16_bf16 v[40:43], v[244:245], v[212:213], 0
    v_lshlrev_b32_sdwa v68, 1, v68 dst_sel:DWORD dst_unused:UNUSED_PAD src0_sel:DWORD src1_sel:WORD_1
    v_cvt_pk_bf16_f32 v147, v149, v151
    v_mov_b64 v[96:97], 0
    v_or_b32 v74, v72, v73
    v_mfma_f32_16x16x16_bf16 v[36:39], v[244:245], v[210:211], 0
    v_lshlrev_b32_sdwa v60, 1, v60 dst_sel:DWORD dst_unused:UNUSED_PAD src0_sel:DWORD src1_sel:WORD_1
    v_lshlrev_b32_sdwa v67, 1, v67 dst_sel:DWORD dst_unused:UNUSED_PAD src0_sel:DWORD src1_sel:WORD_1
    v_pk_mul_f16 v243, v242, v243 neg_lo:[1,0] neg_hi:[1,0]
    v_mfma_f32_32x32x8_bf16 v[120:135], v[96:97], v[96:97], 0
    ds_read_u16_d16_hi v57, v57 offset:0
    ds_write_b128 v171, v[144:147] offset:2560
    v_lshlrev_b32_sdwa v66, 1, v66 dst_sel:DWORD dst_unused:UNUSED_PAD src0_sel:DWORD src1_sel:WORD_1
    v_lshlrev_b32_sdwa v61, 1, v61 dst_sel:DWORD dst_unused:UNUSED_PAD src0_sel:DWORD src1_sel:WORD_1
    v_mfma_f32_16x16x32_bf16 v[0:3], a[216:219], v[74:77], v[0:3]
    v_lshlrev_b32_sdwa v65, 1, v65 dst_sel:DWORD dst_unused:UNUSED_PAD src0_sel:DWORD src1_sel:WORD_1
    v_cvt_pk_bf16_f32 v160, v153, v155
    v_mfma_f32_16x16x32_bf16 v[4:7], a[220:223], v[74:77], v[4:7]
    ds_read_u16_d16_hi v61, v61 offset:0
    v_lshlrev_b32_sdwa v69, 1, v69 dst_sel:DWORD dst_unused:UNUSED_PAD src0_sel:DWORD src1_sel:WORD_1
    v_mfma_f32_16x16x32_bf16 v[8:11], a[224:227], v[74:77], v[8:11]
    ds_read_u16 v66, v66 offset:0
    v_or_b32_e64 v50, v48, v49
    v_mfma_f32_16x16x32_bf16 v[12:15], a[228:231], v[74:77], v[12:15]
    ds_write2_b32 v224, v196, v197 offset0:8 offset1:28
    v_mfma_f32_16x16x32_bf16 v[16:19], a[232:235], v[74:77], v[16:19]
    v_exp_f16_sdwa v243, v243 dst_sel:WORD_0 dst_unused:UNUSED_PRESERVE src0_sel:WORD_0
    v_mfma_f32_16x16x32_bf16 v[20:23], a[236:239], v[74:77], v[20:23]
    ds_read_u16_d16_hi v67, v67 offset:0
    v_lshlrev_b32_sdwa v70, 1, v70 dst_sel:DWORD dst_unused:UNUSED_PAD src0_sel:DWORD src1_sel:WORD_1
    v_mfma_f32_16x16x32_bf16 v[72:75], a[24:27], v[108:111], 0
    s_waitcnt lgkmcnt(8)
    ds_read_u16 v60, v60 offset:0
    ds_read_u16 v58, v58 offset:0
    v_or_b32 v52, v52, v53
    v_mfma_f32_16x16x32_bf16 v[72:75], a[28:31], v[112:115], v[72:75]
    s_add_u32 s55, s55, s56
    ds_write2_b32 v224, v201, v202 offset0:32 offset1:52
    v_or_b32 v53, v54, v55
    v_lshlrev_b32_sdwa v71, 1, v71 dst_sel:DWORD dst_unused:UNUSED_PAD src0_sel:DWORD src1_sel:WORD_1
    v_mfma_f32_16x16x32_bf16 v[72:75], a[32:35], v[116:119], v[72:75]
    ds_read_u16 v68, v68 offset:0
    v_cvt_pk_bf16_f32 v155, v164, v166
    v_mfma_f32_16x16x32_bf16 v[76:79], a[44:47], v[116:119], 0
    v_exp_f16_sdwa v243, v243 dst_sel:WORD_1 dst_unused:UNUSED_PRESERVE src0_sel:WORD_1
    v_mfma_f32_16x16x32_bf16 v[76:79], a[40:43], v[112:115], v[76:79]
    s_add_u32 s55, s55, 31488
    v_pk_fma_f16 v243, v243, s50, s50
    v_cvt_pk_bf16_f32 v162, v161, v163
    v_mfma_f32_16x16x32_bf16 v[76:79], a[36:39], v[108:111], v[76:79]
    ds_read_u16_d16_hi v65, v65 offset:0
    v_rcp_f16_sdwa v243, v243 dst_sel:WORD_0 dst_unused:UNUSED_PRESERVE src0_sel:WORD_0
    v_mfma_f32_32x32x8_bf16 v[136:151], v[96:97], v[96:97], 0
    ds_read_u16 v64, v64 offset:0
    ds_write2_b32 v224, v198, v200 offset0:48 offset1:12
    v_lshlrev_b32_sdwa v72, 1, v72 dst_sel:DWORD dst_unused:UNUSED_PAD src0_sel:DWORD src1_sel:WORD_1
    v_rcp_f16_sdwa v243, v243 dst_sel:WORD_1 dst_unused:UNUSED_PRESERVE src0_sel:WORD_1
    v_mfma_f32_16x16x32_bf16 v[0:3], a[240:243], v[50:53], v[0:3]
    ds_read_u16 v70, v70 offset:0
    v_cvt_pk_bf16_f32 v161, v157, v159
    v_mfma_f32_16x16x32_bf16 v[4:7], a[244:247], v[50:53], v[4:7]
    v_cvt_pk_bf16_f32 v153, v156, v158
    v_cvt_pk_bf16_f32 v163, v165, v167
    v_mfma_f32_16x16x32_bf16 v[8:11], a[248:251], v[50:53], v[8:11]
    ds_read_u16_d16_hi v71, v71 offset:0
    ds_read_u16_d16_hi v69, v69 offset:0
    v_mfma_f32_16x16x32_bf16 v[12:15], a[252:255], v[50:53], v[12:15]
    s_waitcnt lgkmcnt(8)
    v_lshlrev_b32_sdwa v75, 1, v75 dst_sel:DWORD dst_unused:UNUSED_PAD src0_sel:DWORD src1_sel:WORD_1
    v_or_b32 v59, v58, v59
    v_add_u32_e64 v195, 1, v195
    v_lshlrev_b32_sdwa v79, 1, v79 dst_sel:DWORD dst_unused:UNUSED_PAD src0_sel:DWORD src1_sel:WORD_1
    v_mfma_f32_16x16x32_bf16 v[16:19], v[226:229], v[50:53], v[16:19]
    v_lshlrev_b32_sdwa v73, 1, v73 dst_sel:DWORD dst_unused:UNUSED_PAD src0_sel:DWORD src1_sel:WORD_1
    v_lshlrev_b32_sdwa v76, 1, v76 dst_sel:DWORD dst_unused:UNUSED_PAD src0_sel:DWORD src1_sel:WORD_1
    v_mfma_f32_16x16x32_bf16 v[20:23], v[230:233], v[50:53], v[20:23]
    ds_read_u16_d16_hi v75, v75 offset:0
    v_fma_mix_f32 v62, v62, v243, 0 op_sel:[0,0,0] op_sel_hi:[0,1,0]
    v_mfma_f32_16x16x32_bf16 v[48:51], a[48:51], v[108:111], 0
    ds_write_b128 v171, v[152:155] offset:4096
    v_mfma_f32_16x16x32_bf16 v[48:51], a[52:55], v[112:115], v[48:51]
    v_or_b32_e64 v60, v60, v61
    v_lshlrev_b32_sdwa v74, 1, v74 dst_sel:DWORD dst_unused:UNUSED_PAD src0_sel:DWORD src1_sel:WORD_1
    v_mfma_f32_16x16x32_bf16 v[48:51], a[56:59], v[116:119], v[48:51]
    v_fma_mix_f32 v63, v63, v243, 0 op_sel:[0,1,0] op_sel_hi:[0,1,0]
    v_lshlrev_b32_sdwa v77, 1, v77 dst_sel:DWORD dst_unused:UNUSED_PAD src0_sel:DWORD src1_sel:WORD_1
    v_mfma_f32_16x16x32_bf16 v[52:55], a[68:71], v[116:119], 0
    ds_read_u16 v72, v72 offset:0
    ds_write_b128 v171, v[160:163] offset:4608
    v_mfma_f32_16x16x32_bf16 v[52:55], a[64:67], v[112:115], v[52:55]
    v_cvt_pk_bf16_f32 v61, v62, v63
    v_or_b32_e64 v58, v56, v57
    v_mfma_f32_16x16x32_bf16 v[52:55], a[60:63], v[108:111], v[52:55]
    v_lshlrev_b32_sdwa v78, 1, v78 dst_sel:DWORD dst_unused:UNUSED_PAD src0_sel:DWORD src1_sel:WORD_1
    v_or_b32_e64 v67, v66, v67
    v_mfma_f32_16x16x32_bf16 v[0:3], v[234:237], v[58:61], v[0:3]
    s_waitcnt lgkmcnt(4)
    ds_read_u16 v74, v74 offset:0
    v_or_b32 v68, v68, v69
    v_mfma_f32_16x16x32_bf16 v[4:7], v[238:241], v[58:61], v[4:7]
    ds_read_u16_d16_hi v79, v79 offset:0
    v_lshlrev_b32_sdwa v52, 1, v52 dst_sel:DWORD dst_unused:UNUSED_PAD src0_sel:DWORD src1_sel:WORD_1
    v_mfma_f32_16x16x32_bf16 v[8:11], v[80:83], v[58:61], v[8:11]
    ds_write2_b32 v224, v204, v205 offset0:16 offset1:36
    v_mfma_f32_16x16x32_bf16 v[12:15], v[84:87], v[58:61], v[12:15]
    v_or_b32_e64 v69, v70, v71
    v_lshlrev_b32_sdwa v48, 1, v48 dst_sel:DWORD dst_unused:UNUSED_PAD src0_sel:DWORD src1_sel:WORD_1
    v_mfma_f32_16x16x32_bf16 v[16:19], v[88:91], v[58:61], v[16:19]
    ds_read_u16_d16_hi v77, v77 offset:0
    ds_read_u16 v78, v78 offset:0
    v_mfma_f32_16x16x32_bf16 v[20:23], v[92:95], v[58:61], v[20:23]
    ds_write_b32 v224, v206 offset:224
    v_mfma_f32_32x32x8_bf16 v[152:167], v[96:97], v[96:97], 0
    ds_write_b32 v191, v195
    v_cvt_pk_bf16_f32 v8, v8, v9
    v_lshlrev_b32_sdwa v50, 1, v50 dst_sel:DWORD dst_unused:UNUSED_PAD src0_sel:DWORD src1_sel:WORD_1
    v_lshlrev_b32_sdwa v51, 1, v51 dst_sel:DWORD dst_unused:UNUSED_PAD src0_sel:DWORD src1_sel:WORD_1
    v_cvt_pk_f16_f32 v242, v54, v55
    v_add_u32_e64 v171, s96, v203
    v_cvt_pk_bf16_f32 v0, v0, v1
    v_mfma_f32_16x16x32_bf16 v[56:59], a[72:75], v[108:111], 0
    ds_read_u16_d16_hi v73, v73 offset:0
    v_pk_fma_f16 v243, v242, v242, s48
    v_mfma_f32_16x16x32_bf16 v[56:59], a[76:79], v[112:115], v[56:59]
    ds_read_u16_d16_hi v51, v51 offset:0
    v_pk_mul_f16 v243, v242, v243 neg_lo:[1,0] neg_hi:[1,0]
    v_mfma_f32_16x16x32_bf16 v[56:59], a[80:83], v[116:119], v[56:59]
    v_cvt_pk_bf16_f32 v1, v2, v3
    v_lshlrev_b32_sdwa v53, 1, v53 dst_sel:DWORD dst_unused:UNUSED_PAD src0_sel:DWORD src1_sel:WORD_1
    v_mfma_f32_16x16x32_bf16 v[60:63], a[92:95], v[116:119], 0
    ds_read_u16_d16_hi v53, v53 offset:0
    v_cvt_pk_bf16_f32 v3, v6, v7
    v_mfma_f32_16x16x32_bf16 v[60:63], a[88:91], v[112:115], v[60:63]
    s_waitcnt lgkmcnt(9)
    ds_read_u16 v76, v76 offset:0
    v_or_b32 v66, v64, v65
    v_lshlrev_b32_sdwa v57, 1, v57 dst_sel:DWORD dst_unused:UNUSED_PAD src0_sel:DWORD src1_sel:WORD_1
    v_or_b32_e64 v75, v74, v75
    v_mfma_f32_16x16x32_bf16 v[60:63], a[84:87], v[108:111], v[60:63]
    v_cvt_pk_bf16_f32 v2, v4, v5
    v_lshlrev_b32_sdwa v58, 1, v58 dst_sel:DWORD dst_unused:UNUSED_PAD src0_sel:DWORD src1_sel:WORD_1
    v_mfma_f32_16x16x32_bf16 v[24:27], a[144:147], v[66:69], v[24:27]
    ds_read_u16 v52, v52 offset:0
    ds_read_u16 v50, v50 offset:0
    v_mfma_f32_16x16x32_bf16 v[28:31], a[148:151], v[66:69], v[28:31]
    buffer_store_dwordx4 v[0:3], v187, s[20:23], s44 offen offset:0 sc1
    ds_read_u16 v48, v48 offset:0
    v_lshlrev_b32_sdwa v59, 1, v59 dst_sel:DWORD dst_unused:UNUSED_PAD src0_sel:DWORD src1_sel:WORD_1
    v_exp_f16_sdwa v243, v243 dst_sel:WORD_0 dst_unused:UNUSED_PRESERVE src0_sel:WORD_0
    v_lshlrev_b32_sdwa v62, 1, v62 dst_sel:DWORD dst_unused:UNUSED_PAD src0_sel:DWORD src1_sel:WORD_1
    v_mfma_f32_16x16x32_bf16 v[32:35], a[152:155], v[66:69], v[32:35]
    v_lshlrev_b32_sdwa v61, 1, v61 dst_sel:DWORD dst_unused:UNUSED_PAD src0_sel:DWORD src1_sel:WORD_1
    v_lshlrev_b32_sdwa v49, 1, v49 dst_sel:DWORD dst_unused:UNUSED_PAD src0_sel:DWORD src1_sel:WORD_1
    v_mfma_f32_16x16x32_bf16 v[36:39], a[156:159], v[66:69], v[36:39]
    v_exp_f16_sdwa v243, v243 dst_sel:WORD_1 dst_unused:UNUSED_PRESERVE src0_sel:WORD_1
    v_mfma_f32_16x16x32_bf16 v[40:43], a[160:163], v[66:69], v[40:43]
    ds_read_addtid_b32 v199 offset:5120
    ds_read_u16_d16_hi v57, v57 offset:0
    v_mfma_f32_16x16x32_bf16 v[44:47], a[164:167], v[66:69], v[44:47]
    v_pk_fma_f16 v243, v243, s50, s50
    v_cvt_pk_bf16_f32 v9, v10, v11
    v_mfma_f32_16x16x32_bf16 v[64:67], a[96:99], v[108:111], 0
    ds_read_u16_d16_hi v61, v61 offset:0
    ds_read_u16_d16_hi v49, v49 offset:0
    v_lshlrev_b32_sdwa v60, 1, v60 dst_sel:DWORD dst_unused:UNUSED_PAD src0_sel:DWORD src1_sel:WORD_1
    v_mfma_f32_16x16x32_bf16 v[64:67], a[100:103], v[112:115], v[64:67]
    s_waitcnt lgkmcnt(7)
    v_or_b32 v74, v72, v73
    v_lshlrev_b32_sdwa v63, 1, v63 dst_sel:DWORD dst_unused:UNUSED_PAD src0_sel:DWORD src1_sel:WORD_1
    v_or_b32_e64 v76, v76, v77
    v_mfma_f32_16x16x32_bf16 v[64:67], a[104:107], v[116:119], v[64:67]
    ds_read_u16 v58, v58 offset:0
    v_lshlrev_b32_sdwa v56, 1, v56 dst_sel:DWORD dst_unused:UNUSED_PAD src0_sel:DWORD src1_sel:WORD_1
    v_mfma_f32_16x16x32_bf16 v[68:71], a[116:119], v[116:119], 0
    ds_read_u16_d16_hi v63, v63 offset:0
    v_or_b32_e64 v77, v78, v79
    v_mfma_f32_16x16x32_bf16 v[68:71], a[112:115], v[112:115], v[68:71]
    v_rcp_f16_sdwa v243, v243 dst_sel:WORD_0 dst_unused:UNUSED_PRESERVE src0_sel:WORD_0
    v_mfma_f32_16x16x32_bf16 v[68:71], a[108:111], v[108:111], v[68:71]
    ds_read_u16 v62, v62 offset:0
    v_lshlrev_b32_sdwa v66, 1, v66 dst_sel:DWORD dst_unused:UNUSED_PAD src0_sel:DWORD src1_sel:WORD_1
    v_mfma_f32_16x16x32_bf16 v[24:27], a[168:171], v[74:77], v[24:27]
    s_waitcnt lgkmcnt(6)
    ds_read_u16 v60, v60 offset:0
    v_cmp_lt_u32 vcc, v199, v195
    v_mfma_f32_16x16x32_bf16 v[28:31], a[172:175], v[74:77], v[28:31]
    v_rcp_f16_sdwa v243, v243 dst_sel:WORD_1 dst_unused:UNUSED_PRESERVE src0_sel:WORD_1
    v_mfma_f32_16x16x32_bf16 v[32:35], a[176:179], v[74:77], v[32:35]
    ds_read_u16 v56, v56 offset:0
    ds_read_u16 v66, v66 offset:0
    v_mfma_f32_16x16x32_bf16 v[36:39], a[180:183], v[74:77], v[36:39]
    s_cbranch_vccnz L_retry6
L_back6:
    v_lshlrev_b32_sdwa v68, 1, v68 dst_sel:DWORD dst_unused:UNUSED_PAD src0_sel:DWORD src1_sel:WORD_1
    v_mfma_f32_16x16x32_bf16 v[40:43], a[184:187], v[74:77], v[40:43]
    s_nop 0
    ds_read_u16_d16_hi v59, v59 offset:0
    v_fma_mix_f32 v54, v54, v243, 0 op_sel:[0,0,0] op_sel_hi:[0,1,0]
    v_mfma_f32_16x16x32_bf16 v[44:47], a[188:191], v[74:77], v[44:47]
    ds_read_b128 v[216:219], v171 offset:0
    v_or_b32_e64 v52, v52, v53
    v_mfma_f32_16x16x32_bf16 v[72:75], a[120:123], v[108:111], 0
    v_lshlrev_b32_sdwa v64, 1, v64 dst_sel:DWORD dst_unused:UNUSED_PAD src0_sel:DWORD src1_sel:WORD_1
    v_or_b32_e64 v51, v50, v51
    v_mfma_f32_16x16x32_bf16 v[72:75], a[124:127], v[112:115], v[72:75]
    ds_read_b128 v[220:223], v171 offset:1024
    v_lshlrev_b32_sdwa v70, 1, v70 dst_sel:DWORD dst_unused:UNUSED_PAD src0_sel:DWORD src1_sel:WORD_1
    v_mfma_f32_16x16x32_bf16 v[72:75], a[128:131], v[116:119], v[72:75]
    ds_read_u16 v70, v70 offset:0
    v_fma_mix_f32 v55, v55, v243, 0 op_sel:[0,1,0] op_sel_hi:[0,1,0]
    v_mfma_f32_16x16x32_bf16 v[76:79], a[140:143], v[116:119], 0
    v_cvt_pk_bf16_f32 v11, v14, v15
    v_lshlrev_b32_sdwa v67, 1, v67 dst_sel:DWORD dst_unused:UNUSED_PAD src0_sel:DWORD src1_sel:WORD_1
    v_mfma_f32_16x16x32_bf16 v[76:79], a[136:139], v[112:115], v[76:79]
    s_waitcnt lgkmcnt(10)
    ds_read_u16_d16_hi v67, v67 offset:0
    v_cvt_pk_bf16_f32 v53, v54, v55
    v_or_b32 v50, v48, v49
    v_mfma_f32_16x16x32_bf16 v[76:79], a[132:135], v[108:111], v[76:79]
    ds_read_b128 v[100:103], v255 offset:8192
    ds_read_b128 v[208:211], v171 offset:2048
    v_mfma_f32_16x16x32_bf16 v[24:27], a[192:195], v[50:53], v[24:27]
    ds_read_b128 v[96:99], v255 offset:0
    v_lshlrev_b32_sdwa v65, 1, v65 dst_sel:DWORD dst_unused:UNUSED_PAD src0_sel:DWORD src1_sel:WORD_1
    v_mfma_f32_16x16x32_bf16 v[28:31], a[196:199], v[50:53], v[28:31]
    ds_read_u16 v64, v64 offset:0
    v_cvt_pk_bf16_f32 v10, v12, v13
    v_mfma_f32_16x16x32_bf16 v[32:35], a[200:203], v[50:53], v[32:35]
    ds_read_b128 v[104:107], v255 offset:16384
    v_xor_b32 v255, 288, v255
    v_mfma_f32_16x16x32_bf16 v[36:39], a[204:207], v[50:53], v[36:39]
    v_lshlrev_b32_sdwa v69, 1, v69 dst_sel:DWORD dst_unused:UNUSED_PAD src0_sel:DWORD src1_sel:WORD_1
    v_cvt_pk_f16_f32 v242, v78, v79
    v_mfma_f32_16x16x32_bf16 v[40:43], a[208:211], v[50:53], v[40:43]
    v_lshlrev_b32_sdwa v74, 1, v74 dst_sel:DWORD dst_unused:UNUSED_PAD src0_sel:DWORD src1_sel:WORD_1
    v_lshlrev_b32_sdwa v75, 1, v75 dst_sel:DWORD dst_unused:UNUSED_PAD src0_sel:DWORD src1_sel:WORD_1
    v_mfma_f32_16x16x32_bf16 v[44:47], a[212:215], v[50:53], v[44:47]
    s_waitcnt lgkmcnt(7)
    ds_read_u16 v74, v74 offset:0
    v_or_b32 v60, v60, v61
    v_or_b32 v59, v58, v59
    v_or_b32 v58, v56, v57
    v_mfma_f32_16x16x16_bf16 v[32:35], v[244:245], v[220:221], v[32:35]
    ds_read_u16_d16_hi v69, v69 offset:0
    ds_read_u16 v68, v68 offset:0
    v_mfma_f32_16x16x16_bf16 v[36:39], v[244:245], v[222:223], v[36:39]
    buffer_store_dwordx4 v[8:11], v187, s[20:23], s44 offen offset:64 sc1
    ds_read_u16_d16_hi v65, v65 offset:0
    v_or_b32_e64 v61, v62, v63
    v_lshlrev_b32_sdwa v71, 1, v71 dst_sel:DWORD dst_unused:UNUSED_PAD src0_sel:DWORD src1_sel:WORD_1
    v_pk_fma_f16 v243, v242, v242, s48
    v_mfma_f32_16x16x16_bf16 v[28:31], v[244:245], v[218:219], v[28:31]
    ds_read_u16_d16_hi v71, v71 offset:0
    v_lshlrev_b32_sdwa v72, 1, v72 dst_sel:DWORD dst_unused:UNUSED_PAD src0_sel:DWORD src1_sel:WORD_1
    v_mfma_f32_16x16x16_bf16 v[24:27], v[244:245], v[216:217], v[24:27]
    s_waitcnt lgkmcnt(1)
.p2align 6
L_loop:
    v_mfma_f32_16x16x16_bf16 v[40:43], v[244:245], v[208:209], v[40:43]
    ds_read_b128 v[220:223], v253 offset:0
    v_lshlrev_b32_sdwa v73, 1, v73 dst_sel:DWORD dst_unused:UNUSED_PAD src0_sel:DWORD src1_sel:WORD_1
    v_pk_mul_f16 v243, v242, v243 neg_lo:[1,0] neg_hi:[1,0]
    v_mfma_f32_16x16x16_bf16 v[44:47], v[244:245], v[210:211], v[44:47]
    ds_read_b128 v[108:111], v255 offset:0
    ds_read_b128 v[216:219], v252 offset:0
    v_lshlrev_b32_sdwa v76, 1, v76 dst_sel:DWORD dst_unused:UNUSED_PAD src0_sel:DWORD src1_sel:WORD_1
    v_mfma_f32_16x16x32_bf16 v[48:51], a[0:3], v[96:99], 0
    s_waitcnt lgkmcnt(7)
    ds_read_b128 v[212:215], v251 offset:0
    ds_read_b64 v[224:225], v254 offset:0
    v_mfma_f32_16x16x32_bf16 v[48:51], a[4:7], v[100:103], v[48:51]
    v_exp_f16_sdwa v243, v243 dst_sel:WORD_0 dst_unused:UNUSED_PRESERVE src0_sel:WORD_0
    v_mfma_f32_16x16x32_bf16 v[48:51], a[8:11], v[104:107], v[48:51]
    s_waitcnt lgkmcnt(7)
    ds_read_b128 v[208:211], v250 offset:0
    v_or_b32_e64 v68, v68, v69
    v_mfma_f32_16x16x32_bf16 v[52:55], a[20:23], v[104:107], 0
    s_cmp_lt_u32 s46, s54
    ds_read_u16_d16_hi v73, v73 offset:0
    ds_read_u16 v72, v72 offset:0
    v_mfma_f32_16x16x32_bf16 v[52:55], a[16:19], v[100:103], v[52:55]
    s_nop 0
    v_lshlrev_b32_sdwa v49, 1, v49 dst_sel:DWORD dst_unused:UNUSED_PAD src0_sel:DWORD src1_sel:WORD_1
    v_lshlrev_b32_sdwa v48, 1, v48 dst_sel:DWORD dst_unused:UNUSED_PAD src0_sel:DWORD src1_sel:WORD_1
    v_mfma_f32_16x16x32_bf16 v[52:55], a[12:15], v[96:99], v[52:55]
    v_lshlrev_b32_sdwa v51, 1, v51 dst_sel:DWORD dst_unused:UNUSED_PAD src0_sel:DWORD src1_sel:WORD_1
    v_lshlrev_b32_sdwa v77, 1, v77 dst_sel:DWORD dst_unused:UNUSED_PAD src0_sel:DWORD src1_sel:WORD_1
    v_mfma_f32_16x16x32_bf16 v[24:27], a[216:219], v[58:61], v[24:27]
    s_cselect_b32 s18, 98304, 0
    ds_read_u16 v76, v76 offset:0
    v_or_b32_e64 v67, v66, v67
    v_mfma_f32_16x16x32_bf16 v[28:31], a[220:223], v[58:61], v[28:31]
    ds_read_u16_d16_hi v77, v77 offset:0
    v_cvt_pk_bf16_f32 v16, v16, v17
    v_mfma_f32_16x16x32_bf16 v[32:35], a[224:227], v[58:61], v[32:35]
    v_or_b32_e64 v66, v64, v65
    v_lshlrev_b32_sdwa v55, 1, v55 dst_sel:DWORD dst_unused:UNUSED_PAD src0_sel:DWORD src1_sel:WORD_1
    v_mfma_f32_16x16x32_bf16 v[36:39], a[228:231], v[58:61], v[36:39]
    v_exp_f16_sdwa v243, v243 dst_sel:WORD_1 dst_unused:UNUSED_PRESERVE src0_sel:WORD_1
    v_mfma_f32_16x16x32_bf16 v[40:43], a[232:235], v[58:61], v[40:43]
    buffer_load_dwordx3 v[168:170], v179, s[16:19], 0 offen nt
    ds_read_u16_d16_hi v75, v75 offset:0
    v_mfma_f32_16x16x32_bf16 v[44:47], a[236:239], v[58:61], v[44:47]
    s_waitcnt lgkmcnt(5)
    v_lshlrev_b32_sdwa v53, 1, v53 dst_sel:DWORD dst_unused:UNUSED_PAD src0_sel:DWORD src1_sel:WORD_1
    v_lshlrev_b32_sdwa v54, 1, v54 dst_sel:DWORD dst_unused:UNUSED_PAD src0_sel:DWORD src1_sel:WORD_1
    v_smfmac_f32_16x16x64_bf16 v[120:123], v[220:223], v[208:215], v175
    s_nop 0
    ds_read_u16_d16_hi v51, v51 offset:0
    ds_read_b128 v[208:211], v250 offset:80
    v_mfma_f32_16x16x32_bf16 v[56:59], a[24:27], v[96:99], 0
    v_pk_fma_f16 v243, v243, s50, s50
    v_lshlrev_b32_sdwa v50, 1, v50 dst_sel:DWORD dst_unused:UNUSED_PAD src0_sel:DWORD src1_sel:WORD_1
    v_mfma_f32_16x16x32_bf16 v[56:59], a[28:31], v[100:103], v[56:59]
    ds_read_b128 v[116:119], v255 offset:16384
    v_cvt_pk_bf16_f32 v17, v18, v19
    v_mfma_f32_16x16x32_bf16 v[56:59], a[32:35], v[104:107], v[56:59]
    ds_read_u16 v54, v54 offset:0
    v_mfma_f32_16x16x32_bf16 v[60:63], a[44:47], v[104:107], 0
    ds_read_b128 v[212:215], v251 offset:80
    v_or_b32_e64 v69, v70, v71
    v_mfma_f32_16x16x32_bf16 v[60:63], a[40:43], v[100:103], v[60:63]
    v_rcp_f16_sdwa v243, v243 dst_sel:WORD_0 dst_unused:UNUSED_PRESERVE src0_sel:WORD_0
    v_mfma_f32_16x16x32_bf16 v[60:63], a[36:39], v[96:99], v[60:63]
    ds_read_u16 v48, v48 offset:0
    v_cvt_pk_bf16_f32 v19, v22, v23
    v_lshlrev_b32_sdwa v59, 1, v59 dst_sel:DWORD dst_unused:UNUSED_PAD src0_sel:DWORD src1_sel:WORD_1
    v_smfmac_f32_16x16x32_bf16 v[120:123], v[224:225], v[216:219], v175
    ds_read_u16 v50, v50 offset:0
    ds_read_b128 v[216:219], v252 offset:80
    v_lshlrev_b32_sdwa v56, 1, v56 dst_sel:DWORD dst_unused:UNUSED_PAD src0_sel:DWORD src1_sel:WORD_1
    v_mfma_f32_16x16x32_bf16 v[24:27], a[240:243], v[66:69], v[24:27]
    v_rcp_f16_sdwa v243, v243 dst_sel:WORD_1 dst_unused:UNUSED_PRESERVE src0_sel:WORD_1
    v_mfma_f32_16x16x32_bf16 v[28:31], a[244:247], v[66:69], v[28:31]
    ds_read_b128 v[220:223], v253 offset:656
    v_lshlrev_b32_sdwa v52, 1, v52 dst_sel:DWORD dst_unused:UNUSED_PAD src0_sel:DWORD src1_sel:WORD_1
    v_mfma_f32_16x16x32_bf16 v[32:35], a[248:251], v[66:69], v[32:35]
    ds_read_b128 v[112:115], v255 offset:8192
    ds_read_u16_d16_hi v59, v59 offset:0
    v_mfma_f32_16x16x32_bf16 v[36:39], a[252:255], v[66:69], v[36:39]
    v_cvt_pk_bf16_f32 v18, v20, v21
    v_lshlrev_b32_sdwa v58, 1, v58 dst_sel:DWORD dst_unused:UNUSED_PAD src0_sel:DWORD src1_sel:WORD_1
    v_mfma_f32_16x16x32_bf16 v[40:43], v[226:229], v[66:69], v[40:43]
    s_waitcnt lgkmcnt(11)
    v_or_b32 v76, v76, v77
    v_or_b32_e64 v75, v74, v75
    v_mfma_f32_16x16x32_bf16 v[44:47], v[230:233], v[66:69], v[44:47]
    ds_read_u16_d16_hi v53, v53 offset:0
    v_fma_mix_f32 v78, v78, v243, 0 op_sel:[0,0,0] op_sel_hi:[0,1,0]
    v_mfma_f32_16x16x32_bf16 v[64:67], a[48:51], v[96:99], 0
    buffer_store_dwordx4 v[16:19], v187, s[20:23], s44 offen offset:128 sc1
    ds_read_u16_d16_hi v55, v55 offset:0
    ds_read_u16 v52, v52 offset:0
    v_lshlrev_b32_sdwa v63, 1, v63 dst_sel:DWORD dst_unused:UNUSED_PAD src0_sel:DWORD src1_sel:WORD_1
    v_mfma_f32_16x16x32_bf16 v[64:67], a[52:55], v[100:103], v[64:67]
    v_lshlrev_b32_sdwa v61, 1, v61 dst_sel:DWORD dst_unused:UNUSED_PAD src0_sel:DWORD src1_sel:WORD_1
    v_or_b32_e64 v74, v72, v73
    v_mfma_f32_16x16x32_bf16 v[64:67], a[56:59], v[104:107], v[64:67]
    ds_read_b64 v[224:225], v254 offset:656
    v_fma_mix_f32 v79, v79, v243, 0 op_sel:[0,1,0] op_sel_hi:[0,1,0]
    v_mfma_f32_16x16x32_bf16 v[68:71], a[68:71], v[104:107], 0
    ds_read_u16 v56, v56 offset:0
    v_mfma_f32_16x16x32_bf16 v[68:71], a[64:67], v[100:103], v[68:71]
    ds_read_u16 v58, v58 offset:0
    v_lshlrev_b32_sdwa v57, 1, v57 dst_sel:DWORD dst_unused:UNUSED_PAD src0_sel:DWORD src1_sel:WORD_1
    v_mfma_f32_16x16x32_bf16 v[68:71], a[60:63], v[96:99], v[68:71]
    s_waitcnt lgkmcnt(8)
    ds_read_u16_d16_hi v49, v49 offset:0
    v_cvt_pk_bf16_f32 v77, v78, v79
    v_smfmac_f32_16x16x64_bf16 v[124:127], v[220:223], v[208:215], v175
    s_nop 0
    buffer_load_dwordx3 v[172:174], v183, s[16:19], 0 offen offset:0 nt
    v_lshlrev_b32_sdwa v60, 1, v60 dst_sel:DWORD dst_unused:UNUSED_PAD src0_sel:DWORD src1_sel:WORD_1
    v_mfma_f32_16x16x32_bf16 v[24:27], v[234:237], v[74:77], v[24:27]
    ds_read_b128 v[208:211], v250 offset:160
    v_lshlrev_b32_sdwa v69, 1, v69 dst_sel:DWORD dst_unused:UNUSED_PAD src0_sel:DWORD src1_sel:WORD_1
    v_mfma_f32_16x16x32_bf16 v[28:31], v[238:241], v[74:77], v[28:31]
    v_cvt_pk_f16_f32 v242, v70, v71
    v_lshlrev_b32_sdwa v64, 1, v64 dst_sel:DWORD dst_unused:UNUSED_PAD src0_sel:DWORD src1_sel:WORD_1
    v_mfma_f32_16x16x32_bf16 v[32:35], v[80:83], v[74:77], v[32:35]
    ds_read_u16 v64, v64 offset:0
    ds_read_b128 v[220:223], v253 offset:1312
    v_mfma_f32_16x16x32_bf16 v[36:39], v[84:87], v[74:77], v[36:39]
    v_or_b32_e64 v51, v50, v51
    v_lshlrev_b32_sdwa v62, 1, v62 dst_sel:DWORD dst_unused:UNUSED_PAD src0_sel:DWORD src1_sel:WORD_1
    v_mfma_f32_16x16x32_bf16 v[40:43], v[88:91], v[74:77], v[40:43]
    ds_read_b128 v[212:215], v251 offset:160
    ds_read_u16_d16_hi v61, v61 offset:0
    v_mfma_f32_16x16x32_bf16 v[44:47], v[92:95], v[74:77], v[44:47]
    s_waitcnt lgkmcnt(8)
    v_or_b32 v52, v52, v53
    v_lshlrev_b32_sdwa v65, 1, v65 dst_sel:DWORD dst_unused:UNUSED_PAD src0_sel:DWORD src1_sel:WORD_1
    v_cvt_pk_bf16_f32 v24, v24, v25
    v_smfmac_f32_16x16x32_bf16 v[124:127], v[224:225], v[216:219], v175
    ds_read_b64 v[224:225], v254 offset:1312
    v_lshlrev_b32_sdwa v68, 1, v68 dst_sel:DWORD dst_unused:UNUSED_PAD src0_sel:DWORD src1_sel:WORD_1
    v_mfma_f32_16x16x32_bf16 v[72:75], a[72:75], v[96:99], 0
    ds_read_u16_d16_hi v63, v63 offset:0
    ds_read_b128 v[216:219], v252 offset:160
    v_or_b32_e64 v53, v54, v55
    v_cvt_pk_bf16_f32 v32, v32, v33
    v_lshlrev_b32_sdwa v66, 1, v66 dst_sel:DWORD dst_unused:UNUSED_PAD src0_sel:DWORD src1_sel:WORD_1
    v_pk_mul_f32 v[248:249], v[120:121], v[120:121]
    v_pk_fma_f32 v[248:249], v[122:123], v[122:123], v[248:249]
    v_pk_fma_f32 v[248:249], v[124:125], v[124:125], v[248:249]
    v_pk_fma_f32 v[248:249], v[126:127], v[126:127], v[248:249]
    v_pk_add_f32 v[246:247], v[120:121], v[122:123]
    v_mfma_f32_16x16x32_bf16 v[72:75], a[76:79], v[100:103], v[72:75]
    ds_read_u16_d16_hi v65, v65 offset:0
    ds_read_u16 v60, v60 offset:0
    v_mfma_f32_16x16x32_bf16 v[72:75], a[80:83], v[104:107], v[72:75]
    v_cvt_pk_bf16_f32 v40, v40, v41
    v_cvt_pk_bf16_f32 v25, v26, v27
    v_mfma_f32_16x16x32_bf16 v[76:79], a[92:95], v[104:107], 0
    ds_read_u16 v62, v62 offset:0
    v_cvt_pk_bf16_f32 v26, v28, v29
    v_mfma_f32_16x16x32_bf16 v[76:79], a[88:91], v[100:103], v[76:79]
    ds_read_u16_d16_hi v57, v57 offset:0
    v_pk_fma_f16 v243, v242, v242, s48
    v_mfma_f32_16x16x32_bf16 v[76:79], a[84:87], v[96:99], v[76:79]
    s_waitcnt lgkmcnt(8)
    v_pk_mul_f16 v243, v242, v243 neg_lo:[1,0] neg_hi:[1,0]
    v_or_b32 v50, v48, v49
    v_smfmac_f32_16x16x64_bf16 v[128:131], v[220:223], v[208:215], v175
    ds_read_u16 v66, v66 offset:0
    buffer_load_dwordx3 v[176:178], v183, s[16:19], 0 offen offset:768 nt
    v_mfma_f32_16x16x32_bf16 v[0:3], a[144:147], v[50:53], 0
    v_exp_f16_sdwa v243, v243 dst_sel:WORD_0 dst_unused:UNUSED_PRESERVE src0_sel:WORD_0
    v_mfma_f32_16x16x32_bf16 v[4:7], a[148:151], v[50:53], 0
    ds_read_b128 v[208:211], v250 offset:240
    v_lshlrev_b32_sdwa v77, 1, v77 dst_sel:DWORD dst_unused:UNUSED_PAD src0_sel:DWORD src1_sel:WORD_1
    v_mfma_f32_16x16x32_bf16 v[8:11], a[152:155], v[50:53], 0
    s_waitcnt lgkmcnt(6)
    ds_read_b128 v[220:223], v253 offset:1968
    v_lshlrev_b32_sdwa v75, 1, v75 dst_sel:DWORD dst_unused:UNUSED_PAD src0_sel:DWORD src1_sel:WORD_1
    v_cvt_pk_bf16_f32 v27, v30, v31
    v_smfmac_f32_16x16x32_bf16 v[128:131], v[224:225], v[216:219], v175
    s_nop 0
    ds_read_b128 v[216:219], v252 offset:240
    v_exp_f16_sdwa v243, v243 dst_sel:WORD_1 dst_unused:UNUSED_PRESERVE src0_sel:WORD_1
    v_mfma_f32_16x16x32_bf16 v[12:15], a[156:159], v[50:53], 0
    ds_read_b64 v[224:225], v254 offset:1968
    ds_read_b128 v[212:215], v251 offset:240
    v_mfma_f32_16x16x32_bf16 v[16:19], a[160:163], v[50:53], 0
    ds_read_u16 v68, v68 offset:0
    v_or_b32_e64 v59, v58, v59
    v_mfma_f32_16x16x32_bf16 v[20:23], a[164:167], v[50:53], 0
    ds_read_u16_d16_hi v75, v75 offset:0
    v_lshlrev_b32_sdwa v76, 1, v76 dst_sel:DWORD dst_unused:UNUSED_PAD src0_sel:DWORD src1_sel:WORD_1
    v_mfma_f32_16x16x32_bf16 v[48:51], a[96:99], v[96:99], 0
    s_waitcnt lgkmcnt(8)
    buffer_store_dwordx4 v[24:27], v187, s[20:23], s47 offen offset:0 sc1
    ds_read_u16_d16_hi v69, v69 offset:0
    v_lshlrev_b32_sdwa v72, 1, v72 dst_sel:DWORD dst_unused:UNUSED_PAD src0_sel:DWORD src1_sel:WORD_1
    v_lshlrev_b32_sdwa v67, 1, v67 dst_sel:DWORD dst_unused:UNUSED_PAD src0_sel:DWORD src1_sel:WORD_1
    v_or_b32 v60, v60, v61
    v_or_b32_e64 v58, v56, v57
    v_lshlrev_b32_sdwa v74, 1, v74 dst_sel:DWORD dst_unused:UNUSED_PAD src0_sel:DWORD src1_sel:WORD_1
    v_pk_add_f32 v[246:247], v[246:247], v[124:125]
    v_pk_add_f32 v[246:247], v[246:247], v[126:127]
    v_mfma_f32_16x16x32_bf16 v[48:51], a[100:103], v[100:103], v[48:51]
    ds_read_u16 v72, v72 offset:0
    ds_read_u16_d16_hi v67, v67 offset:0
    v_mfma_f32_16x16x32_bf16 v[48:51], a[104:107], v[104:107], v[48:51]
    v_pk_fma_f16 v243, v243, s50, s50
    v_lshlrev_b32_sdwa v73, 1, v73 dst_sel:DWORD dst_unused:UNUSED_PAD src0_sel:DWORD src1_sel:WORD_1
    v_mfma_f32_16x16x32_bf16 v[52:55], a[116:119], v[104:107], 0
    ds_read_u16 v74, v74 offset:0
    v_or_b32_e64 v61, v62, v63
    v_mfma_f32_16x16x32_bf16 v[52:55], a[112:115], v[100:103], v[52:55]
    v_rcp_f16_sdwa v243, v243 dst_sel:WORD_0 dst_unused:UNUSED_PRESERVE src0_sel:WORD_0
    v_mfma_f32_16x16x32_bf16 v[52:55], a[108:111], v[96:99], v[52:55]
    s_waitcnt lgkmcnt(6)
    v_cvt_pk_bf16_f32 v33, v34, v35
    v_cvt_pk_bf16_f32 v34, v36, v37
    v_smfmac_f32_16x16x64_bf16 v[132:135], v[220:223], v[208:215], v175
    s_nop 0
    ds_read_u16_d16_hi v77, v77 offset:0
    v_cvt_pk_bf16_f32 v35, v38, v39
    v_mfma_f32_16x16x32_bf16 v[0:3], a[168:171], v[58:61], v[0:3]
    buffer_load_dwordx3 v[180:182], v183, s[16:19], 0 offen offset:1536 nt
    ds_read_b128 v[212:215], v251 offset:320
    v_mfma_f32_16x16x32_bf16 v[4:7], a[172:175], v[58:61], v[4:7]
    ds_read_b128 v[220:223], v253 offset:2624
    v_lshlrev_b32_sdwa v51, 1, v51 dst_sel:DWORD dst_unused:UNUSED_PAD src0_sel:DWORD src1_sel:WORD_1
    v_mfma_f32_16x16x32_bf16 v[8:11], a[176:179], v[58:61], v[8:11]
    ds_read_b128 v[208:211], v250 offset:320
    ds_read_u16 v76, v76 offset:0
    v_mfma_f32_16x16x32_bf16 v[12:15], a[180:183], v[58:61], v[12:15]
    v_lshlrev_b32_sdwa v50, 1, v50 dst_sel:DWORD dst_unused:UNUSED_PAD src0_sel:DWORD src1_sel:WORD_1
    v_lshlrev_b32_sdwa v79, 1, v79 dst_sel:DWORD dst_unused:UNUSED_PAD src0_sel:DWORD src1_sel:WORD_1
    v_mfma_f32_16x16x32_bf16 v[16:19], a[184:187], v[58:61], v[16:19]
    v_lshlrev_b32_sdwa v78, 1, v78 dst_sel:DWORD dst_unused:UNUSED_PAD src0_sel:DWORD src1_sel:WORD_1
    v_lshlrev_b32_sdwa v49, 1, v49 dst_sel:DWORD dst_unused:UNUSED_PAD src0_sel:DWORD src1_sel:WORD_1
    v_mfma_f32_16x16x32_bf16 v[20:23], a[188:191], v[58:61], v[20:23]
    ds_read_u16_d16_hi v51, v51 offset:0
    v_rcp_f16_sdwa v243, v243 dst_sel:WORD_1 dst_unused:UNUSED_PRESERVE src0_sel:WORD_1
    v_smfmac_f32_16x16x32_bf16 v[132:135], v[224:225], v[216:219], v175
    ds_read_b64 v[224:225], v254 offset:2624
    ds_read_b128 v[216:219], v252 offset:320
    ds_read_u16 v50, v50 offset:0
    v_fma_mix_f32 v71, v71, v243, 0 op_sel:[0,1,0] op_sel_hi:[0,1,0]
    v_lshlrev_b32_sdwa v52, 1, v52 dst_sel:DWORD dst_unused:UNUSED_PAD src0_sel:DWORD src1_sel:WORD_1
    v_pk_add_f32 v[246:247], v[246:247], v[128:129]
    v_pk_fma_f32 v[248:249], v[128:129], v[128:129], v[248:249]
    v_pk_add_f32 v[246:247], v[246:247], v[130:131]
    v_pk_fma_f32 v[248:249], v[130:131], v[130:131], v[248:249]
    v_mfma_f32_16x16x32_bf16 v[56:59], a[120:123], v[96:99], 0
    ds_read_u16 v52, v52 offset:0
    v_lshlrev_b32_sdwa v55, 1, v55 dst_sel:DWORD dst_unused:UNUSED_PAD src0_sel:DWORD src1_sel:WORD_1
    v_mfma_f32_16x16x32_bf16 v[56:59], a[124:127], v[100:103], v[56:59]
    ds_read_u16_d16_hi v73, v73 offset:0
    v_fma_mix_f32 v70, v70, v243, 0 op_sel:[0,0,0] op_sel_hi:[0,1,0]
    v_mfma_f32_16x16x32_bf16 v[56:59], a[128:131], v[104:107], v[56:59]
    v_add_u32_e64 v195, 1, v195
    v_mfma_f32_16x16x32_bf16 v[60:63], a[140:143], v[104:107], 0
    s_waitcnt lgkmcnt(7)
    v_or_b32 v68, v68, v69
    v_cvt_pk_bf16_f32 v41, v42, v43
    v_smfmac_f32_16x16x64_bf16 v[136:139], v[220:223], v[208:215], v175
    ds_read_b128 v[220:223], v253 offset:3280
    ds_read_b128 v[212:215], v251 offset:400
    v_mfma_f32_16x16x32_bf16 v[60:63], a[136:139], v[100:103], v[60:63]
    buffer_store_dwordx4 v[32:35], v187, s[20:23], s47 offen offset:64 sc1
    ds_read_b128 v[208:211], v250 offset:400
    ds_read_u16_d16_hi v79, v79 offset:0
    v_cvt_pk_bf16_f32 v69, v70, v71
    v_mfma_f32_16x16x32_bf16 v[60:63], a[132:135], v[96:99], v[60:63]
    s_waitcnt lgkmcnt(7)
    v_lshlrev_b32_sdwa v53, 1, v53 dst_sel:DWORD dst_unused:UNUSED_PAD src0_sel:DWORD src1_sel:WORD_1
    v_lshlrev_b32_sdwa v48, 1, v48 dst_sel:DWORD dst_unused:UNUSED_PAD src0_sel:DWORD src1_sel:WORD_1
    v_or_b32 v75, v74, v75
    v_smfmac_f32_16x16x32_bf16 v[136:139], v[224:225], v[216:219], v175
    ds_read_u16_d16_hi v49, v49 offset:0
    ds_read_u16 v48, v48 offset:0
    v_or_b32_e64 v67, v66, v67
    v_cvt_pk_f16_f32 v242, v62, v63
    v_or_b32_e64 v66, v64, v65
    v_pk_fma_f32 v[248:249], v[132:133], v[132:133], v[248:249]
    v_pk_add_f32 v[246:247], v[246:247], v[132:133]
    v_pk_fma_f32 v[248:249], v[134:135], v[134:135], v[248:249]
    v_pk_add_f32 v[246:247], v[246:247], v[134:135]
    v_pk_fma_f32 v[248:249], v[136:137], v[136:137], v[248:249]
    v_pk_fma_f32 v[248:249], v[138:139], v[138:139], v[248:249]
    v_pk_add_f32 v[246:247], v[246:247], v[136:137]
    v_mfma_f32_16x16x32_bf16 v[0:3], a[192:195], v[66:69], v[0:3]
    ds_read_b64 v[224:225], v254 offset:3280
    ds_read_u16_d16_hi v53, v53 offset:0
    v_mfma_f32_16x16x32_bf16 v[4:7], a[196:199], v[66:69], v[4:7]
    s_waitcnt lgkmcnt(8)
    ds_read_b128 v[216:219], v252 offset:400
    v_or_b32 v74, v72, v73
    v_mfma_f32_16x16x32_bf16 v[8:11], a[200:203], v[66:69], v[8:11]
    buffer_load_dwordx3 v[184:186], v183, s[16:19], 0 offen offset:2304 nt
    v_lshlrev_b32_sdwa v54, 1, v54 dst_sel:DWORD dst_unused:UNUSED_PAD src0_sel:DWORD src1_sel:WORD_1
    v_mfma_f32_16x16x32_bf16 v[12:15], a[204:207], v[66:69], v[12:15]
    ds_read_u16 v78, v78 offset:0
    v_lshlrev_b32_sdwa v56, 1, v56 dst_sel:DWORD dst_unused:UNUSED_PAD src0_sel:DWORD src1_sel:WORD_1
    v_mfma_f32_16x16x32_bf16 v[16:19], a[208:211], v[66:69], v[16:19]
    s_add_u32 s16, s16, s13
    ds_read_u16 v56, v56 offset:0
    v_or_b32 v51, v50, v51
    v_mfma_f32_16x16x32_bf16 v[20:23], a[212:215], v[66:69], v[20:23]
    s_waitcnt lgkmcnt(8)
    v_cvt_pk_bf16_f32 v43, v46, v47
    v_lshlrev_b32_sdwa v60, 1, v60 dst_sel:DWORD dst_unused:UNUSED_PAD src0_sel:DWORD src1_sel:WORD_1
    v_smfmac_f32_16x16x64_bf16 v[140:143], v[220:223], v[208:215], v175
    s_nop 0
    ds_read_b128 v[212:215], v251 offset:480
    ds_read_b128 v[220:223], v253 offset:3936
    v_mfma_f32_16x16x32_bf16 v[64:67], a[0:3], v[108:111], 0
    ds_read_u16_d16_hi v55, v55 offset:0
    v_lshlrev_b32_sdwa v59, 1, v59 dst_sel:DWORD dst_unused:UNUSED_PAD src0_sel:DWORD src1_sel:WORD_1
    v_mfma_f32_16x16x32_bf16 v[64:67], a[4:7], v[112:115], v[64:67]
    ds_read_b128 v[208:211], v250 offset:480
    v_lshlrev_b32_sdwa v61, 1, v61 dst_sel:DWORD dst_unused:UNUSED_PAD src0_sel:DWORD src1_sel:WORD_1
    v_mfma_f32_16x16x32_bf16 v[64:67], a[8:11], v[116:119], v[64:67]
    v_lshlrev_b32_sdwa v57, 1, v57 dst_sel:DWORD dst_unused:UNUSED_PAD src0_sel:DWORD src1_sel:WORD_1
    v_lshlrev_b32_sdwa v58, 1, v58 dst_sel:DWORD dst_unused:UNUSED_PAD src0_sel:DWORD src1_sel:WORD_1
    v_mfma_f32_16x16x32_bf16 v[68:71], a[20:23], v[116:119], 0
    ds_read_u16 v54, v54 offset:0
    v_or_b32_e64 v76, v76, v77
    v_mfma_f32_16x16x32_bf16 v[68:71], a[16:19], v[112:115], v[68:71]
    ds_read_u16_d16_hi v61, v61 offset:0
    v_pk_fma_f16 v243, v242, v242, s48
    v_mfma_f32_16x16x32_bf16 v[68:71], a[12:15], v[108:111], v[68:71]
    s_waitcnt lgkmcnt(7)
    v_or_b32 v77, v78, v79
    v_lshlrev_b32_sdwa v67, 1, v67 dst_sel:DWORD dst_unused:UNUSED_PAD src0_sel:DWORD src1_sel:WORD_1
    v_lshlrev_b32_sdwa v64, 1, v64 dst_sel:DWORD dst_unused:UNUSED_PAD src0_sel:DWORD src1_sel:WORD_1
    v_smfmac_f32_16x16x32_bf16 v[140:143], v[224:225], v[216:219], v175
    ds_read_b128 v[216:219], v252 offset:480
    v_lshlrev_b32_sdwa v65, 1, v65 dst_sel:DWORD dst_unused:UNUSED_PAD src0_sel:DWORD src1_sel:WORD_1
    v_pk_mul_f16 v243, v242, v243 neg_lo:[1,0] neg_hi:[1,0]
    v_mfma_f32_16x16x32_bf16 v[0:3], a[216:219], v[74:77], v[0:3]
    ds_read_u16_d16_hi v59, v59 offset:0
    v_xor_b32 v255, 800, v255
    v_mfma_f32_16x16x32_bf16 v[4:7], a[220:223], v[74:77], v[4:7]
    v_exp_f16_sdwa v243, v243 dst_sel:WORD_0 dst_unused:UNUSED_PRESERVE src0_sel:WORD_0
    v_mfma_f32_16x16x32_bf16 v[8:11], a[224:227], v[74:77], v[8:11]
    s_addc_u32 s17, s17, s1
    ds_read_b128 v[104:107], v255 offset:16384
    v_cvt_pk_bf16_f32 v42, v44, v45
    v_mfma_f32_16x16x32_bf16 v[12:15], a[228:231], v[74:77], v[12:15]
    s_nop 0
    ds_read_u16 v60, v60 offset:0
    v_lshlrev_b32_sdwa v70, 1, v70 dst_sel:DWORD dst_unused:UNUSED_PAD src0_sel:DWORD src1_sel:WORD_1
    v_mfma_f32_16x16x32_bf16 v[16:19], a[232:235], v[74:77], v[16:19]
    ds_read_b64 v[224:225], v254 offset:3936
    v_or_b32_e64 v52, v52, v53
    v_mfma_f32_16x16x32_bf16 v[20:23], a[236:239], v[74:77], v[20:23]
    s_waitcnt lgkmcnt(7)
    ds_read_u16 v58, v58 offset:0
    v_lshlrev_b32_sdwa v66, 1, v66 dst_sel:DWORD dst_unused:UNUSED_PAD src0_sel:DWORD src1_sel:WORD_1
    v_smfmac_f32_16x16x64_bf16 v[144:147], v[220:223], v[208:215], v175
    ds_read_b128 v[208:211], v250 offset:560
    ds_read_u16 v64, v64 offset:0
    v_mfma_f32_16x16x32_bf16 v[72:75], a[24:27], v[108:111], 0
    s_waitcnt lgkmcnt(9)
    v_add_u32 v171, s96, v203
    v_or_b32 v53, v54, v55
    v_mfma_f32_16x16x32_bf16 v[72:75], a[28:31], v[112:115], v[72:75]
    s_add_u32 s46, s46, 2
    v_exp_f16_sdwa v243, v243 dst_sel:WORD_1 dst_unused:UNUSED_PRESERVE src0_sel:WORD_1
    v_mfma_f32_16x16x32_bf16 v[72:75], a[32:35], v[116:119], v[72:75]
    s_cmp_lt_u32 s46, s54
    ds_read_b128 v[212:215], v251 offset:560
    ds_read_b128 v[220:223], v253 offset:4592
    ds_read_u16_d16_hi v57, v57 offset:0
    v_lshlrev_b32_sdwa v69, 1, v69 dst_sel:DWORD dst_unused:UNUSED_PAD src0_sel:DWORD src1_sel:WORD_1
    v_or_b32_e64 v50, v48, v49
    v_pk_add_f32 v[246:247], v[246:247], v[138:139]
    v_pk_add_f32 v[246:247], v[246:247], v[140:141]
    v_pk_fma_f32 v[248:249], v[140:141], v[140:141], v[248:249]
    v_pk_fma_f32 v[248:249], v[142:143], v[142:143], v[248:249]
    v_mfma_f32_16x16x32_bf16 v[76:79], a[44:47], v[116:119], 0
    ds_read_u16_d16_hi v67, v67 offset:0
    v_pk_fma_f16 v243, v243, s50, s50
    v_mfma_f32_16x16x32_bf16 v[76:79], a[40:43], v[112:115], v[76:79]
    s_waitcnt lgkmcnt(8)
    ds_read_u16 v66, v66 offset:0
    v_or_b32 v60, v60, v61
    v_mfma_f32_16x16x32_bf16 v[76:79], a[36:39], v[108:111], v[76:79]
    s_waitcnt lgkmcnt(8)
    v_lshlrev_b32_sdwa v68, 1, v68 dst_sel:DWORD dst_unused:UNUSED_PAD src0_sel:DWORD src1_sel:WORD_1
    v_rcp_f16_sdwa v243, v243 dst_sel:WORD_0 dst_unused:UNUSED_PRESERVE src0_sel:WORD_0
    v_smfmac_f32_16x16x32_bf16 v[144:147], v[224:225], v[216:219], v175
    s_nop 0
    ds_read_u16 v68, v68 offset:0
    v_rcp_f16_sdwa v243, v243 dst_sel:WORD_1 dst_unused:UNUSED_PRESERVE src0_sel:WORD_1
    v_mfma_f32_16x16x32_bf16 v[0:3], a[240:243], v[50:53], v[0:3]
    ds_read_b128 v[216:219], v252 offset:560
    v_lshlrev_b32_sdwa v77, 1, v77 dst_sel:DWORD dst_unused:UNUSED_PAD src0_sel:DWORD src1_sel:WORD_1
    v_mfma_f32_16x16x32_bf16 v[4:7], a[244:247], v[50:53], v[4:7]
    s_waitcnt lgkmcnt(9)
    buffer_store_dwordx4 v[40:43], v187, s[20:23], s47 offen offset:128 sc1
    ds_read_u16_d16_hi v77, v77 offset:0
    v_or_b32 v59, v58, v59
    v_lshlrev_b32_sdwa v76, 1, v76 dst_sel:DWORD dst_unused:UNUSED_PAD src0_sel:DWORD src1_sel:WORD_1
    v_lshlrev_b32_sdwa v79, 1, v79 dst_sel:DWORD dst_unused:UNUSED_PAD src0_sel:DWORD src1_sel:WORD_1
    v_mfma_f32_16x16x32_bf16 v[8:11], a[248:251], v[50:53], v[8:11]
    s_cselect_b32 s18, 98304, 0
    ds_read_b64 v[224:225], v254 offset:4592
    ds_read_u16 v70, v70 offset:0
    v_mfma_f32_16x16x32_bf16 v[12:15], a[252:255], v[50:53], v[12:15]
    ds_read_u16_d16_hi v69, v69 offset:0
    v_lshlrev_b32_sdwa v71, 1, v71 dst_sel:DWORD dst_unused:UNUSED_PAD src0_sel:DWORD src1_sel:WORD_1
    v_mfma_f32_16x16x32_bf16 v[16:19], v[226:229], v[50:53], v[16:19]
    v_lshlrev_b32_sdwa v74, 1, v74 dst_sel:DWORD dst_unused:UNUSED_PAD src0_sel:DWORD src1_sel:WORD_1
    v_lshlrev_b32_sdwa v72, 1, v72 dst_sel:DWORD dst_unused:UNUSED_PAD src0_sel:DWORD src1_sel:WORD_1
    v_mfma_f32_16x16x32_bf16 v[20:23], v[230:233], v[50:53], v[20:23]
    s_waitcnt lgkmcnt(8)
    buffer_load_dwordx3 v[188:190], v179, s[16:19], 0 offen nt
    v_or_b32 v58, v56, v57
    v_smfmac_f32_16x16x64_bf16 v[148:151], v[220:223], v[208:215], v175
    ds_read_u16_d16_hi v65, v65 offset:0
    ds_read_b128 v[208:211], v250 offset:640
    v_mfma_f32_16x16x32_bf16 v[48:51], a[48:51], v[108:111], 0
    v_lshlrev_b32_sdwa v78, 1, v78 dst_sel:DWORD dst_unused:UNUSED_PAD src0_sel:DWORD src1_sel:WORD_1
    v_fma_mix_f32 v63, v63, v243, 0 op_sel:[0,1,0] op_sel_hi:[0,1,0]
    v_mfma_f32_16x16x32_bf16 v[48:51], a[52:55], v[112:115], v[48:51]
    s_waitcnt lgkmcnt(8)
    ds_read_u16_d16_hi v71, v71 offset:0
    v_or_b32 v67, v66, v67
    v_mfma_f32_16x16x32_bf16 v[48:51], a[56:59], v[116:119], v[48:51]
    ds_read_b128 v[212:215], v251 offset:640
    v_lshlrev_b32_sdwa v73, 1, v73 dst_sel:DWORD dst_unused:UNUSED_PAD src0_sel:DWORD src1_sel:WORD_1
    v_mfma_f32_16x16x32_bf16 v[52:55], a[68:71], v[116:119], 0
    ds_read_b128 v[220:223], v253 offset:5248
    v_fma_mix_f32 v62, v62, v243, 0 op_sel:[0,0,0] op_sel_hi:[0,1,0]
    v_mfma_f32_16x16x32_bf16 v[52:55], a[64:67], v[112:115], v[52:55]
    ds_read_u16 v74, v74 offset:0
    v_lshlrev_b32_sdwa v75, 1, v75 dst_sel:DWORD dst_unused:UNUSED_PAD src0_sel:DWORD src1_sel:WORD_1
    v_mfma_f32_16x16x32_bf16 v[52:55], a[60:63], v[108:111], v[52:55]
    s_waitcnt lgkmcnt(8)
    v_cvt_pk_bf16_f32 v61, v62, v63
    v_lshlrev_b32_sdwa v51, 1, v51 dst_sel:DWORD dst_unused:UNUSED_PAD src0_sel:DWORD src1_sel:WORD_1
    v_lshlrev_b32_sdwa v48, 1, v48 dst_sel:DWORD dst_unused:UNUSED_PAD src0_sel:DWORD src1_sel:WORD_1
    v_lshlrev_b32_sdwa v50, 1, v50 dst_sel:DWORD dst_unused:UNUSED_PAD src0_sel:DWORD src1_sel:WORD_1
    v_smfmac_f32_16x16x32_bf16 v[148:151], v[224:225], v[216:219], v175
    s_nop 0
    ds_read_u16 v48, v48 offset:0
    ds_read_u16_d16_hi v79, v79 offset:0
    v_cvt_pk_f16_f32 v242, v54, v55
    v_mfma_f32_16x16x32_bf16 v[0:3], v[234:237], v[58:61], v[0:3]
    v_pk_fma_f16 v243, v242, v242, s48
    v_pk_mul_f16 v243, v242, v243 neg_lo:[1,0] neg_hi:[1,0]
    v_mfma_f32_16x16x32_bf16 v[4:7], v[238:241], v[58:61], v[4:7]
    v_exp_f16_sdwa v243, v243 dst_sel:WORD_0 dst_unused:UNUSED_PRESERVE src0_sel:WORD_0
    v_lshlrev_b32_sdwa v53, 1, v53 dst_sel:DWORD dst_unused:UNUSED_PAD src0_sel:DWORD src1_sel:WORD_1
    v_mfma_f32_16x16x32_bf16 v[8:11], v[80:83], v[58:61], v[8:11]
    ds_read_b64 v[224:225], v254 offset:5248
    ds_read_b128 v[216:219], v252 offset:640
    ds_read_b128 v[100:103], v255 offset:8192
    v_mfma_f32_16x16x32_bf16 v[12:15], v[84:87], v[58:61], v[12:15]
    v_exp_f16_sdwa v243, v243 dst_sel:WORD_1 dst_unused:UNUSED_PRESERVE src0_sel:WORD_1
    v_mfma_f32_16x16x32_bf16 v[16:19], v[88:91], v[58:61], v[16:19]
    ds_read_u16 v76, v76 offset:0
    v_cvt_pk_bf16_f32 v0, v0, v1
    v_mfma_f32_16x16x32_bf16 v[20:23], v[92:95], v[58:61], v[20:23]
    s_waitcnt lgkmcnt(7)
    v_lshlrev_b32_sdwa v52, 1, v52 dst_sel:DWORD dst_unused:UNUSED_PAD src0_sel:DWORD src1_sel:WORD_1
    v_lshlrev_b32_sdwa v49, 1, v49 dst_sel:DWORD dst_unused:UNUSED_PAD src0_sel:DWORD src1_sel:WORD_1
    v_smfmac_f32_16x16x64_bf16 v[152:155], v[220:223], v[208:215], v175
    s_nop 0
    ds_read_b128 v[220:223], v253 offset:5904
    ds_read_b128 v[212:215], v251 offset:720
    v_mfma_f32_16x16x32_bf16 v[56:59], a[72:75], v[108:111], 0
    ds_read_b128 v[208:211], v250 offset:720
    ds_read_u16 v78, v78 offset:0
    v_or_b32_e64 v68, v68, v69
    v_mfma_f32_16x16x32_bf16 v[56:59], a[76:79], v[112:115], v[56:59]
    v_cvt_pk_bf16_f32 v1, v2, v3
    v_cvt_pk_bf16_f32 v8, v8, v9
    v_mfma_f32_16x16x32_bf16 v[56:59], a[80:83], v[116:119], v[56:59]
    buffer_load_dwordx3 v[192:194], v183, s[16:19], 0 offen offset:0 nt
    ds_read_u16_d16_hi v75, v75 offset:0
    v_mfma_f32_16x16x32_bf16 v[60:63], a[92:95], v[116:119], 0
    v_cvt_pk_bf16_f32 v3, v6, v7
    v_cvt_pk_bf16_f32 v2, v4, v5
    v_or_b32_e64 v66, v64, v65
    v_mfma_f32_16x16x32_bf16 v[60:63], a[88:91], v[112:115], v[60:63]
    ds_read_u16_d16_hi v73, v73 offset:0
    v_lshlrev_b32_sdwa v59, 1, v59 dst_sel:DWORD dst_unused:UNUSED_PAD src0_sel:DWORD src1_sel:WORD_1
    v_mfma_f32_16x16x32_bf16 v[60:63], a[84:87], v[108:111], v[60:63]
    s_waitcnt lgkmcnt(8)
    ds_read_u16 v50, v50 offset:0
    ds_write_b128 v171, v[0:3] offset:0
    v_pk_fma_f32 v[248:249], v[144:145], v[144:145], v[248:249]
    v_cvt_pk_bf16_f32 v16, v16, v17
    v_pk_add_f32 v[246:247], v[246:247], v[142:143]
    v_pk_fma_f32 v[248:249], v[146:147], v[146:147], v[248:249]
    v_pk_add_f32 v[246:247], v[246:247], v[144:145]
    v_pk_add_f32 v[246:247], v[246:247], v[146:147]
    v_cvt_pk_bf16_f32 v9, v10, v11
    v_pk_fma_f32 v[248:249], v[148:149], v[148:149], v[248:249]
    v_pk_fma_f32 v[248:249], v[150:151], v[150:151], v[248:249]
    v_pk_add_f32 v[246:247], v[246:247], v[148:149]
    v_cvt_pk_bf16_f32 v10, v12, v13
    v_smfmac_f32_16x16x32_bf16 v[152:155], v[224:225], v[216:219], v175
    s_waitcnt lgkmcnt(5)
    ds_read_u16 v72, v72 offset:0
    ds_read_b128 v[216:219], v252 offset:720
    v_lshlrev_b32_sdwa v62, 1, v62 dst_sel:DWORD dst_unused:UNUSED_PAD src0_sel:DWORD src1_sel:WORD_1
    v_smfmac_f32_16x16x64_bf16 v[156:159], v[220:223], v[208:215], v175
    ds_read_b64 v[224:225], v254 offset:5904
    ds_read_b128 v[208:211], v250 offset:800
    v_or_b32_e64 v69, v70, v71
    v_cvt_pk_bf16_f32 v17, v18, v19
    v_lshlrev_b32_sdwa v60, 1, v60 dst_sel:DWORD dst_unused:UNUSED_PAD src0_sel:DWORD src1_sel:WORD_1
    v_pk_add_f32 v[246:247], v[246:247], v[150:151]
    v_pk_fma_f32 v[248:249], v[152:153], v[152:153], v[248:249]
    v_mfma_f32_16x16x32_bf16 v[24:27], a[144:147], v[66:69], 0
    ds_read_b128 v[212:215], v251 offset:800
    ds_read_b128 v[220:223], v253 offset:6560
    v_mfma_f32_16x16x32_bf16 v[28:31], a[148:151], v[66:69], 0
    v_lshlrev_b32_sdwa v58, 1, v58 dst_sel:DWORD dst_unused:UNUSED_PAD src0_sel:DWORD src1_sel:WORD_1
    v_lshlrev_b32_sdwa v63, 1, v63 dst_sel:DWORD dst_unused:UNUSED_PAD src0_sel:DWORD src1_sel:WORD_1
    v_mfma_f32_16x16x32_bf16 v[32:35], a[152:155], v[66:69], 0
    s_waitcnt lgkmcnt(9)
    ds_read_u16 v52, v52 offset:0
    v_or_b32 v75, v74, v75
    v_mfma_f32_16x16x32_bf16 v[36:39], a[156:159], v[66:69], 0
    ds_read_u16_d16_hi v51, v51 offset:0
    v_lshlrev_b32_sdwa v61, 1, v61 dst_sel:DWORD dst_unused:UNUSED_PAD src0_sel:DWORD src1_sel:WORD_1
    v_mfma_f32_16x16x32_bf16 v[40:43], a[160:163], v[66:69], 0
    ds_read_u16_d16_hi v59, v59 offset:0
    v_pk_fma_f16 v243, v243, s50, s50
    v_mfma_f32_16x16x32_bf16 v[44:47], a[164:167], v[66:69], 0
    v_rcp_f16_sdwa v243, v243 dst_sel:WORD_0 dst_unused:UNUSED_PRESERVE src0_sel:WORD_0
    v_or_b32_e64 v76, v76, v77
    v_mfma_f32_16x16x32_bf16 v[64:67], a[96:99], v[108:111], 0
    ds_read_b128 v[96:99], v255 offset:0
    ds_read_u16 v58, v58 offset:0
    v_mfma_f32_16x16x32_bf16 v[64:67], a[100:103], v[112:115], v[64:67]
    buffer_load_dwordx3 v[196:198], v183, s[16:19], 0 offen offset:768 nt
    v_cvt_pk_bf16_f32 v18, v20, v21
    v_mfma_f32_16x16x32_bf16 v[64:67], a[104:107], v[116:119], v[64:67]
    v_lshlrev_b32_sdwa v57, 1, v57 dst_sel:DWORD dst_unused:UNUSED_PAD src0_sel:DWORD src1_sel:WORD_1
    v_cvt_pk_bf16_f32 v11, v14, v15
    v_mfma_f32_16x16x32_bf16 v[68:71], a[116:119], v[116:119], 0
    s_waitcnt lgkmcnt(8)
    ds_read_u16 v60, v60 offset:0
    v_xor_b32 v255, 288, v255
    v_or_b32 v74, v72, v73
    v_smfmac_f32_16x16x32_bf16 v[156:159], v[224:225], v[216:219], v175
    s_waitcnt lgkmcnt(6)
    ds_read_b64 v[224:225], v254 offset:6560
    ds_read_b128 v[216:219], v252 offset:800
    v_lshlrev_b32_sdwa v67, 1, v67 dst_sel:DWORD dst_unused:UNUSED_PAD src0_sel:DWORD src1_sel:WORD_1
    v_smfmac_f32_16x16x64_bf16 v[160:163], v[220:223], v[208:215], v175
    ds_read_b128 v[220:223], v253 offset:7216
    ds_read_u16_d16_hi v53, v53 offset:0
    v_mfma_f32_16x16x32_bf16 v[68:71], a[112:115], v[112:115], v[68:71]
    v_or_b32 v77, v78, v79
    v_cvt_pk_bf16_f32 v19, v22, v23
    v_mfma_f32_16x16x32_bf16 v[68:71], a[108:111], v[108:111], v[68:71]
    ds_write_b128 v171, v[8:11] offset:1024
    v_pk_fma_f32 v[248:249], v[154:155], v[154:155], v[248:249]
    v_pk_add_f32 v[246:247], v[246:247], v[152:153]
    v_mfma_f32_16x16x32_bf16 v[24:27], a[168:171], v[74:77], v[24:27]
    v_rcp_f16_sdwa v243, v243 dst_sel:WORD_1 dst_unused:UNUSED_PRESERVE src0_sel:WORD_1
    v_mfma_f32_16x16x32_bf16 v[28:31], a[172:175], v[74:77], v[28:31]
    ds_read_u16_d16_hi v49, v49 offset:0
    v_lshlrev_b32_sdwa v65, 1, v65 dst_sel:DWORD dst_unused:UNUSED_PAD src0_sel:DWORD src1_sel:WORD_1
    v_mfma_f32_16x16x32_bf16 v[32:35], a[176:179], v[74:77], v[32:35]
    ds_read_u16_d16_hi v63, v63 offset:0
    v_fma_mix_f32 v55, v55, v243, 0 op_sel:[0,1,0] op_sel_hi:[0,1,0]
    v_mfma_f32_16x16x32_bf16 v[36:39], a[180:183], v[74:77], v[36:39]
    ds_read_b128 v[208:211], v250 offset:880
    v_lshlrev_b32_sdwa v56, 1, v56 dst_sel:DWORD dst_unused:UNUSED_PAD src0_sel:DWORD src1_sel:WORD_1
    v_mfma_f32_16x16x32_bf16 v[40:43], a[184:187], v[74:77], v[40:43]
    s_waitcnt lgkmcnt(12)
    ds_read_b128 v[212:215], v251 offset:880
    v_or_b32 v51, v50, v51
    v_mfma_f32_16x16x32_bf16 v[44:47], a[188:191], v[74:77], v[44:47]
    s_waitcnt lgkmcnt(7)
    ds_read_u16_d16_hi v67, v67 offset:0
    v_lshlrev_b32_sdwa v64, 1, v64 dst_sel:DWORD dst_unused:UNUSED_PAD src0_sel:DWORD src1_sel:WORD_1
    v_lshlrev_b32_sdwa v69, 1, v69 dst_sel:DWORD dst_unused:UNUSED_PAD src0_sel:DWORD src1_sel:WORD_1
    v_smfmac_f32_16x16x32_bf16 v[160:163], v[224:225], v[216:219], v175
    s_nop 0
    ds_write_b128 v171, v[16:19] offset:2048
    v_pk_fma_f32 v[248:249], v[156:157], v[156:157], v[248:249]
    v_pk_add_f32 v[246:247], v[246:247], v[154:155]
    v_pk_fma_f32 v[248:249], v[158:159], v[158:159], v[248:249]
    v_pk_add_f32 v[246:247], v[246:247], v[156:157]
    v_pk_add_f32 v[246:247], v[246:247], v[158:159]
    v_mfma_f32_16x16x32_bf16 v[72:75], a[120:123], v[108:111], 0
    ds_read_b64 v[224:225], v254 offset:7216
    v_lshlrev_b32_sdwa v66, 1, v66 dst_sel:DWORD dst_unused:UNUSED_PAD src0_sel:DWORD src1_sel:WORD_1
    v_mfma_f32_16x16x32_bf16 v[72:75], a[124:127], v[112:115], v[72:75]
    buffer_load_dwordx3 v[200:202], v183, s[16:19], 0 offen offset:1536 nt
    ds_read_b128 v[216:219], v252 offset:880
    v_mfma_f32_16x16x32_bf16 v[72:75], a[128:131], v[116:119], v[72:75]
    s_waitcnt lgkmcnt(7)
    ds_read_u16 v62, v62 offset:0
    v_or_b32 v50, v48, v49
    v_mfma_f32_16x16x32_bf16 v[76:79], a[140:143], v[116:119], 0
    ds_read_u16_d16_hi v61, v61 offset:0
    v_or_b32_e64 v59, v58, v59
    v_mfma_f32_16x16x32_bf16 v[76:79], a[136:139], v[112:115], v[76:79]
    v_or_b32_e64 v52, v52, v53
    v_fma_mix_f32 v54, v54, v243, 0 op_sel:[0,0,0] op_sel_hi:[0,1,0]
    v_mfma_f32_16x16x32_bf16 v[76:79], a[132:135], v[108:111], v[76:79]
    s_waitcnt lgkmcnt(6)
    ds_read_u16 v64, v64 offset:0
    v_lshlrev_b32_sdwa v72, 1, v72 dst_sel:DWORD dst_unused:UNUSED_PAD src0_sel:DWORD src1_sel:WORD_1
    v_smfmac_f32_16x16x64_bf16 v[164:167], v[220:223], v[208:215], v175
    ds_read_u16 v56, v56 offset:0
    v_lshlrev_b32_sdwa v71, 1, v71 dst_sel:DWORD dst_unused:UNUSED_PAD src0_sel:DWORD src1_sel:WORD_1
    v_add_u32 v171, s98, v203
    v_cvt_pk_bf16_f32 v53, v54, v55
    v_lshlrev_b32_sdwa v73, 1, v73 dst_sel:DWORD dst_unused:UNUSED_PAD src0_sel:DWORD src1_sel:WORD_1
    v_pk_add_f32 v[246:247], v[246:247], v[160:161]
    v_mfma_f32_16x16x32_bf16 v[24:27], a[192:195], v[50:53], v[24:27]
    ds_read_u16 v66, v66 offset:0
    v_lshlrev_b32_sdwa v74, 1, v74 dst_sel:DWORD dst_unused:UNUSED_PAD src0_sel:DWORD src1_sel:WORD_1
    v_mfma_f32_16x16x32_bf16 v[28:31], a[196:199], v[50:53], v[28:31]
    ds_read_u16_d16_hi v69, v69 offset:0
    v_lshlrev_b32_sdwa v77, 1, v77 dst_sel:DWORD dst_unused:UNUSED_PAD src0_sel:DWORD src1_sel:WORD_1
    v_mfma_f32_16x16x32_bf16 v[32:35], a[200:203], v[50:53], v[32:35]
    v_lshlrev_b32_sdwa v75, 1, v75 dst_sel:DWORD dst_unused:UNUSED_PAD src0_sel:DWORD src1_sel:WORD_1
    v_cvt_pk_f16_f32 v242, v78, v79
    v_mfma_f32_16x16x32_bf16 v[36:39], a[204:207], v[50:53], v[36:39]
    ds_read_u16_d16_hi v65, v65 offset:0
    v_lshlrev_b32_sdwa v70, 1, v70 dst_sel:DWORD dst_unused:UNUSED_PAD src0_sel:DWORD src1_sel:WORD_1
    v_mfma_f32_16x16x32_bf16 v[40:43], a[208:211], v[50:53], v[40:43]
    ds_read_u16_d16_hi v57, v57 offset:0
    v_lshlrev_b32_sdwa v68, 1, v68 dst_sel:DWORD dst_unused:UNUSED_PAD src0_sel:DWORD src1_sel:WORD_1
    v_mfma_f32_16x16x32_bf16 v[44:47], a[212:215], v[50:53], v[44:47]
    s_waitcnt lgkmcnt(6)
    ds_read_u16 v70, v70 offset:0
    v_pk_fma_f16 v243, v242, v242, s48
    v_or_b32 v60, v60, v61
    v_smfmac_f32_16x16x32_bf16 v[164:167], v[224:225], v[216:219], v175
    v_mul_hi_u32_u24 v224, 39147, v250
    v_add_u32_sdwa v225, s45, v175 dst_sel:DWORD dst_unused:UNUSED_PAD src0_sel:DWORD src1_sel:WORD_1
    v_pk_mul_f16 v243, v242, v243 neg_lo:[1,0] neg_hi:[1,0]
    v_mfma_f32_16x16x32_bf16 v[48:51], a[0:3], v[96:99], 0
    ds_read2_b32 v[212:213], v225 offset0:0 offset1:20
    v_lshlrev_b32_sdwa v76, 1, v76 dst_sel:DWORD dst_unused:UNUSED_PAD src0_sel:DWORD src1_sel:WORD_1
    v_mfma_f32_16x16x32_bf16 v[48:51], a[4:7], v[100:103], v[48:51]
    ds_read_b128 v[116:119], v255 offset:16384
    v_add_u32 v250, 31488, v250
    v_mfma_f32_16x16x32_bf16 v[48:51], a[8:11], v[104:107], v[48:51]
    ds_read_b128 v[108:111], v255 offset:0
    ds_read_u16 v68, v68 offset:0
    v_or_b32_e64 v61, v62, v63
    v_exp_f16_sdwa v243, v243 dst_sel:WORD_0 dst_unused:UNUSED_PRESERVE src0_sel:WORD_0
    v_pk_fma_f32 v[248:249], v[160:161], v[160:161], v[248:249]
    v_pk_fma_f32 v[248:249], v[162:163], v[162:163], v[248:249]
    v_pk_add_f32 v[246:247], v[246:247], v[162:163]
    v_pk_fma_f32 v[248:249], v[164:165], v[164:165], v[248:249]
    v_pk_add_f32 v[246:247], v[246:247], v[164:165]
    v_pk_fma_f32 v[248:249], v[166:167], v[166:167], v[248:249]
    v_pk_add_f32 v[246:247], v[246:247], v[166:167]
    v_mfma_f32_16x16x32_bf16 v[52:55], a[20:23], v[104:107], 0
    ds_read_u16_d16_hi v75, v75 offset:0
    ds_write_b128 v171, v[246:249]
    v_lshlrev_b32_sdwa v48, 1, v48 dst_sel:DWORD dst_unused:UNUSED_PAD src0_sel:DWORD src1_sel:WORD_1
    v_mfma_f32_16x16x32_bf16 v[52:55], a[16:19], v[100:103], v[52:55]
    s_waitcnt lgkmcnt(7)
    v_lshlrev_b32_sdwa v50, 1, v50 dst_sel:DWORD dst_unused:UNUSED_PAD src0_sel:DWORD src1_sel:WORD_1
    v_or_b32 v58, v56, v57
    v_mfma_f32_16x16x32_bf16 v[52:55], a[12:15], v[96:99], v[52:55]
    ds_read_b128 v[112:115], v255 offset:8192
    ds_read_u16 v74, v74 offset:0
    v_mad_i32_i24 v250, v224, s99, v250
    v_exp_f16_sdwa v243, v243 dst_sel:WORD_1 dst_unused:UNUSED_PRESERVE src0_sel:WORD_1
    v_mfma_f32_16x16x32_bf16 v[24:27], a[216:219], v[58:61], v[24:27]
    ds_write_b32 v191, v195
    v_mfma_f32_16x16x32_bf16 v[28:31], a[220:223], v[58:61], v[28:31]
    ds_read_u16_d16_hi v71, v71 offset:0
    v_lshlrev_b32_sdwa v49, 1, v49 dst_sel:DWORD dst_unused:UNUSED_PAD src0_sel:DWORD src1_sel:WORD_1
    v_mfma_f32_16x16x32_bf16 v[32:35], a[224:227], v[58:61], v[32:35]
    buffer_load_dwordx3 v[204:206], v183, s[16:19], 0 offen offset:2304 nt
    ds_read2_b32 v[214:215], v225 offset0:40 offset1:60
    v_mfma_f32_16x16x32_bf16 v[36:39], a[228:231], v[58:61], v[36:39]
    ds_read_u16 v72, v72 offset:0
    v_add_u32 v225, 1280, v225
    v_mfma_f32_16x16x32_bf16 v[40:43], a[232:235], v[58:61], v[40:43]
    ds_read2_b32 v[216:217], v225 offset0:0 offset1:20
    v_pk_fma_f16 v243, v243, s50, s50
    v_mfma_f32_16x16x32_bf16 v[44:47], a[236:239], v[58:61], v[44:47]
    s_waitcnt lgkmcnt(9)
    ds_read_u16_d16_hi v77, v77 offset:0
    v_mul_hi_u32_u24 v224, 39147, v251
    v_or_b32 v67, v66, v67
    v_lshlrev_b32_sdwa v54, 1, v54 dst_sel:DWORD dst_unused:UNUSED_PAD src0_sel:DWORD src1_sel:WORD_1
    v_mfma_f32_16x16x16_bf16 v[0:3], v[244:245], v[212:213], 0
    v_lshlrev_b32_sdwa v51, 1, v51 dst_sel:DWORD dst_unused:UNUSED_PAD src0_sel:DWORD src1_sel:WORD_1
    v_or_b32 v68, v68, v69
    v_add_u32 v171, s97, v203
    v_add_u32 v251, 31488, v251
    v_mfma_f32_16x16x32_bf16 v[56:59], a[24:27], v[96:99], 0
    ds_read_u16 v50, v50 offset:0
    v_lshlrev_b32_sdwa v55, 1, v55 dst_sel:DWORD dst_unused:UNUSED_PAD src0_sel:DWORD src1_sel:WORD_1
    v_mfma_f32_16x16x32_bf16 v[56:59], a[28:31], v[100:103], v[56:59]
    ds_read2_b32 v[218:219], v225 offset0:40 offset1:60
    v_or_b32_e64 v66, v64, v65
    v_mfma_f32_16x16x32_bf16 v[56:59], a[32:35], v[104:107], v[56:59]
    s_add_u32 s16, s16, s14
    v_rcp_f16_sdwa v243, v243 dst_sel:WORD_0 dst_unused:UNUSED_PRESERVE src0_sel:WORD_0
    v_mfma_f32_16x16x32_bf16 v[60:63], a[44:47], v[104:107], 0
    ds_read_u16 v76, v76 offset:0
    v_mad_i32_i24 v251, v224, s99, v251
    v_mfma_f32_16x16x32_bf16 v[60:63], a[40:43], v[100:103], v[60:63]
    s_waitcnt lgkmcnt(7)
    ds_read_u16 v54, v54 offset:0
    v_lshlrev_b32_sdwa v59, 1, v59 dst_sel:DWORD dst_unused:UNUSED_PAD src0_sel:DWORD src1_sel:WORD_1
    v_mul_hi_u32_u24 v224, 39147, v252
    v_or_b32_e64 v69, v70, v71
    v_lshlrev_b32_sdwa v52, 1, v52 dst_sel:DWORD dst_unused:UNUSED_PAD src0_sel:DWORD src1_sel:WORD_1
    v_mfma_f32_16x16x32_bf16 v[60:63], a[36:39], v[96:99], v[60:63]
    ds_read_u16_d16_hi v73, v73 offset:0
    v_add_u32 v225, 1280, v225
    v_mfma_f32_16x16x32_bf16 v[24:27], a[240:243], v[66:69], v[24:27]
    ds_read_addtid_b32 v199 offset:5120
    ds_read_u16 v48, v48 offset:0
    v_mfma_f32_16x16x32_bf16 v[28:31], a[244:247], v[66:69], v[28:31]
    v_lshlrev_b32_sdwa v58, 1, v58 dst_sel:DWORD dst_unused:UNUSED_PAD src0_sel:DWORD src1_sel:WORD_1
    v_add_u32 v252, 31488, v252
    v_mfma_f32_16x16x32_bf16 v[32:35], a[248:251], v[66:69], v[32:35]
    ds_read_u16_d16_hi v51, v51 offset:0
    v_lshlrev_b32_sdwa v57, 1, v57 dst_sel:DWORD dst_unused:UNUSED_PAD src0_sel:DWORD src1_sel:WORD_1
    v_mad_i32_i24 v252, v224, s99, v252
    v_mfma_f32_16x16x32_bf16 v[36:39], a[252:255], v[66:69], v[36:39]
    ds_read2_b32 v[220:221], v225 offset0:0 offset1:20
    v_or_b32_e64 v75, v74, v75
    v_mfma_f32_16x16x32_bf16 v[40:43], v[226:229], v[66:69], v[40:43]
    ds_read2_b32 v[222:223], v225 offset0:40 offset1:60
    v_lshlrev_b32_sdwa v60, 1, v60 dst_sel:DWORD dst_unused:UNUSED_PAD src0_sel:DWORD src1_sel:WORD_1
    v_mfma_f32_16x16x32_bf16 v[44:47], v[230:233], v[66:69], v[44:47]
    ds_read_u16 v52, v52 offset:0
    v_lshlrev_b32_sdwa v56, 1, v56 dst_sel:DWORD dst_unused:UNUSED_PAD src0_sel:DWORD src1_sel:WORD_1
    v_mfma_f32_16x16x32_bf16 v[64:67], a[48:51], v[96:99], 0
    v_rcp_f16_sdwa v243, v243 dst_sel:WORD_1 dst_unused:UNUSED_PRESERVE src0_sel:WORD_1
    v_mfma_f32_16x16x32_bf16 v[64:67], a[52:55], v[100:103], v[64:67]
    v_lshlrev_b32_sdwa v53, 1, v53 dst_sel:DWORD dst_unused:UNUSED_PAD src0_sel:DWORD src1_sel:WORD_1
    v_lshlrev_b32_sdwa v62, 1, v62 dst_sel:DWORD dst_unused:UNUSED_PAD src0_sel:DWORD src1_sel:WORD_1
    v_mfma_f32_16x16x32_bf16 v[64:67], a[56:59], v[104:107], v[64:67]
    s_addc_u32 s17, s17, s1
    ds_read_u16_d16_hi v53, v53 offset:0
    v_fma_mix_f32 v79, v79, v243, 0 op_sel:[0,1,0] op_sel_hi:[0,1,0]
    v_mfma_f32_16x16x32_bf16 v[68:71], a[68:71], v[104:107], 0
    s_waitcnt lgkmcnt(6)
    ds_read_u16 v58, v58 offset:0
    ds_read_u16_d16_hi v49, v49 offset:0
    v_cmp_lt_u32_e64 vcc, v199, v195
    v_mfma_f32_16x16x16_bf16 v[8:11], v[244:245], v[216:217], 0
    v_lshlrev_b32_sdwa v64, 1, v64 dst_sel:DWORD dst_unused:UNUSED_PAD src0_sel:DWORD src1_sel:WORD_1
    v_add_u32_sdwa v224, s45, v207 dst_sel:DWORD dst_unused:UNUSED_PAD src0_sel:DWORD src1_sel:WORD_0
    v_or_b32_e64 v76, v76, v77
    v_mfma_f32_16x16x16_bf16 v[12:15], v[244:245], v[218:219], 0
    v_lshlrev_b32_sdwa v61, 1, v61 dst_sel:DWORD dst_unused:UNUSED_PAD src0_sel:DWORD src1_sel:WORD_1
    v_or_b32_e64 v74, v72, v73
    v_fma_mix_f32 v78, v78, v243, 0 op_sel:[0,0,0] op_sel_hi:[0,1,0]
    v_cvt_pk_bf16_f32 v77, v78, v79
    v_mfma_f32_16x16x32_bf16 v[68:71], a[64:67], v[100:103], v[68:71]
    s_waitcnt vmcnt(13)
    s_cbranch_vccnz L_retry0
L_back0:
    ds_read_b128 v[208:211], v203 offset:61440
    v_mfma_f32_16x16x16_bf16 v[4:7], v[244:245], v[214:215], 0
    ds_write2_b32 v224, v168, v169 offset0:0 offset1:20
    v_lshlrev_b32_sdwa v63, 1, v63 dst_sel:DWORD dst_unused:UNUSED_PAD src0_sel:DWORD src1_sel:WORD_1
    v_mfma_f32_16x16x32_bf16 v[68:71], a[60:63], v[96:99], v[68:71]
    s_waitcnt lgkmcnt(6)
    ds_read_b128 v[216:219], v203 offset:63488
    ds_read_b128 v[212:215], v203 offset:62464
    ds_read_u16 v56, v56 offset:0
    v_mfma_f32_16x16x16_bf16 v[20:23], v[244:245], v[222:223], 0
    v_lshlrev_b32_sdwa v66, 1, v66 dst_sel:DWORD dst_unused:UNUSED_PAD src0_sel:DWORD src1_sel:WORD_1
    v_lshlrev_b32_sdwa v67, 1, v67 dst_sel:DWORD dst_unused:UNUSED_PAD src0_sel:DWORD src1_sel:WORD_1
    v_or_b32 v51, v50, v51
    v_mfma_f32_16x16x16_bf16 v[16:19], v[244:245], v[220:221], 0
    v_cvt_pk_f16_f32 v242, v70, v71
    v_pk_fma_f16 v243, v242, v242, s48
    v_pk_mul_f16 v243, v242, v243 neg_lo:[1,0] neg_hi:[1,0]
    v_exp_f16_sdwa v243, v243 dst_sel:WORD_0 dst_unused:UNUSED_PRESERVE src0_sel:WORD_0
    v_mfma_f32_16x16x32_bf16 v[24:27], v[234:237], v[74:77], v[24:27]
    ds_read_b128 v[220:223], v203 offset:64512
    v_lshlrev_b32_sdwa v65, 1, v65 dst_sel:DWORD dst_unused:UNUSED_PAD src0_sel:DWORD src1_sel:WORD_1
    v_mfma_f32_16x16x32_bf16 v[28:31], v[238:241], v[74:77], v[28:31]
    s_waitcnt vmcnt(10)
    ds_read_u16 v62, v62 offset:0
    ds_write2_b32 v224, v173, v174 offset0:24 offset1:44
    v_mfma_f32_16x16x32_bf16 v[32:35], v[80:83], v[74:77], v[32:35]
    s_waitcnt lgkmcnt(8)
    v_or_b32_e64 v50, v48, v49
    v_cvt_pk_bf16_f32 v24, v24, v25
    v_mfma_f32_16x16x32_bf16 v[36:39], v[84:87], v[74:77], v[36:39]
    s_add_u32 s46, s46, 6
    ds_read_u16_d16_hi v55, v55 offset:0
    v_add_u32_sdwa v225, s55, v175 dst_sel:DWORD dst_unused:UNUSED_PAD src0_sel:DWORD src1_sel:WORD_1
    v_mfma_f32_16x16x32_bf16 v[40:43], v[88:91], v[74:77], v[40:43]
    v_or_b32 v52, v52, v53
    v_cvt_pk_bf16_f32 v32, v32, v33
    v_mfma_f32_16x16x32_bf16 v[44:47], v[92:95], v[74:77], v[44:47]
    ds_read_u16_d16_hi v67, v67 offset:0
    ds_read_u16_d16_hi v59, v59 offset:0
    v_mfma_f32_16x16x32_bf16 v[72:75], a[72:75], v[96:99], 0
    s_add_u32 s44, s44, s15
    ds_write2_b32 v224, v170, v172 offset0:40 offset1:4
    v_mfma_f32_16x16x32_bf16 v[72:75], a[76:79], v[100:103], v[72:75]
    s_nop 0
    v_exp_f16_sdwa v243, v243 dst_sel:WORD_1 dst_unused:UNUSED_PRESERVE src0_sel:WORD_1
    v_cvt_pk_bf16_f32 v40, v40, v41
    v_lshlrev_b32_sdwa v69, 1, v69 dst_sel:DWORD dst_unused:UNUSED_PAD src0_sel:DWORD src1_sel:WORD_1
    v_mfma_f32_16x16x32_bf16 v[72:75], a[80:83], v[104:107], v[72:75]
    s_waitcnt lgkmcnt(6)
    ds_read_u16_d16_hi v63, v63 offset:0
    ds_read_u16 v64, v64 offset:0
    v_cvt_pk_bf16_f32 v41, v42, v43
    v_cvt_pk_bf16_f32 v33, v34, v35
    v_cvt_pk_bf16_f32 v25, v26, v27
    v_pk_add_f32 v[216:217], v[216:217], v[220:221]
    v_pk_add_f32 v[218:219], v[218:219], v[222:223]
    v_pk_add_f32 v[210:211], v[210:211], v[214:215]
    v_pk_add_f32 v[208:209], v[208:209], v[212:213]
    v_pk_add_f32 v[246:247], v[208:209], v[216:217]
    v_lshlrev_b32_sdwa v68, 1, v68 dst_sel:DWORD dst_unused:UNUSED_PAD src0_sel:DWORD src1_sel:WORD_1
    v_pk_add_f32 v[248:249], v[210:211], v[218:219]
    v_pk_mul_f32 v[248:249], s[52:53], v[248:249] op_sel_hi:[0,1]
    v_pk_mul_f32 v[246:247], s[52:53], v[246:247] op_sel_hi:[0,1]
    v_mfma_f32_16x16x32_bf16 v[76:79], a[92:95], v[104:107], 0
    s_nop 0
    ds_read_b128 v[208:211], v171 offset:0
    v_cvt_pk_bf16_f32 v34, v36, v37
    v_mfma_f32_16x16x32_bf16 v[76:79], a[88:91], v[100:103], v[76:79]
    ds_read_u16 v68, v68 offset:0
    ds_read_u16_d16_hi v61, v61 offset:0
    v_lshlrev_b32_sdwa v73, 1, v73 dst_sel:DWORD dst_unused:UNUSED_PAD src0_sel:DWORD src1_sel:WORD_1
    v_pk_fma_f16 v243, v243, s50, s50
    v_mfma_f32_16x16x32_bf16 v[76:79], a[84:87], v[96:99], v[76:79]
    s_waitcnt lgkmcnt(8)
    ds_read_b128 v[216:219], v171 offset:2048
    ds_write2_b32 v224, v176, v177 offset0:8 offset1:28
    v_or_b32 v53, v54, v55
    v_lshlrev_b32_sdwa v72, 1, v72 dst_sel:DWORD dst_unused:UNUSED_PAD src0_sel:DWORD src1_sel:WORD_1
    v_pk_fma_f32 v[248:249], v[246:247], v[246:247], v[248:249] neg_lo:[1,0,0] neg_hi:[1,0,0]
    v_max_f32 v249, 0, v249
    v_max_f32 v248, 0, v248
    v_mfma_f32_16x16x32_bf16 v[0:3], a[144:147], v[50:53], v[0:3]
    ds_read2_b32 v[220:221], v225 offset0:0 offset1:20
    ds_read_u16_d16_hi v65, v65 offset:0
    v_cvt_pk_bf16_f32 v27, v30, v31
    v_mfma_f32_16x16x32_bf16 v[4:7], a[148:151], v[50:53], v[4:7]
    s_add_u32 s47, s44, s13
    v_add_f32 v249, s51, v249
    v_lshlrev_b32_sdwa v79, 1, v79 dst_sel:DWORD dst_unused:UNUSED_PAD src0_sel:DWORD src1_sel:WORD_1
    v_rsq_f32 v249, v249
    v_add_f32 v248, s51, v248
    v_mfma_f32_16x16x32_bf16 v[8:11], a[152:155], v[50:53], v[8:11]
    ds_read_u16_d16_hi v73, v73 offset:0
    v_cvt_pk_bf16_f32 v42, v44, v45
    v_rsq_f32_e64 v248, v248
    v_mfma_f32_16x16x32_bf16 v[12:15], a[156:159], v[50:53], v[12:15]
    ds_read_b128 v[212:215], v171 offset:1024
    ds_read_u16 v66, v66 offset:0
    v_lshlrev_b32_sdwa v77, 1, v77 dst_sel:DWORD dst_unused:UNUSED_PAD src0_sel:DWORD src1_sel:WORD_1
    v_cvt_pk_bf16_f32 v43, v46, v47
    v_cvt_pk_bf16_f32 v35, v38, v39
    v_mfma_f32_16x16x32_bf16 v[16:19], a[160:163], v[50:53], v[16:19]
    s_cmp_ge_u32 s45, 109716
    v_mul_f32_e64 v249, s49, v249
    v_rcp_f16_sdwa v243, v243 dst_sel:WORD_0 dst_unused:UNUSED_PRESERVE src0_sel:WORD_0
    v_mfma_f32_16x16x32_bf16 v[20:23], a[164:167], v[50:53], v[20:23]
    ds_read_u16_d16_hi v57, v57 offset:0
    v_lshlrev_b32_sdwa v78, 1, v78 dst_sel:DWORD dst_unused:UNUSED_PAD src0_sel:DWORD src1_sel:WORD_1
    v_cvt_pk_bf16_f32 v26, v28, v29
    v_mul_f32_e64 v247, -v247, v249
    v_mfma_f32_16x16x32_bf16 v[48:51], a[96:99], v[96:99], 0
    ds_read_u16 v72, v72 offset:0
    v_mul_f32_e64 v248, s49, v248
    v_mfma_f32_16x16x32_bf16 v[48:51], a[100:103], v[100:103], v[48:51]
    v_lshlrev_b32_sdwa v75, 1, v75 dst_sel:DWORD dst_unused:UNUSED_PAD src0_sel:DWORD src1_sel:WORD_1
    v_mul_f32_e64 v246, -v246, v248
    v_mfma_f32_16x16x32_bf16 v[48:51], a[104:107], v[104:107], v[48:51]
    ds_read_u16 v60, v60 offset:0
    ds_read_u16_d16_hi v79, v79 offset:0
    v_mfma_f32_16x16x32_bf16 v[52:55], a[116:119], v[104:107], 0
    ds_write_b128 v171, v[32:35] offset:1024
    v_pk_fma_f32 v[150:151], v[150:151], v[248:249], v[246:247]
    v_pk_fma_f32 v[128:129], v[128:129], v[248:249], v[246:247]
    v_pk_fma_f32 v[124:125], v[124:125], v[248:249], v[246:247]
    v_pk_fma_f32 v[122:123], v[122:123], v[248:249], v[246:247]
    v_pk_fma_f32 v[132:133], v[132:133], v[248:249], v[246:247]
    v_pk_fma_f32 v[148:149], v[148:149], v[248:249], v[246:247]
    v_pk_fma_f32 v[144:145], v[144:145], v[248:249], v[246:247]
    v_pk_fma_f32 v[138:139], v[138:139], v[248:249], v[246:247]
    v_pk_fma_f32 v[162:163], v[162:163], v[248:249], v[246:247]
    v_pk_fma_f32 v[120:121], v[120:121], v[248:249], v[246:247]
    v_pk_fma_f32 v[130:131], v[130:131], v[248:249], v[246:247]
    v_pk_fma_f32 v[156:157], v[156:157], v[248:249], v[246:247]
    v_mfma_f32_16x16x32_bf16 v[52:55], a[112:115], v[100:103], v[52:55]
    ds_write_b128 v171, v[40:43] offset:2048
    v_pk_fma_f32 v[142:143], v[142:143], v[248:249], v[246:247]
    v_pk_fma_f32 v[140:141], v[140:141], v[248:249], v[246:247]
    v_pk_fma_f32 v[136:137], v[136:137], v[248:249], v[246:247]
    v_pk_fma_f32 v[126:127], v[126:127], v[248:249], v[246:247]
    v_lshlrev_b32_sdwa v74, 1, v74 dst_sel:DWORD dst_unused:UNUSED_PAD src0_sel:DWORD src1_sel:WORD_1
    v_pk_fma_f32 v[134:135], v[134:135], v[248:249], v[246:247]
    v_lshlrev_b32_sdwa v49, 1, v49 dst_sel:DWORD dst_unused:UNUSED_PAD src0_sel:DWORD src1_sel:WORD_1
    v_lshlrev_b32_sdwa v50, 1, v50 dst_sel:DWORD dst_unused:UNUSED_PAD src0_sel:DWORD src1_sel:WORD_1
    v_mfma_f32_16x16x32_bf16 v[52:55], a[108:111], v[96:99], v[52:55]
    s_waitcnt vmcnt(8) lgkmcnt(3)
    ds_read_u16 v74, v74 offset:0
    ds_read2_b32 v[222:223], v225 offset0:40 offset1:60
    ds_write_b128 v171, v[24:27] offset:0
    v_or_b32 v60, v60, v61
    v_pk_fma_f32 v[160:161], v[160:161], v[248:249], v[246:247]
    v_pk_fma_f32 v[154:155], v[154:155], v[248:249], v[246:247]
    v_mfma_f32_16x16x16_bf16 v[4:7], v[244:245], v[210:211], v[4:7]
    v_lshlrev_b32_sdwa v51, 1, v51 dst_sel:DWORD dst_unused:UNUSED_PAD src0_sel:DWORD src1_sel:WORD_1
    v_lshlrev_b32_sdwa v55, 1, v55 dst_sel:DWORD dst_unused:UNUSED_PAD src0_sel:DWORD src1_sel:WORD_1
    v_or_b32_e64 v59, v58, v59
    v_mfma_f32_16x16x16_bf16 v[0:3], v[244:245], v[208:209], v[0:3]
    v_add_u32 v225, 1280, v225
    v_or_b32_e64 v61, v62, v63
    v_lshlrev_b32_sdwa v52, 1, v52 dst_sel:DWORD dst_unused:UNUSED_PAD src0_sel:DWORD src1_sel:WORD_1
    v_mfma_f32_16x16x16_bf16 v[20:23], v[244:245], v[218:219], v[20:23]
    ds_read_u16 v78, v78 offset:0
    ds_read_u16_d16_hi v75, v75 offset:0
    v_mfma_f32_16x16x16_bf16 v[12:15], v[244:245], v[214:215], v[12:15]
    ds_write2_b32 v224, v178, v180 offset0:48 offset1:12
    v_mfma_f32_16x16x16_bf16 v[8:11], v[244:245], v[212:213], v[8:11]
    v_cvt_pk_bf16_f32 v120, v120, v122
    v_rcp_f16_sdwa v243, v243 dst_sel:WORD_1 dst_unused:UNUSED_PRESERVE src0_sel:WORD_1
    v_lshlrev_b32_sdwa v54, 1, v54 dst_sel:DWORD dst_unused:UNUSED_PAD src0_sel:DWORD src1_sel:WORD_1
    v_cvt_pk_bf16_f32 v122, v128, v130
    v_add_u32_sdwa v171, s8, v207 dst_sel:DWORD dst_unused:UNUSED_PAD src0_sel:DWORD src1_sel:WORD_1
    v_mfma_f32_16x16x16_bf16 v[24:27], v[244:245], v[220:221], 0
    ds_read2_b32 v[210:211], v225 offset0:40 offset1:60
    ds_read_u16_d16_hi v77, v77 offset:0
    v_or_b32_e64 v58, v56, v57
    v_mfma_f32_16x16x16_bf16 v[16:19], v[244:245], v[216:217], v[16:19]
    v_cvt_pk_bf16_f32 v128, v121, v123
    v_lshlrev_b32_sdwa v76, 1, v76 dst_sel:DWORD dst_unused:UNUSED_PAD src0_sel:DWORD src1_sel:WORD_1
    v_cvt_pk_bf16_f32 v121, v124, v126
    v_or_b32_e64 v67, v66, v67
    v_mfma_f32_16x16x32_bf16 v[0:3], a[168:171], v[58:61], v[0:3]
    ds_read_u16_d16_hi v69, v69 offset:0
    v_cvt_pk_bf16_f32 v136, v136, v138
    v_mfma_f32_16x16x32_bf16 v[4:7], a[172:175], v[58:61], v[4:7]
    ds_read2_b32 v[208:209], v225 offset0:0 offset1:20
    v_cvt_pk_bf16_f32 v130, v129, v131
    v_mfma_f32_16x16x32_bf16 v[8:11], a[176:179], v[58:61], v[8:11]
    s_cselect_b32 s56, s99, 0
    v_lshlrev_b32_sdwa v48, 1, v48 dst_sel:DWORD dst_unused:UNUSED_PAD src0_sel:DWORD src1_sel:WORD_1
    v_fma_mix_f32 v70, v70, v243, 0 op_sel:[0,0,0] op_sel_hi:[0,1,0]
    v_mfma_f32_16x16x32_bf16 v[12:15], a[180:183], v[58:61], v[12:15]
    s_add_u32 s45, s45, s56
    ds_read_u16_d16_hi v51, v51 offset:0
    v_add_u32 v225, 1280, v225
    v_mfma_f32_16x16x32_bf16 v[16:19], a[184:187], v[58:61], v[16:19]
    ds_write2_b32 v224, v181, v182 offset0:32 offset1:52
    v_cvt_pk_bf16_f32 v123, v132, v134
    v_mfma_f32_16x16x32_bf16 v[20:23], a[188:191], v[58:61], v[20:23]
    s_waitcnt vmcnt(6)
    ds_read2_b32 v[214:215], v225 offset0:40 offset1:60
    ds_write2_b32 v224, v184, v185 offset0:16 offset1:36
    v_or_b32 v66, v64, v65
    v_pk_fma_f32 v[152:153], v[152:153], v[248:249], v[246:247]
    v_mfma_f32_16x16x32_bf16 v[56:59], a[120:123], v[96:99], 0
    ds_read_u16 v50, v50 offset:0
    v_cvt_pk_bf16_f32 v131, v133, v135
    v_cvt_pk_bf16_f32 v129, v125, v127
    v_mfma_f32_16x16x32_bf16 v[56:59], a[124:127], v[100:103], v[56:59]
    ds_read_u16 v52, v52 offset:0
    ds_write_b128 v171, v[120:123] offset:0
    v_pk_fma_f32 v[164:165], v[164:165], v[248:249], v[246:247]
    v_pk_fma_f32 v[146:147], v[146:147], v[248:249], v[246:247]
    v_cvt_pk_bf16_f32 v152, v152, v154
    v_lshlrev_b32_sdwa v53, 1, v53 dst_sel:DWORD dst_unused:UNUSED_PAD src0_sel:DWORD src1_sel:WORD_1
    v_mfma_f32_16x16x32_bf16 v[56:59], a[128:131], v[104:107], v[56:59]
    s_waitcnt lgkmcnt(8)
    v_or_b32 v68, v68, v69
    v_fma_mix_f32 v71, v71, v243, 0 op_sel:[0,1,0] op_sel_hi:[0,1,0]
    v_mfma_f32_16x16x32_bf16 v[60:63], a[140:143], v[104:107], 0
    ds_write_b32 v224, v186 offset:224
    v_mfma_f32_16x16x32_bf16 v[60:63], a[136:139], v[100:103], v[60:63]
    s_add_u32 s45, s45, 31488
    ds_read_u16 v54, v54 offset:0
    v_cvt_pk_bf16_f32 v69, v70, v71
    v_mfma_f32_16x16x32_bf16 v[60:63], a[132:135], v[96:99], v[60:63]
    ds_read2_b32 v[212:213], v225 offset0:0 offset1:20
    ds_read_u16 v76, v76 offset:0
    v_mfma_f32_16x16x32_bf16 v[0:3], a[192:195], v[66:69], v[0:3]
    ds_write_b128 v171, v[128:131] offset:512
    v_mfma_f32_16x16x32_bf16 v[4:7], a[196:199], v[66:69], v[4:7]
    s_cmp_ge_u32 s55, 109716
    v_cvt_pk_bf16_f32 v138, v144, v146
    v_add_u32_sdwa v224, s55, v207 dst_sel:DWORD dst_unused:UNUSED_PAD src0_sel:DWORD src1_sel:WORD_0
    v_mfma_f32_16x16x32_bf16 v[8:11], a[200:203], v[66:69], v[8:11]
    v_lshlrev_b32_sdwa v57, 1, v57 dst_sel:DWORD dst_unused:UNUSED_PAD src0_sel:DWORD src1_sel:WORD_1
    v_lshlrev_b32_sdwa v58, 1, v58 dst_sel:DWORD dst_unused:UNUSED_PAD src0_sel:DWORD src1_sel:WORD_1
    v_cvt_pk_bf16_f32 v144, v137, v139
    v_mov_b64_e64 v[96:97], 0
    v_mfma_f32_16x16x32_bf16 v[12:15], a[204:207], v[66:69], v[12:15]
    ds_read_u16_d16_hi v49, v49 offset:0
    ds_read_u16_d16_hi v55, v55 offset:0
    v_mfma_f32_16x16x32_bf16 v[16:19], a[208:211], v[66:69], v[16:19]
    s_waitcnt vmcnt(3)
    ds_write2_b32 v224, v188, v189 offset0:0 offset1:20
    v_mfma_f32_16x16x32_bf16 v[20:23], a[212:215], v[66:69], v[20:23]
    v_or_b32 v75, v74, v75
    v_cvt_pk_bf16_f32 v154, v160, v162
    v_mfma_f32_16x16x32_bf16 v[64:67], a[0:3], v[108:111], 0
    v_cvt_pk_bf16_f32 v146, v145, v147
    v_lshlrev_b32_sdwa v56, 1, v56 dst_sel:DWORD dst_unused:UNUSED_PAD src0_sel:DWORD src1_sel:WORD_1
    v_mfma_f32_16x16x32_bf16 v[64:67], a[4:7], v[112:115], v[64:67]
    ds_read_u16 v58, v58 offset:0
    ds_read_u16_d16_hi v53, v53 offset:0
    v_mfma_f32_16x16x32_bf16 v[64:67], a[8:11], v[116:119], v[64:67]
    s_waitcnt lgkmcnt(6)
    ds_write2_b32 v224, v190, v192 offset0:40 offset1:4
    v_mfma_f32_16x16x16_bf16 v[36:39], v[244:245], v[210:211], 0
    v_or_b32 v51, v50, v51
    v_cvt_pk_bf16_f32 v145, v141, v143
    v_lshlrev_b32_sdwa v61, 1, v61 dst_sel:DWORD dst_unused:UNUSED_PAD src0_sel:DWORD src1_sel:WORD_1
    v_mfma_f32_32x32x8_bf16 v[120:135], v[96:97], v[96:97], 0
    v_cvt_pk_bf16_f32 v137, v140, v142
    v_cvt_pk_f16_f32 v242, v62, v63
    v_cvt_pk_bf16_f32 v162, v161, v163
    v_or_b32_e64 v74, v72, v73
    v_cvt_pk_bf16_f32 v139, v148, v150
    v_lshlrev_b32_sdwa v60, 1, v60 dst_sel:DWORD dst_unused:UNUSED_PAD src0_sel:DWORD src1_sel:WORD_1
    v_pk_fma_f16 v243, v242, v242, s48
    v_mfma_f32_16x16x16_bf16 v[28:31], v[244:245], v[222:223], 0
    s_cselect_b32 s56, s99, 0
    ds_read_u16 v48, v48 offset:0
    ds_read_u16_d16_hi v61, v61 offset:0
    v_mfma_f32_16x16x16_bf16 v[32:35], v[244:245], v[208:209], 0
    ds_write_b128 v171, v[136:139] offset:2048
    v_or_b32 v76, v76, v77
    v_pk_fma_f32 v[166:167], v[166:167], v[248:249], v[246:247]
    v_pk_fma_f32 v[158:159], v[158:159], v[248:249], v[246:247]
    v_lshlrev_b32_sdwa v59, 1, v59 dst_sel:DWORD dst_unused:UNUSED_PAD src0_sel:DWORD src1_sel:WORD_1
    v_mfma_f32_16x16x32_bf16 v[68:71], a[20:23], v[116:119], 0
    v_or_b32_e64 v77, v78, v79
    v_pk_mul_f16 v243, v242, v243 neg_lo:[1,0] neg_hi:[1,0]
    v_mfma_f32_16x16x32_bf16 v[68:71], a[16:19], v[112:115], v[68:71]
    s_add_u32 s55, s55, s56
    ds_read_u16 v60, v60 offset:0
    v_lshlrev_b32_sdwa v67, 1, v67 dst_sel:DWORD dst_unused:UNUSED_PAD src0_sel:DWORD src1_sel:WORD_1
    v_mfma_f32_16x16x32_bf16 v[68:71], a[12:15], v[108:111], v[68:71]
    s_waitcnt vmcnt(2)
    ds_write2_b32 v224, v196, v197 offset0:8 offset1:28
    v_mfma_f32_16x16x32_bf16 v[0:3], a[216:219], v[74:77], v[0:3]
    v_exp_f16_sdwa v243, v243 dst_sel:WORD_0 dst_unused:UNUSED_PRESERVE src0_sel:WORD_0
    v_mfma_f32_16x16x32_bf16 v[4:7], a[220:223], v[74:77], v[4:7]
    ds_read_u16_d16_hi v59, v59 offset:0
    ds_read_u16_d16_hi v57, v57 offset:0
    v_mfma_f32_16x16x32_bf16 v[8:11], a[224:227], v[74:77], v[8:11]
    s_add_u32 s55, s55, 31488
    v_lshlrev_b32_sdwa v66, 1, v66 dst_sel:DWORD dst_unused:UNUSED_PAD src0_sel:DWORD src1_sel:WORD_1
    v_lshlrev_b32_sdwa v65, 1, v65 dst_sel:DWORD dst_unused:UNUSED_PAD src0_sel:DWORD src1_sel:WORD_1
    v_mfma_f32_16x16x32_bf16 v[12:15], a[228:231], v[74:77], v[12:15]
    ds_write2_b32 v224, v193, v194 offset0:24 offset1:44
    v_mfma_f32_16x16x32_bf16 v[16:19], a[232:235], v[74:77], v[16:19]
    s_waitcnt lgkmcnt(7)
    v_or_b32 v50, v48, v49
    v_cvt_pk_bf16_f32 v147, v149, v151
    v_mfma_f32_16x16x32_bf16 v[20:23], a[236:239], v[74:77], v[20:23]
    s_waitcnt vmcnt(1)
    ds_write2_b32 v224, v198, v200 offset0:48 offset1:12
    v_mfma_f32_16x16x32_bf16 v[72:75], a[24:27], v[108:111], 0
    s_nop 0
    v_cvt_pk_bf16_f32 v160, v153, v155
    v_lshlrev_b32_sdwa v68, 1, v68 dst_sel:DWORD dst_unused:UNUSED_PAD src0_sel:DWORD src1_sel:WORD_1
    v_mfma_f32_16x16x32_bf16 v[72:75], a[28:31], v[112:115], v[72:75]
    ds_read_u16 v56, v56 offset:0
    v_lshlrev_b32_sdwa v71, 1, v71 dst_sel:DWORD dst_unused:UNUSED_PAD src0_sel:DWORD src1_sel:WORD_1
    v_mfma_f32_16x16x32_bf16 v[72:75], a[32:35], v[116:119], v[72:75]
    ds_read_u16 v68, v68 offset:0
    v_or_b32_e64 v52, v52, v53
    v_mfma_f32_16x16x32_bf16 v[76:79], a[44:47], v[116:119], 0
    v_or_b32_e64 v53, v54, v55
    v_lshlrev_b32_sdwa v64, 1, v64 dst_sel:DWORD dst_unused:UNUSED_PAD src0_sel:DWORD src1_sel:WORD_1
    v_mfma_f32_16x16x32_bf16 v[76:79], a[40:43], v[112:115], v[76:79]
    ds_read_u16 v64, v64 offset:0
    ds_read_u16_d16_hi v65, v65 offset:0
    v_exp_f16_sdwa v243, v243 dst_sel:WORD_1 dst_unused:UNUSED_PRESERVE src0_sel:WORD_1
    v_mfma_f32_16x16x32_bf16 v[76:79], a[36:39], v[108:111], v[76:79]
    ds_write_b128 v171, v[144:147] offset:2560
    v_cvt_pk_bf16_f32 v163, v165, v167
    v_mfma_f32_16x16x32_bf16 v[0:3], a[240:243], v[50:53], v[0:3]
    v_cvt_pk_bf16_f32 v161, v157, v159
    v_lshlrev_b32_sdwa v75, 1, v75 dst_sel:DWORD dst_unused:UNUSED_PAD src0_sel:DWORD src1_sel:WORD_1
    v_mfma_f32_16x16x32_bf16 v[4:7], a[244:247], v[50:53], v[4:7]
    v_pk_fma_f16 v243, v243, s50, s50
    v_cvt_pk_bf16_f32 v155, v164, v166
    v_mfma_f32_16x16x32_bf16 v[8:11], a[248:251], v[50:53], v[8:11]
    ds_read_u16_d16_hi v71, v71 offset:0
    v_lshlrev_b32_sdwa v69, 1, v69 dst_sel:DWORD dst_unused:UNUSED_PAD src0_sel:DWORD src1_sel:WORD_1
    v_mfma_f32_16x16x32_bf16 v[12:15], a[252:255], v[50:53], v[12:15]
    ds_write2_b32 v224, v201, v202 offset0:32 offset1:52
    v_cvt_pk_bf16_f32 v153, v156, v158
    v_mfma_f32_16x16x32_bf16 v[16:19], v[226:229], v[50:53], v[16:19]
    ds_read_u16 v66, v66 offset:0
    v_lshlrev_b32_sdwa v73, 1, v73 dst_sel:DWORD dst_unused:UNUSED_PAD src0_sel:DWORD src1_sel:WORD_1
    v_mfma_f32_16x16x32_bf16 v[20:23], v[230:233], v[50:53], v[20:23]
    s_waitcnt lgkmcnt(7)
    ds_read_u16_d16_hi v73, v73 offset:0
    v_rcp_f16_sdwa v243, v243 dst_sel:WORD_0 dst_unused:UNUSED_PRESERVE src0_sel:WORD_0
    v_mfma_f32_32x32x8_bf16 v[136:151], v[96:97], v[96:97], 0
    ds_read_u16_d16_hi v69, v69 offset:0
    ds_write_b128 v171, v[152:155] offset:4096
    v_lshlrev_b32_sdwa v72, 1, v72 dst_sel:DWORD dst_unused:UNUSED_PAD src0_sel:DWORD src1_sel:WORD_1
    v_xor_b32 v255, 800, v255
    v_mfma_f32_16x16x16_bf16 v[44:47], v[244:245], v[214:215], 0
    v_rcp_f16_sdwa v243, v243 dst_sel:WORD_1 dst_unused:UNUSED_PRESERVE src0_sel:WORD_1
    v_or_b32 v59, v58, v59
    v_mfma_f32_16x16x16_bf16 v[40:43], v[244:245], v[212:213], 0
    v_or_b32 v58, v56, v57
    v_or_b32 v60, v60, v61
    v_lshlrev_b32_sdwa v70, 1, v70 dst_sel:DWORD dst_unused:UNUSED_PAD src0_sel:DWORD src1_sel:WORD_1
    v_fma_mix_f32 v62, v62, v243, 0 op_sel:[0,0,0] op_sel_hi:[0,1,0]
    v_mfma_f32_16x16x32_bf16 v[48:51], a[48:51], v[108:111], 0
    ds_read_u16_d16_hi v67, v67 offset:0
    ds_read_u16_d16_hi v75, v75 offset:0
    v_mfma_f32_16x16x32_bf16 v[48:51], a[52:55], v[112:115], v[48:51]
    ds_write_b128 v171, v[160:163] offset:4608
    v_mfma_f32_16x16x32_bf16 v[48:51], a[56:59], v[116:119], v[48:51]
    v_add_u32_e64 v195, 1, v195
    v_lshlrev_b32_sdwa v74, 1, v74 dst_sel:DWORD dst_unused:UNUSED_PAD src0_sel:DWORD src1_sel:WORD_1
    v_mfma_f32_16x16x32_bf16 v[52:55], a[68:71], v[116:119], 0
    v_fma_mix_f32 v63, v63, v243, 0 op_sel:[0,1,0] op_sel_hi:[0,1,0]
    v_cvt_pk_bf16_f32 v61, v62, v63
    v_mfma_f32_16x16x32_bf16 v[52:55], a[64:67], v[112:115], v[52:55]
    s_waitcnt vmcnt(0)
    ds_write_b32 v224, v206 offset:224
    v_mfma_f32_16x16x32_bf16 v[52:55], a[60:63], v[108:111], v[52:55]
    ds_read_u16 v74, v74 offset:0
    ds_write2_b32 v224, v204, v205 offset0:16 offset1:36
    v_add_u32 v171, s96, v203
    v_mfma_f32_16x16x32_bf16 v[0:3], v[234:237], v[58:61], v[0:3]
    ds_read_u16 v70, v70 offset:0
    v_lshlrev_b32_sdwa v76, 1, v76 dst_sel:DWORD dst_unused:UNUSED_PAD src0_sel:DWORD src1_sel:WORD_1
    v_mfma_f32_16x16x32_bf16 v[4:7], v[238:241], v[58:61], v[4:7]
    v_lshlrev_b32_sdwa v50, 1, v50 dst_sel:DWORD dst_unused:UNUSED_PAD src0_sel:DWORD src1_sel:WORD_1
    v_lshlrev_b32_sdwa v77, 1, v77 dst_sel:DWORD dst_unused:UNUSED_PAD src0_sel:DWORD src1_sel:WORD_1
    v_lshlrev_b32_sdwa v79, 1, v79 dst_sel:DWORD dst_unused:UNUSED_PAD src0_sel:DWORD src1_sel:WORD_1
    v_mfma_f32_16x16x32_bf16 v[8:11], v[80:83], v[58:61], v[8:11]
    ds_read_u16 v72, v72 offset:0
    ds_write_b32 v191, v195
    v_mfma_f32_16x16x32_bf16 v[12:15], v[84:87], v[58:61], v[12:15]
    v_lshlrev_b32_sdwa v52, 1, v52 dst_sel:DWORD dst_unused:UNUSED_PAD src0_sel:DWORD src1_sel:WORD_1
    v_cvt_pk_bf16_f32 v0, v0, v1
    v_mfma_f32_16x16x32_bf16 v[16:19], v[88:91], v[58:61], v[16:19]
    ds_read_u16 v76, v76 offset:0
    ds_read_u16 v50, v50 offset:0
    v_mfma_f32_16x16x32_bf16 v[20:23], v[92:95], v[58:61], v[20:23]
    s_waitcnt lgkmcnt(10)
    v_or_b32 v67, v66, v67
    v_or_b32_e64 v68, v68, v69
    v_mfma_f32_16x16x32_bf16 v[56:59], a[72:75], v[108:111], 0
    v_lshlrev_b32_sdwa v78, 1, v78 dst_sel:DWORD dst_unused:UNUSED_PAD src0_sel:DWORD src1_sel:WORD_1
    v_lshlrev_b32_sdwa v49, 1, v49 dst_sel:DWORD dst_unused:UNUSED_PAD src0_sel:DWORD src1_sel:WORD_1
    v_mfma_f32_16x16x32_bf16 v[56:59], a[76:79], v[112:115], v[56:59]
    ds_read_u16_d16_hi v79, v79 offset:0
    ds_read_u16 v78, v78 offset:0
    v_mfma_f32_16x16x32_bf16 v[56:59], a[80:83], v[116:119], v[56:59]
    v_lshlrev_b32_sdwa v53, 1, v53 dst_sel:DWORD dst_unused:UNUSED_PAD src0_sel:DWORD src1_sel:WORD_1
    v_cvt_pk_bf16_f32 v1, v2, v3
    v_or_b32_e64 v66, v64, v65
    v_lshlrev_b32_sdwa v51, 1, v51 dst_sel:DWORD dst_unused:UNUSED_PAD src0_sel:DWORD src1_sel:WORD_1
    v_mfma_f32_16x16x32_bf16 v[60:63], a[92:95], v[116:119], 0
    ds_read_u16_d16_hi v51, v51 offset:0
    v_cvt_pk_bf16_f32 v3, v6, v7
    v_mfma_f32_16x16x32_bf16 v[60:63], a[88:91], v[112:115], v[60:63]
    v_lshlrev_b32_sdwa v59, 1, v59 dst_sel:DWORD dst_unused:UNUSED_PAD src0_sel:DWORD src1_sel:WORD_1
    v_cvt_pk_bf16_f32 v2, v4, v5
    v_cvt_pk_f16_f32 v242, v54, v55
    v_lshlrev_b32_sdwa v48, 1, v48 dst_sel:DWORD dst_unused:UNUSED_PAD src0_sel:DWORD src1_sel:WORD_1
    v_mfma_f32_16x16x32_bf16 v[60:63], a[84:87], v[108:111], v[60:63]
    s_waitcnt lgkmcnt(7)
    ds_read_u16 v52, v52 offset:0
    ds_read_u16_d16_hi v77, v77 offset:0
    ds_read_u16 v48, v48 offset:0
    v_mfma_f32_32x32x8_bf16 v[152:167], v[96:97], v[96:97], 0
    buffer_store_dwordx4 v[0:3], v187, s[20:23], s44 offen offset:0 sc1
    v_pk_fma_f16 v243, v242, v242, s48
    v_pk_mul_f16 v243, v242, v243 neg_lo:[1,0] neg_hi:[1,0]
    v_or_b32 v69, v70, v71
    v_exp_f16_sdwa v243, v243 dst_sel:WORD_0 dst_unused:UNUSED_PRESERVE src0_sel:WORD_0
    v_lshlrev_b32_sdwa v63, 1, v63 dst_sel:DWORD dst_unused:UNUSED_PAD src0_sel:DWORD src1_sel:WORD_1
    v_exp_f16_sdwa v243, v243 dst_sel:WORD_1 dst_unused:UNUSED_PRESERVE src0_sel:WORD_1
    v_lshlrev_b32_sdwa v57, 1, v57 dst_sel:DWORD dst_unused:UNUSED_PAD src0_sel:DWORD src1_sel:WORD_1
    v_or_b32_e64 v75, v74, v75
    v_mfma_f32_16x16x32_bf16 v[24:27], a[144:147], v[66:69], v[24:27]
    ds_read_addtid_b32 v199 offset:5120
    ds_read_u16_d16_hi v53, v53 offset:0
    v_mfma_f32_16x16x32_bf16 v[28:31], a[148:151], v[66:69], v[28:31]
    v_pk_fma_f16 v243, v243, s50, s50
    v_lshlrev_b32_sdwa v60, 1, v60 dst_sel:DWORD dst_unused:UNUSED_PAD src0_sel:DWORD src1_sel:WORD_1
    v_mfma_f32_16x16x32_bf16 v[32:35], a[152:155], v[66:69], v[32:35]
    ds_read_u16_d16_hi v49, v49 offset:0
    v_lshlrev_b32_sdwa v61, 1, v61 dst_sel:DWORD dst_unused:UNUSED_PAD src0_sel:DWORD src1_sel:WORD_1
    v_mfma_f32_16x16x32_bf16 v[36:39], a[156:159], v[66:69], v[36:39]
    ds_read_u16_d16_hi v59, v59 offset:0
    v_cvt_pk_bf16_f32 v8, v8, v9
    v_mfma_f32_16x16x32_bf16 v[40:43], a[160:163], v[66:69], v[40:43]
    ds_read_u16 v60, v60 offset:0
    v_lshlrev_b32_sdwa v56, 1, v56 dst_sel:DWORD dst_unused:UNUSED_PAD src0_sel:DWORD src1_sel:WORD_1
    v_mfma_f32_16x16x32_bf16 v[44:47], a[164:167], v[66:69], v[44:47]
    v_rcp_f16_sdwa v243, v243 dst_sel:WORD_0 dst_unused:UNUSED_PRESERVE src0_sel:WORD_0
    v_mfma_f32_16x16x32_bf16 v[64:67], a[96:99], v[108:111], 0
    s_waitcnt lgkmcnt(6)
    v_or_b32 v76, v76, v77
    v_or_b32_e64 v74, v72, v73
    v_mfma_f32_16x16x32_bf16 v[64:67], a[100:103], v[112:115], v[64:67]
    ds_read_u16_d16_hi v63, v63 offset:0
    v_lshlrev_b32_sdwa v58, 1, v58 dst_sel:DWORD dst_unused:UNUSED_PAD src0_sel:DWORD src1_sel:WORD_1
    v_mfma_f32_16x16x32_bf16 v[64:67], a[104:107], v[116:119], v[64:67]
    ds_read_u16_d16_hi v57, v57 offset:0
    v_or_b32_e64 v77, v78, v79
    v_mfma_f32_16x16x32_bf16 v[68:71], a[116:119], v[116:119], 0
    s_waitcnt lgkmcnt(6)
    v_lshlrev_b32_sdwa v62, 1, v62 dst_sel:DWORD dst_unused:UNUSED_PAD src0_sel:DWORD src1_sel:WORD_1
    v_cmp_lt_u32 vcc, v199, v195
    v_mfma_f32_16x16x32_bf16 v[68:71], a[112:115], v[112:115], v[68:71]
    ds_read_u16_d16_hi v61, v61 offset:0
    v_cvt_pk_bf16_f32 v9, v10, v11
    v_mfma_f32_16x16x32_bf16 v[68:71], a[108:111], v[108:111], v[68:71]
    ds_read_u16 v56, v56 offset:0
    v_or_b32_e64 v51, v50, v51
    v_lshlrev_b32_sdwa v67, 1, v67 dst_sel:DWORD dst_unused:UNUSED_PAD src0_sel:DWORD src1_sel:WORD_1
    v_mfma_f32_16x16x32_bf16 v[24:27], a[168:171], v[74:77], v[24:27]
    s_cbranch_vccnz L_retry1
L_back1:
    v_mfma_f32_16x16x32_bf16 v[28:31], a[172:175], v[74:77], v[28:31]
    s_nop 0
    ds_read_u16 v62, v62 offset:0
    ds_read_u16_d16_hi v67, v67 offset:0
    v_mfma_f32_16x16x32_bf16 v[32:35], a[176:179], v[74:77], v[32:35]
    v_rcp_f16_sdwa v243, v243 dst_sel:WORD_1 dst_unused:UNUSED_PRESERVE src0_sel:WORD_1
    v_mfma_f32_16x16x32_bf16 v[36:39], a[180:183], v[74:77], v[36:39]
    v_lshlrev_b32_sdwa v70, 1, v70 dst_sel:DWORD dst_unused:UNUSED_PAD src0_sel:DWORD src1_sel:WORD_1
    v_lshlrev_b32_sdwa v66, 1, v66 dst_sel:DWORD dst_unused:UNUSED_PAD src0_sel:DWORD src1_sel:WORD_1
    v_mfma_f32_16x16x32_bf16 v[40:43], a[184:187], v[74:77], v[40:43]
    ds_read_b128 v[96:99], v255 offset:0
    ds_read_u16 v58, v58 offset:0
    v_mfma_f32_16x16x32_bf16 v[44:47], a[188:191], v[74:77], v[44:47]
    s_waitcnt lgkmcnt(10)
    ds_read_b128 v[208:211], v171 offset:2048
    v_fma_mix_f32 v54, v54, v243, 0 op_sel:[0,0,0] op_sel_hi:[0,1,0]
    v_or_b32 v50, v48, v49
    v_mfma_f32_16x16x32_bf16 v[72:75], a[120:123], v[108:111], 0
    ds_read_b128 v[216:219], v171 offset:0
    v_or_b32_e64 v52, v52, v53
    v_mfma_f32_16x16x32_bf16 v[72:75], a[124:127], v[112:115], v[72:75]
    v_lshlrev_b32_sdwa v68, 1, v68 dst_sel:DWORD dst_unused:UNUSED_PAD src0_sel:DWORD src1_sel:WORD_1
    v_fma_mix_f32 v55, v55, v243, 0 op_sel:[0,1,0] op_sel_hi:[0,1,0]
    v_mfma_f32_16x16x32_bf16 v[72:75], a[128:131], v[116:119], v[72:75]
    ds_read_b128 v[220:223], v171 offset:1024
    v_lshlrev_b32_sdwa v69, 1, v69 dst_sel:DWORD dst_unused:UNUSED_PAD src0_sel:DWORD src1_sel:WORD_1
    v_mfma_f32_16x16x32_bf16 v[76:79], a[140:143], v[116:119], 0
    ds_read_u16 v66, v66 offset:0
    v_cvt_pk_bf16_f32 v53, v54, v55
    v_mfma_f32_16x16x32_bf16 v[76:79], a[136:139], v[112:115], v[76:79]
    ds_read_u16 v68, v68 offset:0
    v_cvt_pk_bf16_f32 v11, v14, v15
    v_mfma_f32_16x16x32_bf16 v[76:79], a[132:135], v[108:111], v[76:79]
    v_lshlrev_b32_sdwa v71, 1, v71 dst_sel:DWORD dst_unused:UNUSED_PAD src0_sel:DWORD src1_sel:WORD_1
    v_lshlrev_b32_sdwa v65, 1, v65 dst_sel:DWORD dst_unused:UNUSED_PAD src0_sel:DWORD src1_sel:WORD_1
    v_mfma_f32_16x16x32_bf16 v[24:27], a[192:195], v[50:53], v[24:27]
    ds_read_b128 v[104:107], v255 offset:16384
    v_lshlrev_b32_sdwa v75, 1, v75 dst_sel:DWORD dst_unused:UNUSED_PAD src0_sel:DWORD src1_sel:WORD_1
    v_mfma_f32_16x16x32_bf16 v[28:31], a[196:199], v[50:53], v[28:31]
    ds_read_u16_d16_hi v65, v65 offset:0
    v_cvt_pk_bf16_f32 v10, v12, v13
    v_mfma_f32_16x16x32_bf16 v[32:35], a[200:203], v[50:53], v[32:35]
    v_cvt_pk_f16_f32 v242, v78, v79
    v_lshlrev_b32_sdwa v64, 1, v64 dst_sel:DWORD dst_unused:UNUSED_PAD src0_sel:DWORD src1_sel:WORD_1
    v_mfma_f32_16x16x32_bf16 v[36:39], a[204:207], v[50:53], v[36:39]
    ds_read_u16 v70, v70 offset:0
    ds_read_b128 v[100:103], v255 offset:8192
    v_mfma_f32_16x16x32_bf16 v[40:43], a[208:211], v[50:53], v[40:43]
    v_lshlrev_b32_sdwa v72, 1, v72 dst_sel:DWORD dst_unused:UNUSED_PAD src0_sel:DWORD src1_sel:WORD_1
    v_pk_fma_f16 v243, v242, v242, s48
    v_mfma_f32_16x16x32_bf16 v[44:47], a[212:215], v[50:53], v[44:47]
    s_waitcnt lgkmcnt(6)
    ds_read_u16 v64, v64 offset:0
    v_or_b32 v60, v60, v61
    v_or_b32_e64 v59, v58, v59
    v_mfma_f32_16x16x16_bf16 v[32:35], v[244:245], v[220:221], v[32:35]
    v_lshlrev_b32_sdwa v74, 1, v74 dst_sel:DWORD dst_unused:UNUSED_PAD src0_sel:DWORD src1_sel:WORD_1
    v_xor_b32 v255, 288, v255
    v_or_b32_e64 v58, v56, v57
    v_mfma_f32_16x16x16_bf16 v[28:31], v[244:245], v[218:219], v[28:31]
    ds_read_u16_d16_hi v69, v69 offset:0
    v_or_b32_e64 v61, v62, v63
    v_mfma_f32_16x16x16_bf16 v[24:27], v[244:245], v[216:217], v[24:27]
    ds_read_u16 v74, v74 offset:0
    ds_read_u16_d16_hi v71, v71 offset:0
    v_mfma_f32_16x16x16_bf16 v[36:39], v[244:245], v[222:223], v[36:39]
    buffer_store_dwordx4 v[8:11], v187, s[20:23], s44 offen offset:64 sc1
    s_cmp_lg_u32 s44, s43
    s_cbranch_scc1 L_loop
    v_mfma_f32_16x16x32_bf16 v[48:51], a[0:3], v[96:99], 0
    s_waitcnt lgkmcnt(4)
    ds_read_u16_d16_hi v75, v75 offset:0
    v_lshlrev_b32_sdwa v76, 1, v76 dst_sel:DWORD dst_unused:UNUSED_PAD src0_sel:DWORD src1_sel:WORD_1
    v_mfma_f32_16x16x32_bf16 v[48:51], a[4:7], v[100:103], v[48:51]
    s_nop 0
    ds_read_u16 v76, v76 offset:0
    v_pk_mul_f16 v243, v242, v243 neg_lo:[1,0] neg_hi:[1,0]
    v_mfma_f32_16x16x32_bf16 v[48:51], a[8:11], v[104:107], v[48:51]
    ds_read_b128 v[112:115], v255 offset:8192
    v_lshlrev_b32_sdwa v73, 1, v73 dst_sel:DWORD dst_unused:UNUSED_PAD src0_sel:DWORD src1_sel:WORD_1
    v_mfma_f32_16x16x32_bf16 v[52:55], a[20:23], v[104:107], 0
    v_exp_f16_sdwa v243, v243 dst_sel:WORD_0 dst_unused:UNUSED_PRESERVE src0_sel:WORD_0
    v_mfma_f32_16x16x32_bf16 v[52:55], a[16:19], v[100:103], v[52:55]
    v_exp_f16_sdwa v243, v243 dst_sel:WORD_1 dst_unused:UNUSED_PRESERVE src0_sel:WORD_1
    v_mfma_f32_16x16x32_bf16 v[52:55], a[12:15], v[96:99], v[52:55]
    ds_read_u16 v72, v72 offset:0
    v_lshlrev_b32_sdwa v49, 1, v49 dst_sel:DWORD dst_unused:UNUSED_PAD src0_sel:DWORD src1_sel:WORD_1
    v_add_u32_sdwa v225, s45, v175 dst_sel:DWORD dst_unused:UNUSED_PAD src0_sel:DWORD src1_sel:WORD_1
    v_mfma_f32_16x16x16_bf16 v[44:47], v[244:245], v[210:211], v[44:47]
    v_lshlrev_b32_sdwa v50, 1, v50 dst_sel:DWORD dst_unused:UNUSED_PAD src0_sel:DWORD src1_sel:WORD_1
    v_pk_fma_f16 v243, v243, s50, s50
    v_lshlrev_b32_sdwa v51, 1, v51 dst_sel:DWORD dst_unused:UNUSED_PAD src0_sel:DWORD src1_sel:WORD_1
    v_mfma_f32_16x16x16_bf16 v[40:43], v[244:245], v[208:209], v[40:43]
    v_lshlrev_b32_sdwa v53, 1, v53 dst_sel:DWORD dst_unused:UNUSED_PAD src0_sel:DWORD src1_sel:WORD_1
    v_lshlrev_b32_sdwa v52, 1, v52 dst_sel:DWORD dst_unused:UNUSED_PAD src0_sel:DWORD src1_sel:WORD_1
    v_lshlrev_b32_sdwa v55, 1, v55 dst_sel:DWORD dst_unused:UNUSED_PAD src0_sel:DWORD src1_sel:WORD_1
    v_cvt_pk_bf16_f32 v16, v16, v17
    v_mfma_f32_16x16x32_bf16 v[24:27], a[216:219], v[58:61], v[24:27]
    ds_read2_b32 v[212:213], v225 offset0:0 offset1:20
    ds_read_b128 v[108:111], v255 offset:0
    v_mfma_f32_16x16x32_bf16 v[28:31], a[220:223], v[58:61], v[28:31]
    ds_read2_b32 v[214:215], v225 offset0:40 offset1:60
    ds_read_u16_d16_hi v55, v55 offset:0
    v_mfma_f32_16x16x32_bf16 v[32:35], a[224:227], v[58:61], v[32:35]
    s_waitcnt lgkmcnt(7)
    v_or_b32 v75, v74, v75
    v_or_b32_e64 v68, v68, v69
    v_mfma_f32_16x16x32_bf16 v[36:39], a[228:231], v[58:61], v[36:39]
    ds_read_u16_d16_hi v73, v73 offset:0
    v_or_b32_e64 v67, v66, v67
    v_mfma_f32_16x16x32_bf16 v[40:43], a[232:235], v[58:61], v[40:43]
    v_cvt_pk_bf16_f32 v17, v18, v19
    v_lshlrev_b32_sdwa v77, 1, v77 dst_sel:DWORD dst_unused:UNUSED_PAD src0_sel:DWORD src1_sel:WORD_1
    v_mfma_f32_16x16x32_bf16 v[44:47], a[236:239], v[58:61], v[44:47]
    ds_read_b128 v[116:119], v255 offset:16384
    v_lshlrev_b32_sdwa v48, 1, v48 dst_sel:DWORD dst_unused:UNUSED_PAD src0_sel:DWORD src1_sel:WORD_1
    v_mfma_f32_16x16x32_bf16 v[56:59], a[24:27], v[96:99], 0
    ds_read_u16_d16_hi v77, v77 offset:0
    v_cvt_pk_bf16_f32 v19, v22, v23
    v_mfma_f32_16x16x32_bf16 v[56:59], a[28:31], v[100:103], v[56:59]
    v_add_u32_e64 v195, 1, v195
    v_cvt_pk_bf16_f32 v18, v20, v21
    v_mfma_f32_16x16x32_bf16 v[56:59], a[32:35], v[104:107], v[56:59]
    ds_read_u16 v50, v50 offset:0
    v_or_b32_e64 v69, v70, v71
    v_mfma_f32_16x16x32_bf16 v[60:63], a[44:47], v[104:107], 0
    v_or_b32_e64 v66, v64, v65
    v_lshlrev_b32_sdwa v54, 1, v54 dst_sel:DWORD dst_unused:UNUSED_PAD src0_sel:DWORD src1_sel:WORD_1
    v_mfma_f32_16x16x32_bf16 v[60:63], a[40:43], v[100:103], v[60:63]
    ds_read_u16 v52, v52 offset:0
    ds_read_u16_d16_hi v51, v51 offset:0
    v_mfma_f32_16x16x32_bf16 v[60:63], a[36:39], v[96:99], v[60:63]
    v_rcp_f16_sdwa v243, v243 dst_sel:WORD_0 dst_unused:UNUSED_PRESERVE src0_sel:WORD_0
    v_mfma_f32_16x16x32_bf16 v[24:27], a[240:243], v[66:69], v[24:27]
    buffer_store_dwordx4 v[16:19], v187, s[20:23], s44 offen offset:128 sc1
    ds_read_u16_d16_hi v49, v49 offset:0
    v_rcp_f16_sdwa v243, v243 dst_sel:WORD_1 dst_unused:UNUSED_PRESERVE src0_sel:WORD_1
    v_lshlrev_b32_sdwa v58, 1, v58 dst_sel:DWORD dst_unused:UNUSED_PAD src0_sel:DWORD src1_sel:WORD_1
    v_mfma_f32_16x16x32_bf16 v[28:31], a[244:247], v[66:69], v[28:31]
    ds_read_u16_d16_hi v53, v53 offset:0
    v_fma_mix_f32 v79, v79, v243, 0 op_sel:[0,1,0] op_sel_hi:[0,1,0]
    v_mfma_f32_16x16x32_bf16 v[32:35], a[248:251], v[66:69], v[32:35]
    v_lshlrev_b32_sdwa v56, 1, v56 dst_sel:DWORD dst_unused:UNUSED_PAD src0_sel:DWORD src1_sel:WORD_1
    v_fma_mix_f32 v78, v78, v243, 0 op_sel:[0,0,0] op_sel_hi:[0,1,0]
    v_mfma_f32_16x16x32_bf16 v[36:39], a[252:255], v[66:69], v[36:39]
    ds_read_u16 v48, v48 offset:0
    v_add_u32 v225, 1280, v225
    v_mfma_f32_16x16x32_bf16 v[40:43], v[226:229], v[66:69], v[40:43]
    ds_read_u16 v58, v58 offset:0
    v_xor_b32 v255, 800, v255
    v_mfma_f32_16x16x32_bf16 v[44:47], v[230:233], v[66:69], v[44:47]
    ds_read_u16 v54, v54 offset:0
    v_lshlrev_b32_sdwa v61, 1, v61 dst_sel:DWORD dst_unused:UNUSED_PAD src0_sel:DWORD src1_sel:WORD_1
    v_mfma_f32_16x16x32_bf16 v[64:67], a[48:51], v[96:99], 0
    s_waitcnt lgkmcnt(8)
    v_or_b32 v76, v76, v77
    v_cvt_pk_bf16_f32 v77, v78, v79
    v_lshlrev_b32_sdwa v63, 1, v63 dst_sel:DWORD dst_unused:UNUSED_PAD src0_sel:DWORD src1_sel:WORD_1
    v_mfma_f32_16x16x32_bf16 v[64:67], a[52:55], v[100:103], v[64:67]
    ds_read2_b32 v[218:219], v225 offset0:40 offset1:60
    v_lshlrev_b32_sdwa v59, 1, v59 dst_sel:DWORD dst_unused:UNUSED_PAD src0_sel:DWORD src1_sel:WORD_1
    v_mfma_f32_16x16x32_bf16 v[64:67], a[56:59], v[104:107], v[64:67]
    ds_read_u16_d16_hi v59, v59 offset:0
    v_lshlrev_b32_sdwa v57, 1, v57 dst_sel:DWORD dst_unused:UNUSED_PAD src0_sel:DWORD src1_sel:WORD_1
    v_mfma_f32_16x16x32_bf16 v[68:71], a[68:71], v[104:107], 0
    v_or_b32_e64 v74, v72, v73
    v_lshlrev_b32_sdwa v60, 1, v60 dst_sel:DWORD dst_unused:UNUSED_PAD src0_sel:DWORD src1_sel:WORD_1
    v_mfma_f32_16x16x32_bf16 v[68:71], a[64:67], v[100:103], v[68:71]
    ds_read_u16 v56, v56 offset:0
    v_lshlrev_b32_sdwa v62, 1, v62 dst_sel:DWORD dst_unused:UNUSED_PAD src0_sel:DWORD src1_sel:WORD_1
    v_mfma_f32_16x16x32_bf16 v[68:71], a[60:63], v[96:99], v[68:71]
    v_lshlrev_b32_sdwa v66, 1, v66 dst_sel:DWORD dst_unused:UNUSED_PAD src0_sel:DWORD src1_sel:WORD_1
    v_lshlrev_b32_sdwa v67, 1, v67 dst_sel:DWORD dst_unused:UNUSED_PAD src0_sel:DWORD src1_sel:WORD_1
    v_mfma_f32_16x16x32_bf16 v[24:27], v[234:237], v[74:77], v[24:27]
    s_waitcnt lgkmcnt(6)
    ds_read_u16_d16_hi v63, v63 offset:0
    v_or_b32 v52, v52, v53
    v_mfma_f32_16x16x32_bf16 v[28:31], v[238:241], v[74:77], v[28:31]
    ds_read_u16_d16_hi v61, v61 offset:0
    v_cvt_pk_f16_f32 v242, v70, v71
    v_mfma_f32_16x16x32_bf16 v[32:35], v[80:83], v[74:77], v[32:35]
    ds_read_u16_d16_hi v57, v57 offset:0
    v_or_b32_e64 v51, v50, v51
    v_cvt_pk_bf16_f32 v24, v24, v25
    v_mfma_f32_16x16x32_bf16 v[36:39], v[84:87], v[74:77], v[36:39]
    ds_read_u16 v62, v62 offset:0
    v_lshlrev_b32_sdwa v68, 1, v68 dst_sel:DWORD dst_unused:UNUSED_PAD src0_sel:DWORD src1_sel:WORD_1
    v_lshlrev_b32_sdwa v64, 1, v64 dst_sel:DWORD dst_unused:UNUSED_PAD src0_sel:DWORD src1_sel:WORD_1
    v_mfma_f32_16x16x32_bf16 v[40:43], v[88:91], v[74:77], v[40:43]
    v_pk_fma_f16 v243, v242, v242, s48
    v_lshlrev_b32_sdwa v65, 1, v65 dst_sel:DWORD dst_unused:UNUSED_PAD src0_sel:DWORD src1_sel:WORD_1
    v_mfma_f32_16x16x32_bf16 v[44:47], v[92:95], v[74:77], v[44:47]
    ds_read_u16 v60, v60 offset:0
    v_pk_mul_f16 v243, v242, v243 neg_lo:[1,0] neg_hi:[1,0]
    v_mfma_f32_16x16x32_bf16 v[72:75], a[72:75], v[96:99], 0
    s_waitcnt lgkmcnt(6)
    v_or_b32 v59, v58, v59
    v_or_b32_e64 v53, v54, v55
    v_mfma_f32_16x16x32_bf16 v[72:75], a[76:79], v[100:103], v[72:75]
    ds_read_u16_d16_hi v67, v67 offset:0
    v_lshlrev_b32_sdwa v69, 1, v69 dst_sel:DWORD dst_unused:UNUSED_PAD src0_sel:DWORD src1_sel:WORD_1
    v_mfma_f32_16x16x32_bf16 v[72:75], a[80:83], v[104:107], v[72:75]
    v_cvt_pk_bf16_f32 v40, v40, v41
    v_cvt_pk_bf16_f32 v25, v26, v27
    v_mfma_f32_16x16x32_bf16 v[76:79], a[92:95], v[104:107], 0
    v_cvt_pk_bf16_f32 v26, v28, v29
    v_cvt_pk_bf16_f32 v27, v30, v31
    v_mfma_f32_16x16x32_bf16 v[76:79], a[88:91], v[100:103], v[76:79]
    ds_read_u16_d16_hi v65, v65 offset:0
    v_or_b32_e64 v50, v48, v49
    v_mfma_f32_16x16x32_bf16 v[76:79], a[84:87], v[96:99], v[76:79]
    buffer_store_dwordx4 v[24:27], v187, s[20:23], s47 offen offset:0 sc1
    ds_read2_b32 v[216:217], v225 offset0:0 offset1:20
    ds_read_u16_d16_hi v69, v69 offset:0
    v_lshlrev_b32_sdwa v74, 1, v74 dst_sel:DWORD dst_unused:UNUSED_PAD src0_sel:DWORD src1_sel:WORD_1
    v_lshlrev_b32_sdwa v75, 1, v75 dst_sel:DWORD dst_unused:UNUSED_PAD src0_sel:DWORD src1_sel:WORD_1
    v_mfma_f32_16x16x32_bf16 v[0:3], a[144:147], v[50:53], 0
    ds_read_u16 v68, v68 offset:0
    v_exp_f16_sdwa v243, v243 dst_sel:WORD_0 dst_unused:UNUSED_PRESERVE src0_sel:WORD_0
    v_mfma_f32_16x16x32_bf16 v[4:7], a[148:151], v[50:53], 0
    v_lshlrev_b32_sdwa v76, 1, v76 dst_sel:DWORD dst_unused:UNUSED_PAD src0_sel:DWORD src1_sel:WORD_1
    v_lshlrev_b32_sdwa v73, 1, v73 dst_sel:DWORD dst_unused:UNUSED_PAD src0_sel:DWORD src1_sel:WORD_1
    v_mfma_f32_16x16x32_bf16 v[8:11], a[152:155], v[50:53], 0
    s_waitcnt lgkmcnt(5)
    ds_read_u16 v74, v74 offset:0
    v_or_b32 v60, v60, v61
    v_mfma_f32_16x16x32_bf16 v[12:15], a[156:159], v[50:53], 0
    v_or_b32_e64 v61, v62, v63
    v_lshlrev_b32_sdwa v77, 1, v77 dst_sel:DWORD dst_unused:UNUSED_PAD src0_sel:DWORD src1_sel:WORD_1
    v_mfma_f32_16x16x32_bf16 v[16:19], a[160:163], v[50:53], 0
    ds_read_u16_d16_hi v75, v75 offset:0
    v_lshlrev_b32_sdwa v78, 1, v78 dst_sel:DWORD dst_unused:UNUSED_PAD src0_sel:DWORD src1_sel:WORD_1
    v_mfma_f32_16x16x32_bf16 v[20:23], a[164:167], v[50:53], 0
    ds_read_u16_d16_hi v77, v77 offset:0
    v_cvt_pk_bf16_f32 v32, v32, v33
    v_mfma_f32_16x16x32_bf16 v[48:51], a[96:99], v[96:99], 0
    v_exp_f16_sdwa v243, v243 dst_sel:WORD_1 dst_unused:UNUSED_PRESERVE src0_sel:WORD_1
    v_mfma_f32_16x16x32_bf16 v[48:51], a[100:103], v[100:103], v[48:51]
    ds_read_u16 v64, v64 offset:0
    v_pk_fma_f16 v243, v243, s50, s50
    v_mfma_f32_16x16x32_bf16 v[48:51], a[104:107], v[104:107], v[48:51]
    ds_read_u16 v66, v66 offset:0
    v_lshlrev_b32_sdwa v72, 1, v72 dst_sel:DWORD dst_unused:UNUSED_PAD src0_sel:DWORD src1_sel:WORD_1
    v_mfma_f32_16x16x32_bf16 v[52:55], a[116:119], v[104:107], 0
    v_lshlrev_b32_sdwa v79, 1, v79 dst_sel:DWORD dst_unused:UNUSED_PAD src0_sel:DWORD src1_sel:WORD_1
    v_cvt_pk_bf16_f32 v33, v34, v35
    v_mfma_f32_16x16x32_bf16 v[52:55], a[112:115], v[100:103], v[52:55]
    ds_read_u16_d16_hi v73, v73 offset:0
    v_or_b32_e64 v58, v56, v57
    v_mfma_f32_16x16x32_bf16 v[52:55], a[108:111], v[96:99], v[52:55]
    v_rcp_f16_sdwa v243, v243 dst_sel:WORD_0 dst_unused:UNUSED_PRESERVE src0_sel:WORD_0
    v_mfma_f32_16x16x32_bf16 v[0:3], a[168:171], v[58:61], v[0:3]
    ds_read_u16 v76, v76 offset:0
    ds_read_u16_d16_hi v79, v79 offset:0
    v_mfma_f32_16x16x32_bf16 v[4:7], a[172:175], v[58:61], v[4:7]
    v_cvt_pk_bf16_f32 v41, v42, v43
    v_cvt_pk_bf16_f32 v35, v38, v39
    v_mfma_f32_16x16x32_bf16 v[8:11], a[176:179], v[58:61], v[8:11]
    v_cvt_pk_bf16_f32 v43, v46, v47
    v_cvt_pk_bf16_f32 v34, v36, v37
    v_lshlrev_b32_sdwa v50, 1, v50 dst_sel:DWORD dst_unused:UNUSED_PAD src0_sel:DWORD src1_sel:WORD_1
    v_mfma_f32_16x16x32_bf16 v[12:15], a[180:183], v[58:61], v[12:15]
    ds_read_u16 v72, v72 offset:0
    v_lshlrev_b32_sdwa v55, 1, v55 dst_sel:DWORD dst_unused:UNUSED_PAD src0_sel:DWORD src1_sel:WORD_1
    v_mfma_f32_16x16x32_bf16 v[16:19], a[184:187], v[58:61], v[16:19]
    v_rcp_f16_sdwa v243, v243 dst_sel:WORD_1 dst_unused:UNUSED_PRESERVE src0_sel:WORD_1
    v_mfma_f32_16x16x32_bf16 v[20:23], a[188:191], v[58:61], v[20:23]
    ds_read_u16 v50, v50 offset:0
    ds_read_u16 v78, v78 offset:0
    v_mfma_f32_16x16x32_bf16 v[56:59], a[120:123], v[96:99], 0
    s_waitcnt lgkmcnt(6)
    v_lshlrev_b32_sdwa v52, 1, v52 dst_sel:DWORD dst_unused:UNUSED_PAD src0_sel:DWORD src1_sel:WORD_1
    v_cvt_pk_bf16_f32 v42, v44, v45
    v_or_b32 v67, v66, v67
    v_mfma_f32_16x16x32_bf16 v[56:59], a[124:127], v[100:103], v[56:59]
    v_or_b32_e64 v66, v64, v65
    v_lshlrev_b32_sdwa v51, 1, v51 dst_sel:DWORD dst_unused:UNUSED_PAD src0_sel:DWORD src1_sel:WORD_1
    v_mfma_f32_16x16x32_bf16 v[56:59], a[128:131], v[104:107], v[56:59]
    buffer_store_dwordx4 v[32:35], v187, s[20:23], s47 offen offset:64 sc1
    ds_read_u16_d16_hi v51, v51 offset:0
    v_lshlrev_b32_sdwa v48, 1, v48 dst_sel:DWORD dst_unused:UNUSED_PAD src0_sel:DWORD src1_sel:WORD_1
    v_fma_mix_f32 v71, v71, v243, 0 op_sel:[0,1,0] op_sel_hi:[0,1,0]
    v_or_b32_e64 v68, v68, v69
    v_mfma_f32_16x16x32_bf16 v[60:63], a[140:143], v[104:107], 0
    ds_read_u16 v48, v48 offset:0
    ds_read_u16 v52, v52 offset:0
    v_mfma_f32_16x16x32_bf16 v[60:63], a[136:139], v[100:103], v[60:63]
    v_fma_mix_f32 v70, v70, v243, 0 op_sel:[0,0,0] op_sel_hi:[0,1,0]
    v_cvt_pk_bf16_f32 v69, v70, v71
    v_mfma_f32_16x16x32_bf16 v[60:63], a[132:135], v[96:99], v[60:63]
    s_add_u32 s44, s44, s15
    v_lshlrev_b32_sdwa v53, 1, v53 dst_sel:DWORD dst_unused:UNUSED_PAD src0_sel:DWORD src1_sel:WORD_1
    v_lshlrev_b32_sdwa v49, 1, v49 dst_sel:DWORD dst_unused:UNUSED_PAD src0_sel:DWORD src1_sel:WORD_1
    v_mfma_f32_16x16x32_bf16 v[0:3], a[192:195], v[66:69], v[0:3]
    s_nop 0
    ds_read_u16_d16_hi v53, v53 offset:0
    v_lshlrev_b32_sdwa v54, 1, v54 dst_sel:DWORD dst_unused:UNUSED_PAD src0_sel:DWORD src1_sel:WORD_1
    v_mfma_f32_16x16x32_bf16 v[4:7], a[196:199], v[66:69], v[4:7]
    ds_read_u16_d16_hi v49, v49 offset:0
    v_lshlrev_b32_sdwa v59, 1, v59 dst_sel:DWORD dst_unused:UNUSED_PAD src0_sel:DWORD src1_sel:WORD_1
    v_mfma_f32_16x16x32_bf16 v[8:11], a[200:203], v[66:69], v[8:11]
    ds_read_u16_d16_hi v59, v59 offset:0
    v_lshlrev_b32_sdwa v60, 1, v60 dst_sel:DWORD dst_unused:UNUSED_PAD src0_sel:DWORD src1_sel:WORD_1
    v_mfma_f32_16x16x32_bf16 v[12:15], a[204:207], v[66:69], v[12:15]
    v_cvt_pk_f16_f32 v242, v62, v63
    v_add_u32 v225, 1280, v225
    v_mfma_f32_16x16x32_bf16 v[16:19], a[208:211], v[66:69], v[16:19]
    ds_read_u16 v60, v60 offset:0
    v_lshlrev_b32_sdwa v58, 1, v58 dst_sel:DWORD dst_unused:UNUSED_PAD src0_sel:DWORD src1_sel:WORD_1
    v_mfma_f32_16x16x32_bf16 v[20:23], a[212:215], v[66:69], v[20:23]
    s_waitcnt lgkmcnt(6)
    v_or_b32 v51, v50, v51
    v_pk_fma_f16 v243, v242, v242, s48
    v_mfma_f32_16x16x32_bf16 v[64:67], a[0:3], v[108:111], 0
    ds_read_u16 v54, v54 offset:0
    v_or_b32_e64 v75, v74, v75
    v_mfma_f32_16x16x32_bf16 v[64:67], a[4:7], v[112:115], v[64:67]
    v_or_b32_e64 v76, v76, v77
    v_lshlrev_b32_sdwa v61, 1, v61 dst_sel:DWORD dst_unused:UNUSED_PAD src0_sel:DWORD src1_sel:WORD_1
    v_mfma_f32_16x16x32_bf16 v[64:67], a[8:11], v[116:119], v[64:67]
    ds_read_u16_d16_hi v55, v55 offset:0
    ds_read_b128 v[104:107], v255 offset:16384
    v_mfma_f32_16x16x32_bf16 v[68:71], a[20:23], v[116:119], 0
    ds_read_u16_d16_hi v61, v61 offset:0
    v_or_b32_e64 v77, v78, v79
    v_mfma_f32_16x16x32_bf16 v[68:71], a[16:19], v[112:115], v[68:71]
    v_or_b32_e64 v74, v72, v73
    v_lshlrev_b32_sdwa v57, 1, v57 dst_sel:DWORD dst_unused:UNUSED_PAD src0_sel:DWORD src1_sel:WORD_1
    v_mfma_f32_16x16x32_bf16 v[68:71], a[12:15], v[108:111], v[68:71]
    v_lshlrev_b32_sdwa v65, 1, v65 dst_sel:DWORD dst_unused:UNUSED_PAD src0_sel:DWORD src1_sel:WORD_1
    v_pk_mul_f16 v243, v242, v243 neg_lo:[1,0] neg_hi:[1,0]
    v_mfma_f32_16x16x32_bf16 v[0:3], a[216:219], v[74:77], v[0:3]
    ds_read_b128 v[96:99], v255 offset:0
    ds_read_u16 v58, v58 offset:0
    v_mfma_f32_16x16x32_bf16 v[4:7], a[220:223], v[74:77], v[4:7]
    s_waitcnt lgkmcnt(9)
    v_or_b32 v52, v52, v53
    v_lshlrev_b32_sdwa v70, 1, v70 dst_sel:DWORD dst_unused:UNUSED_PAD src0_sel:DWORD src1_sel:WORD_1
    v_mfma_f32_16x16x32_bf16 v[8:11], a[224:227], v[74:77], v[8:11]
    ds_read2_b32 v[222:223], v225 offset0:40 offset1:60
    v_lshlrev_b32_sdwa v56, 1, v56 dst_sel:DWORD dst_unused:UNUSED_PAD src0_sel:DWORD src1_sel:WORD_1
    v_mfma_f32_16x16x32_bf16 v[12:15], a[228:231], v[74:77], v[12:15]
    ds_read_u16_d16_hi v57, v57 offset:0
    v_lshlrev_b32_sdwa v67, 1, v67 dst_sel:DWORD dst_unused:UNUSED_PAD src0_sel:DWORD src1_sel:WORD_1
    v_mfma_f32_16x16x32_bf16 v[16:19], a[232:235], v[74:77], v[16:19]
    v_exp_f16_sdwa v243, v243 dst_sel:WORD_0 dst_unused:UNUSED_PRESERVE src0_sel:WORD_0
    v_mfma_f32_16x16x32_bf16 v[20:23], a[236:239], v[74:77], v[20:23]
    buffer_store_dwordx4 v[40:43], v187, s[20:23], s47 offen offset:128 sc1
    ds_read_u16 v56, v56 offset:0
    ds_read_u16_d16_hi v67, v67 offset:0
    v_lshlrev_b32_sdwa v64, 1, v64 dst_sel:DWORD dst_unused:UNUSED_PAD src0_sel:DWORD src1_sel:WORD_1
    v_lshlrev_b32_sdwa v66, 1, v66 dst_sel:DWORD dst_unused:UNUSED_PAD src0_sel:DWORD src1_sel:WORD_1
    v_mfma_f32_16x16x32_bf16 v[72:75], a[24:27], v[108:111], 0
    v_exp_f16_sdwa v243, v243 dst_sel:WORD_1 dst_unused:UNUSED_PRESERVE src0_sel:WORD_1
    v_mfma_f32_16x16x32_bf16 v[72:75], a[28:31], v[112:115], v[72:75]
    ds_read_u16 v66, v66 offset:0
    v_lshlrev_b32_sdwa v71, 1, v71 dst_sel:DWORD dst_unused:UNUSED_PAD src0_sel:DWORD src1_sel:WORD_1
    v_mfma_f32_16x16x32_bf16 v[72:75], a[32:35], v[116:119], v[72:75]
    ds_read_u16 v64, v64 offset:0
    v_lshlrev_b32_sdwa v69, 1, v69 dst_sel:DWORD dst_unused:UNUSED_PAD src0_sel:DWORD src1_sel:WORD_1
    v_mfma_f32_16x16x32_bf16 v[76:79], a[44:47], v[116:119], 0
    s_waitcnt lgkmcnt(8)
    v_or_b32 v60, v60, v61
    v_or_b32_e64 v50, v48, v49
    v_mfma_f32_16x16x32_bf16 v[76:79], a[40:43], v[112:115], v[76:79]
    s_nop 0
    v_lshlrev_b32_sdwa v74, 1, v74 dst_sel:DWORD dst_unused:UNUSED_PAD src0_sel:DWORD src1_sel:WORD_1
    v_or_b32 v53, v54, v55
    v_mfma_f32_16x16x32_bf16 v[76:79], a[36:39], v[108:111], v[76:79]
    ds_read_u16 v70, v70 offset:0
    ds_read_u16_d16_hi v65, v65 offset:0
    v_mfma_f32_16x16x32_bf16 v[0:3], a[240:243], v[50:53], v[0:3]
    v_pk_fma_f16 v243, v243, s50, s50
    v_lshlrev_b32_sdwa v68, 1, v68 dst_sel:DWORD dst_unused:UNUSED_PAD src0_sel:DWORD src1_sel:WORD_1
    v_mfma_f32_16x16x32_bf16 v[4:7], a[244:247], v[50:53], v[4:7]
    v_rcp_f16_sdwa v243, v243 dst_sel:WORD_0 dst_unused:UNUSED_PRESERVE src0_sel:WORD_0
    v_mfma_f32_16x16x32_bf16 v[8:11], a[248:251], v[50:53], v[8:11]
    ds_read_u16 v68, v68 offset:0
    v_lshlrev_b32_sdwa v78, 1, v78 dst_sel:DWORD dst_unused:UNUSED_PAD src0_sel:DWORD src1_sel:WORD_1
    v_mfma_f32_16x16x32_bf16 v[12:15], a[252:255], v[50:53], v[12:15]
    s_waitcnt lgkmcnt(9)
    ds_read_u16_d16_hi v71, v71 offset:0
    v_or_b32 v59, v58, v59
    v_mfma_f32_16x16x32_bf16 v[16:19], v[226:229], v[50:53], v[16:19]
    v_rcp_f16_sdwa v243, v243 dst_sel:WORD_1 dst_unused:UNUSED_PRESERVE src0_sel:WORD_1
    v_mfma_f32_16x16x32_bf16 v[20:23], v[230:233], v[50:53], v[20:23]
    ds_read2_b32 v[220:221], v225 offset0:0 offset1:20
    v_lshlrev_b32_sdwa v73, 1, v73 dst_sel:DWORD dst_unused:UNUSED_PAD src0_sel:DWORD src1_sel:WORD_1
    v_mfma_f32_16x16x32_bf16 v[48:51], a[48:51], v[108:111], 0
    ds_read_u16_d16_hi v69, v69 offset:0
    v_fma_mix_f32 v63, v63, v243, 0 op_sel:[0,1,0] op_sel_hi:[0,1,0]
    v_mfma_f32_16x16x32_bf16 v[48:51], a[52:55], v[112:115], v[48:51]
    ds_read_u16 v78, v78 offset:0
    v_lshlrev_b32_sdwa v77, 1, v77 dst_sel:DWORD dst_unused:UNUSED_PAD src0_sel:DWORD src1_sel:WORD_1
    v_mfma_f32_16x16x32_bf16 v[48:51], a[56:59], v[116:119], v[48:51]
    s_waitcnt lgkmcnt(10)
    ds_read_u16 v74, v74 offset:0
    v_or_b32 v58, v56, v57
    v_mfma_f32_16x16x32_bf16 v[52:55], a[68:71], v[116:119], 0
    v_fma_mix_f32 v62, v62, v243, 0 op_sel:[0,0,0] op_sel_hi:[0,1,0]
    v_lshlrev_b32_sdwa v79, 1, v79 dst_sel:DWORD dst_unused:UNUSED_PAD src0_sel:DWORD src1_sel:WORD_1
    v_mfma_f32_16x16x32_bf16 v[52:55], a[64:67], v[112:115], v[52:55]
    v_cvt_pk_bf16_f32 v61, v62, v63
    v_lshlrev_b32_sdwa v72, 1, v72 dst_sel:DWORD dst_unused:UNUSED_PAD src0_sel:DWORD src1_sel:WORD_1
    v_mfma_f32_16x16x32_bf16 v[52:55], a[60:63], v[108:111], v[52:55]
    ds_read_u16_d16_hi v79, v79 offset:0
    v_lshlrev_b32_sdwa v50, 1, v50 dst_sel:DWORD dst_unused:UNUSED_PAD src0_sel:DWORD src1_sel:WORD_1
    v_mfma_f32_16x16x32_bf16 v[0:3], v[234:237], v[58:61], v[0:3]
    ds_read_u16_d16_hi v77, v77 offset:0
    ds_read_u16 v72, v72 offset:0
    v_mfma_f32_16x16x32_bf16 v[4:7], v[238:241], v[58:61], v[4:7]
    v_lshlrev_b32_sdwa v48, 1, v48 dst_sel:DWORD dst_unused:UNUSED_PAD src0_sel:DWORD src1_sel:WORD_1
    v_lshlrev_b32_sdwa v75, 1, v75 dst_sel:DWORD dst_unused:UNUSED_PAD src0_sel:DWORD src1_sel:WORD_1
    v_mfma_f32_16x16x32_bf16 v[8:11], v[80:83], v[58:61], v[8:11]
    ds_read_u16_d16_hi v73, v73 offset:0
    v_cvt_pk_f16_f32 v242, v54, v55
    v_mfma_f32_16x16x32_bf16 v[12:15], v[84:87], v[58:61], v[12:15]
    v_pk_fma_f16 v243, v242, v242, s48
    v_lshlrev_b32_sdwa v52, 1, v52 dst_sel:DWORD dst_unused:UNUSED_PAD src0_sel:DWORD src1_sel:WORD_1
    v_mfma_f32_16x16x32_bf16 v[16:19], v[88:91], v[58:61], v[16:19]
    v_lshlrev_b32_sdwa v49, 1, v49 dst_sel:DWORD dst_unused:UNUSED_PAD src0_sel:DWORD src1_sel:WORD_1
    v_lshlrev_b32_sdwa v76, 1, v76 dst_sel:DWORD dst_unused:UNUSED_PAD src0_sel:DWORD src1_sel:WORD_1
    v_mfma_f32_16x16x32_bf16 v[20:23], v[92:95], v[58:61], v[20:23]
    v_cvt_pk_bf16_f32 v8, v8, v9
    v_add_u32_e64 v171, s96, v203
    v_mfma_f32_16x16x32_bf16 v[56:59], a[72:75], v[108:111], 0
    s_waitcnt lgkmcnt(6)
    ds_read_u16 v50, v50 offset:0
    v_or_b32 v68, v68, v69
    v_mfma_f32_16x16x32_bf16 v[56:59], a[76:79], v[112:115], v[56:59]
    v_cvt_pk_bf16_f32 v9, v10, v11
    v_lshlrev_b32_sdwa v51, 1, v51 dst_sel:DWORD dst_unused:UNUSED_PAD src0_sel:DWORD src1_sel:WORD_1
    v_mfma_f32_16x16x32_bf16 v[56:59], a[80:83], v[116:119], v[56:59]
    ds_read_u16_d16_hi v75, v75 offset:0
    v_cvt_pk_bf16_f32 v11, v14, v15
    v_mfma_f32_16x16x32_bf16 v[60:63], a[92:95], v[116:119], 0
    ds_read_u16 v76, v76 offset:0
    v_or_b32_e64 v69, v70, v71
    v_mfma_f32_16x16x32_bf16 v[60:63], a[88:91], v[112:115], v[60:63]
    v_or_b32_e64 v67, v66, v67
    v_pk_mul_f16 v243, v242, v243 neg_lo:[1,0] neg_hi:[1,0]
    v_or_b32_e64 v66, v64, v65
    v_mfma_f32_16x16x32_bf16 v[60:63], a[84:87], v[108:111], v[60:63]
    ds_read_u16 v48, v48 offset:0
    ds_read_b128 v[100:103], v255 offset:8192
    v_lshlrev_b32_sdwa v59, 1, v59 dst_sel:DWORD dst_unused:UNUSED_PAD src0_sel:DWORD src1_sel:WORD_1
    v_mfma_f32_16x16x32_bf16 v[24:27], a[144:147], v[66:69], 0
    ds_read_u16 v52, v52 offset:0
    v_lshlrev_b32_sdwa v56, 1, v56 dst_sel:DWORD dst_unused:UNUSED_PAD src0_sel:DWORD src1_sel:WORD_1
    v_mfma_f32_16x16x32_bf16 v[28:31], a[148:151], v[66:69], 0
    v_exp_f16_sdwa v243, v243 dst_sel:WORD_0 dst_unused:UNUSED_PRESERVE src0_sel:WORD_0
    v_lshlrev_b32_sdwa v61, 1, v61 dst_sel:DWORD dst_unused:UNUSED_PAD src0_sel:DWORD src1_sel:WORD_1
    v_mfma_f32_16x16x32_bf16 v[32:35], a[152:155], v[66:69], 0
    v_exp_f16_sdwa v243, v243 dst_sel:WORD_1 dst_unused:UNUSED_PRESERVE src0_sel:WORD_1
    v_cvt_pk_bf16_f32 v16, v16, v17
    v_mfma_f32_16x16x32_bf16 v[36:39], a[156:159], v[66:69], 0
    v_cvt_pk_bf16_f32 v10, v12, v13
    v_lshlrev_b32_sdwa v60, 1, v60 dst_sel:DWORD dst_unused:UNUSED_PAD src0_sel:DWORD src1_sel:WORD_1
    v_mfma_f32_16x16x32_bf16 v[40:43], a[160:163], v[66:69], 0
    ds_read_u16_d16_hi v49, v49 offset:0
    ds_read_u16_d16_hi v61, v61 offset:0
    v_mfma_f32_16x16x32_bf16 v[44:47], a[164:167], v[66:69], 0
    v_pk_fma_f16 v243, v243, s50, s50
    v_lshlrev_b32_sdwa v53, 1, v53 dst_sel:DWORD dst_unused:UNUSED_PAD src0_sel:DWORD src1_sel:WORD_1
    v_mfma_f32_16x16x32_bf16 v[64:67], a[96:99], v[108:111], 0
    ds_read_u16_d16_hi v53, v53 offset:0
    v_cvt_pk_bf16_f32 v17, v18, v19
    v_mfma_f32_16x16x32_bf16 v[64:67], a[100:103], v[112:115], v[64:67]
    s_waitcnt lgkmcnt(6)
    v_or_b32 v76, v76, v77
    v_lshlrev_b32_sdwa v63, 1, v63 dst_sel:DWORD dst_unused:UNUSED_PAD src0_sel:DWORD src1_sel:WORD_1
    v_mfma_f32_16x16x32_bf16 v[64:67], a[104:107], v[116:119], v[64:67]
    ds_read_u16 v60, v60 offset:0
    v_or_b32_e64 v75, v74, v75
    v_mfma_f32_16x16x32_bf16 v[68:71], a[116:119], v[116:119], 0
    ds_read_u16_d16_hi v63, v63 offset:0
    v_cvt_pk_bf16_f32 v19, v22, v23
    v_or_b32 v77, v78, v79
    v_or_b32 v74, v72, v73
    v_mfma_f32_16x16x32_bf16 v[68:71], a[112:115], v[112:115], v[68:71]
    ds_read_u16_d16_hi v51, v51 offset:0
    v_lshlrev_b32_sdwa v57, 1, v57 dst_sel:DWORD dst_unused:UNUSED_PAD src0_sel:DWORD src1_sel:WORD_1
    v_cvt_pk_bf16_f32 v18, v20, v21
    v_mfma_f32_16x16x32_bf16 v[68:71], a[108:111], v[108:111], v[68:71]
    ds_read_u16_d16_hi v57, v57 offset:0
    v_cvt_pk_bf16_f32 v0, v0, v1
    v_lshlrev_b32_sdwa v58, 1, v58 dst_sel:DWORD dst_unused:UNUSED_PAD src0_sel:DWORD src1_sel:WORD_1
    v_mfma_f32_16x16x32_bf16 v[24:27], a[168:171], v[74:77], v[24:27]
    ds_read_u16 v56, v56 offset:0
    v_lshlrev_b32_sdwa v67, 1, v67 dst_sel:DWORD dst_unused:UNUSED_PAD src0_sel:DWORD src1_sel:WORD_1
    v_mfma_f32_16x16x32_bf16 v[28:31], a[172:175], v[74:77], v[28:31]
    ds_write_b128 v171, v[16:19] offset:2048
    v_mfma_f32_16x16x32_bf16 v[32:35], a[176:179], v[74:77], v[32:35]
    v_rcp_f16_sdwa v243, v243 dst_sel:WORD_0 dst_unused:UNUSED_PRESERVE src0_sel:WORD_0
    v_mfma_f32_16x16x32_bf16 v[36:39], a[180:183], v[74:77], v[36:39]
    v_lshlrev_b32_sdwa v62, 1, v62 dst_sel:DWORD dst_unused:UNUSED_PAD src0_sel:DWORD src1_sel:WORD_1
    v_lshlrev_b32_sdwa v64, 1, v64 dst_sel:DWORD dst_unused:UNUSED_PAD src0_sel:DWORD src1_sel:WORD_1
    v_mfma_f32_16x16x32_bf16 v[40:43], a[184:187], v[74:77], v[40:43]
    ds_read_u16_d16_hi v59, v59 offset:0
    v_lshlrev_b32_sdwa v69, 1, v69 dst_sel:DWORD dst_unused:UNUSED_PAD src0_sel:DWORD src1_sel:WORD_1
    v_mfma_f32_16x16x32_bf16 v[44:47], a[188:191], v[74:77], v[44:47]
    v_rcp_f16_sdwa v243, v243 dst_sel:WORD_1 dst_unused:UNUSED_PRESERVE src0_sel:WORD_1
    v_mfma_f32_16x16x32_bf16 v[72:75], a[120:123], v[108:111], 0
    ds_read_u16 v62, v62 offset:0
    ds_read_u16 v64, v64 offset:0
    v_mfma_f32_16x16x32_bf16 v[72:75], a[124:127], v[112:115], v[72:75]
    v_cvt_pk_bf16_f32 v1, v2, v3
    v_fma_mix_f32 v55, v55, v243, 0 op_sel:[0,1,0] op_sel_hi:[0,1,0]
    v_mfma_f32_16x16x32_bf16 v[72:75], a[128:131], v[116:119], v[72:75]
    s_waitcnt lgkmcnt(6)
    v_or_b32 v51, v50, v51
    v_or_b32_e64 v52, v52, v53
    v_mfma_f32_16x16x32_bf16 v[76:79], a[140:143], v[116:119], 0
    v_fma_mix_f32 v54, v54, v243, 0 op_sel:[0,0,0] op_sel_hi:[0,1,0]
    v_cvt_pk_bf16_f32 v53, v54, v55
    v_mfma_f32_16x16x32_bf16 v[76:79], a[136:139], v[112:115], v[76:79]
    ds_read_u16 v58, v58 offset:0
    v_or_b32_e64 v50, v48, v49
    v_mfma_f32_16x16x32_bf16 v[76:79], a[132:135], v[108:111], v[76:79]
    ds_write_b128 v171, v[8:11] offset:1024
    v_cvt_pk_bf16_f32 v3, v6, v7
    v_mfma_f32_16x16x32_bf16 v[24:27], a[192:195], v[50:53], v[24:27]
    v_lshlrev_b32_sdwa v66, 1, v66 dst_sel:DWORD dst_unused:UNUSED_PAD src0_sel:DWORD src1_sel:WORD_1
    v_or_b32_e64 v60, v60, v61
    v_lshlrev_b32_sdwa v65, 1, v65 dst_sel:DWORD dst_unused:UNUSED_PAD src0_sel:DWORD src1_sel:WORD_1
    v_mfma_f32_16x16x32_bf16 v[28:31], a[196:199], v[50:53], v[28:31]
    ds_read_u16_d16_hi v65, v65 offset:0
    v_cvt_pk_bf16_f32 v2, v4, v5
    v_mfma_f32_16x16x32_bf16 v[32:35], a[200:203], v[50:53], v[32:35]
    ds_read_u16_d16_hi v69, v69 offset:0
    v_lshlrev_b32_sdwa v71, 1, v71 dst_sel:DWORD dst_unused:UNUSED_PAD src0_sel:DWORD src1_sel:WORD_1
    v_mfma_f32_16x16x32_bf16 v[36:39], a[204:207], v[50:53], v[36:39]
    ds_write_b128 v171, v[0:3] offset:0
    v_lshlrev_b32_sdwa v68, 1, v68 dst_sel:DWORD dst_unused:UNUSED_PAD src0_sel:DWORD src1_sel:WORD_1
    v_mfma_f32_16x16x32_bf16 v[40:43], a[208:211], v[50:53], v[40:43]
    v_lshlrev_b32_sdwa v70, 1, v70 dst_sel:DWORD dst_unused:UNUSED_PAD src0_sel:DWORD src1_sel:WORD_1
    v_xor_b32 v255, 288, v255
    v_mfma_f32_16x16x32_bf16 v[44:47], a[212:215], v[50:53], v[44:47]
    s_waitcnt lgkmcnt(4)
    ds_read_u16 v70, v70 offset:0
    v_or_b32 v59, v58, v59
    v_mfma_f32_16x16x32_bf16 v[48:51], a[0:3], v[96:99], 0
    v_lshlrev_b32_sdwa v73, 1, v73 dst_sel:DWORD dst_unused:UNUSED_PAD src0_sel:DWORD src1_sel:WORD_1
    v_or_b32_e64 v61, v62, v63
    v_mfma_f32_16x16x32_bf16 v[48:51], a[4:7], v[100:103], v[48:51]
    ds_read_u16_d16_hi v71, v71 offset:0
    v_cvt_pk_f16_f32 v242, v78, v79
    v_mfma_f32_16x16x32_bf16 v[48:51], a[8:11], v[104:107], v[48:51]
    ds_read_u16_d16_hi v67, v67 offset:0
    v_or_b32_e64 v58, v56, v57
    v_mfma_f32_16x16x32_bf16 v[52:55], a[20:23], v[104:107], 0
    ds_read_u16 v68, v68 offset:0
    v_lshlrev_b32_sdwa v77, 1, v77 dst_sel:DWORD dst_unused:UNUSED_PAD src0_sel:DWORD src1_sel:WORD_1
    v_mfma_f32_16x16x32_bf16 v[52:55], a[16:19], v[100:103], v[52:55]
    ds_read_u16 v66, v66 offset:0
    v_pk_fma_f16 v243, v242, v242, s48
    v_mfma_f32_16x16x32_bf16 v[52:55], a[12:15], v[96:99], v[52:55]
    v_lshlrev_b32_sdwa v50, 1, v50 dst_sel:DWORD dst_unused:UNUSED_PAD src0_sel:DWORD src1_sel:WORD_1
    v_lshlrev_b32_sdwa v76, 1, v76 dst_sel:DWORD dst_unused:UNUSED_PAD src0_sel:DWORD src1_sel:WORD_1
    v_mfma_f32_16x16x32_bf16 v[24:27], a[216:219], v[58:61], v[24:27]
    ds_write_b32 v191, v195
    v_mfma_f32_16x16x32_bf16 v[28:31], a[220:223], v[58:61], v[28:31]
    v_pk_mul_f16 v243, v242, v243 neg_lo:[1,0] neg_hi:[1,0]
    v_lshlrev_b32_sdwa v75, 1, v75 dst_sel:DWORD dst_unused:UNUSED_PAD src0_sel:DWORD src1_sel:WORD_1
    v_mfma_f32_16x16x32_bf16 v[32:35], a[224:227], v[58:61], v[32:35]
    ds_read_u16 v76, v76 offset:0
    ds_read_u16_d16_hi v77, v77 offset:0
    v_mfma_f32_16x16x32_bf16 v[36:39], a[228:231], v[58:61], v[36:39]
    v_lshlrev_b32_sdwa v52, 1, v52 dst_sel:DWORD dst_unused:UNUSED_PAD src0_sel:DWORD src1_sel:WORD_1
    v_lshlrev_b32_sdwa v74, 1, v74 dst_sel:DWORD dst_unused:UNUSED_PAD src0_sel:DWORD src1_sel:WORD_1
    v_mfma_f32_16x16x32_bf16 v[40:43], a[232:235], v[58:61], v[40:43]
    v_exp_f16_sdwa v243, v243 dst_sel:WORD_0 dst_unused:UNUSED_PRESERVE src0_sel:WORD_0
    v_mfma_f32_16x16x32_bf16 v[44:47], a[236:239], v[58:61], v[44:47]
    ds_read_u16 v74, v74 offset:0
    v_add_u32_sdwa v225, s55, v175 dst_sel:DWORD dst_unused:UNUSED_PAD src0_sel:DWORD src1_sel:WORD_1
    v_mfma_f32_16x16x32_bf16 v[56:59], a[24:27], v[96:99], 0
    ds_read_u16_d16_hi v73, v73 offset:0
    v_lshlrev_b32_sdwa v53, 1, v53 dst_sel:DWORD dst_unused:UNUSED_PAD src0_sel:DWORD src1_sel:WORD_1
    v_mfma_f32_16x16x32_bf16 v[56:59], a[28:31], v[100:103], v[56:59]
    ds_read_u16 v52, v52 offset:0
    v_lshlrev_b32_sdwa v49, 1, v49 dst_sel:DWORD dst_unused:UNUSED_PAD src0_sel:DWORD src1_sel:WORD_1
    v_mfma_f32_16x16x32_bf16 v[56:59], a[32:35], v[104:107], v[56:59]
    ds_read_u16_d16_hi v75, v75 offset:0
    v_lshlrev_b32_sdwa v55, 1, v55 dst_sel:DWORD dst_unused:UNUSED_PAD src0_sel:DWORD src1_sel:WORD_1
    v_mfma_f32_16x16x32_bf16 v[60:63], a[44:47], v[104:107], 0
    v_lshlrev_b32_sdwa v72, 1, v72 dst_sel:DWORD dst_unused:UNUSED_PAD src0_sel:DWORD src1_sel:WORD_1
    v_lshlrev_b32_sdwa v54, 1, v54 dst_sel:DWORD dst_unused:UNUSED_PAD src0_sel:DWORD src1_sel:WORD_1
    v_mfma_f32_16x16x32_bf16 v[60:63], a[40:43], v[100:103], v[60:63]
    s_waitcnt lgkmcnt(7)
    ds_read_u16_d16_hi v49, v49 offset:0
    v_or_b32 v67, v66, v67
    v_mfma_f32_16x16x32_bf16 v[60:63], a[36:39], v[96:99], v[60:63]
    ds_read_u16_d16_hi v53, v53 offset:0
    v_exp_f16_sdwa v243, v243 dst_sel:WORD_1 dst_unused:UNUSED_PRESERVE src0_sel:WORD_1
    v_mfma_f32_16x16x16_bf16 v[4:7], v[244:245], v[214:215], 0
    v_or_b32_e64 v68, v68, v69
    v_lshlrev_b32_sdwa v59, 1, v59 dst_sel:DWORD dst_unused:UNUSED_PAD src0_sel:DWORD src1_sel:WORD_1
    v_or_b32_e64 v69, v70, v71
    v_mfma_f32_16x16x16_bf16 v[0:3], v[244:245], v[212:213], 0
    v_lshlrev_b32_sdwa v57, 1, v57 dst_sel:DWORD dst_unused:UNUSED_PAD src0_sel:DWORD src1_sel:WORD_1
    v_or_b32 v66, v64, v65
    v_add_u32 v171, s97, v203
    v_lshlrev_b32_sdwa v62, 1, v62 dst_sel:DWORD dst_unused:UNUSED_PAD src0_sel:DWORD src1_sel:WORD_1
    v_mfma_f32_16x16x32_bf16 v[24:27], a[240:243], v[66:69], v[24:27]
    ds_read_u16 v72, v72 offset:0
    ds_read_addtid_b32 v199 offset:5120
    v_mfma_f32_16x16x32_bf16 v[28:31], a[244:247], v[66:69], v[28:31]
    v_lshlrev_b32_sdwa v58, 1, v58 dst_sel:DWORD dst_unused:UNUSED_PAD src0_sel:DWORD src1_sel:WORD_1
    v_lshlrev_b32_sdwa v48, 1, v48 dst_sel:DWORD dst_unused:UNUSED_PAD src0_sel:DWORD src1_sel:WORD_1
    v_mfma_f32_16x16x32_bf16 v[32:35], a[248:251], v[66:69], v[32:35]
    ds_read_u16 v50, v50 offset:0
    v_lshlrev_b32_sdwa v51, 1, v51 dst_sel:DWORD dst_unused:UNUSED_PAD src0_sel:DWORD src1_sel:WORD_1
    v_mfma_f32_16x16x32_bf16 v[36:39], a[252:255], v[66:69], v[36:39]
    ds_read_u16_d16_hi v57, v57 offset:0
    v_pk_fma_f16 v243, v243, s50, s50
    v_mfma_f32_16x16x32_bf16 v[40:43], v[226:229], v[66:69], v[40:43]
    v_rcp_f16_sdwa v243, v243 dst_sel:WORD_0 dst_unused:UNUSED_PRESERVE src0_sel:WORD_0
    v_mfma_f32_16x16x32_bf16 v[44:47], v[230:233], v[66:69], v[44:47]
    ds_read_u16_d16_hi v59, v59 offset:0
    ds_read_u16_d16_hi v55, v55 offset:0
    v_mfma_f32_16x16x32_bf16 v[64:67], a[48:51], v[96:99], 0
    v_rcp_f16_sdwa v243, v243 dst_sel:WORD_1 dst_unused:UNUSED_PRESERVE src0_sel:WORD_1
    v_mfma_f32_16x16x32_bf16 v[64:67], a[52:55], v[100:103], v[64:67]
    s_waitcnt lgkmcnt(8)
    v_or_b32 v75, v74, v75
    v_fma_mix_f32 v79, v79, v243, 0 op_sel:[0,1,0] op_sel_hi:[0,1,0]
    v_mfma_f32_16x16x32_bf16 v[64:67], a[56:59], v[104:107], v[64:67]
    s_add_u32 s47, s44, s13
    ds_read_u16 v58, v58 offset:0
    v_lshlrev_b32_sdwa v60, 1, v60 dst_sel:DWORD dst_unused:UNUSED_PAD src0_sel:DWORD src1_sel:WORD_1
    v_mfma_f32_16x16x32_bf16 v[68:71], a[68:71], v[104:107], 0
    ds_read_u16 v48, v48 offset:0
    v_lshlrev_b32_sdwa v63, 1, v63 dst_sel:DWORD dst_unused:UNUSED_PAD src0_sel:DWORD src1_sel:WORD_1
    v_mfma_f32_16x16x32_bf16 v[68:71], a[64:67], v[100:103], v[68:71]
    s_waitcnt lgkmcnt(6)
    v_cmp_lt_u32 vcc, v199, v195
    v_or_b32 v74, v72, v73
    v_mfma_f32_16x16x32_bf16 v[68:71], a[60:63], v[96:99], v[68:71]
    ds_read_b128 v[108:111], v255 offset:0
    v_fma_mix_f32 v78, v78, v243, 0 op_sel:[0,0,0] op_sel_hi:[0,1,0]
    v_lshlrev_b32_sdwa v64, 1, v64 dst_sel:DWORD dst_unused:UNUSED_PAD src0_sel:DWORD src1_sel:WORD_1
    v_mfma_f32_16x16x16_bf16 v[20:23], v[244:245], v[222:223], 0
    ds_read_u16 v54, v54 offset:0
    ds_read_u16_d16_hi v63, v63 offset:0
    v_mfma_f32_16x16x16_bf16 v[12:15], v[244:245], v[218:219], 0
    v_lshlrev_b32_sdwa v65, 1, v65 dst_sel:DWORD dst_unused:UNUSED_PAD src0_sel:DWORD src1_sel:WORD_1
    v_or_b32 v76, v76, v77
    v_or_b32 v52, v52, v53
    v_mfma_f32_16x16x16_bf16 v[8:11], v[244:245], v[216:217], 0
    v_lshlrev_b32_sdwa v66, 1, v66 dst_sel:DWORD dst_unused:UNUSED_PAD src0_sel:DWORD src1_sel:WORD_1
    v_cvt_pk_bf16_f32 v77, v78, v79
    v_cvt_pk_f16_f32 v242, v70, v71
    v_mfma_f32_16x16x16_bf16 v[16:19], v[244:245], v[220:221], 0
    ds_read_u16_d16_hi v51, v51 offset:0
    ds_read_u16 v66, v66 offset:0
    v_lshlrev_b32_sdwa v67, 1, v67 dst_sel:DWORD dst_unused:UNUSED_PAD src0_sel:DWORD src1_sel:WORD_1
    v_mfma_f32_16x16x32_bf16 v[24:27], v[234:237], v[74:77], v[24:27]
    v_pk_fma_f16 v243, v242, v242, s48
    v_lshlrev_b32_sdwa v61, 1, v61 dst_sel:DWORD dst_unused:UNUSED_PAD src0_sel:DWORD src1_sel:WORD_1
    v_mfma_f32_16x16x32_bf16 v[28:31], v[238:241], v[74:77], v[28:31]
    s_cbranch_vccnz L_retry2
L_back2:
    v_mfma_f32_16x16x32_bf16 v[32:35], v[80:83], v[74:77], v[32:35]
    s_nop 0
    ds_read_u16_d16_hi v61, v61 offset:0
    v_lshlrev_b32_sdwa v56, 1, v56 dst_sel:DWORD dst_unused:UNUSED_PAD src0_sel:DWORD src1_sel:WORD_1
    v_mfma_f32_16x16x32_bf16 v[36:39], v[84:87], v[74:77], v[36:39]
    ds_read_u16 v62, v62 offset:0
    v_lshlrev_b32_sdwa v69, 1, v69 dst_sel:DWORD dst_unused:UNUSED_PAD src0_sel:DWORD src1_sel:WORD_1
    v_mfma_f32_16x16x32_bf16 v[40:43], v[88:91], v[74:77], v[40:43]
    v_lshlrev_b32_sdwa v68, 1, v68 dst_sel:DWORD dst_unused:UNUSED_PAD src0_sel:DWORD src1_sel:WORD_1
    v_pk_mul_f16 v243, v242, v243 neg_lo:[1,0] neg_hi:[1,0]
    v_mfma_f32_16x16x32_bf16 v[44:47], v[92:95], v[74:77], v[44:47]
    s_waitcnt lgkmcnt(8)
    ds_read_u16_d16_hi v67, v67 offset:0
    v_or_b32 v59, v58, v59
    v_mfma_f32_16x16x32_bf16 v[72:75], a[72:75], v[96:99], 0
    ds_read_b128 v[216:219], v171 offset:2048
    ds_read_b128 v[208:211], v171 offset:0
    v_mfma_f32_16x16x32_bf16 v[72:75], a[76:79], v[100:103], v[72:75]
    ds_read2_b32 v[220:221], v225 offset0:0 offset1:20
    v_cvt_pk_bf16_f32 v24, v24, v25
    v_mfma_f32_16x16x32_bf16 v[72:75], a[80:83], v[104:107], v[72:75]
    s_waitcnt lgkmcnt(7)
    v_or_b32 v53, v54, v55
    v_or_b32_e64 v51, v50, v51
    v_mfma_f32_16x16x32_bf16 v[76:79], a[92:95], v[104:107], 0
    ds_read_u16 v56, v56 offset:0
    v_or_b32_e64 v50, v48, v49
    v_mfma_f32_16x16x32_bf16 v[76:79], a[88:91], v[100:103], v[76:79]
    ds_read_u16 v60, v60 offset:0
    v_cvt_pk_bf16_f32 v25, v26, v27
    v_mfma_f32_16x16x32_bf16 v[76:79], a[84:87], v[96:99], v[76:79]
    v_cvt_pk_bf16_f32 v40, v40, v41
    v_lshlrev_b32_sdwa v72, 1, v72 dst_sel:DWORD dst_unused:UNUSED_PAD src0_sel:DWORD src1_sel:WORD_1
    v_mfma_f32_16x16x32_bf16 v[0:3], a[144:147], v[50:53], v[0:3]
    ds_read_u16 v68, v68 offset:0
    v_add_u32_e64 v195, 1, v195
    v_mfma_f32_16x16x32_bf16 v[4:7], a[148:151], v[50:53], v[4:7]
    ds_read_b128 v[212:215], v171 offset:1024
    v_lshlrev_b32_sdwa v73, 1, v73 dst_sel:DWORD dst_unused:UNUSED_PAD src0_sel:DWORD src1_sel:WORD_1
    v_mfma_f32_16x16x32_bf16 v[8:11], a[152:155], v[50:53], v[8:11]
    v_cvt_pk_bf16_f32 v41, v42, v43
    v_lshlrev_b32_sdwa v78, 1, v78 dst_sel:DWORD dst_unused:UNUSED_PAD src0_sel:DWORD src1_sel:WORD_1
    v_mfma_f32_16x16x32_bf16 v[12:15], a[156:159], v[50:53], v[12:15]
    ds_read_b128 v[112:115], v255 offset:8192
    v_lshlrev_b32_sdwa v75, 1, v75 dst_sel:DWORD dst_unused:UNUSED_PAD src0_sel:DWORD src1_sel:WORD_1
    v_mfma_f32_16x16x32_bf16 v[16:19], a[160:163], v[50:53], v[16:19]
    ds_read_u16_d16_hi v65, v65 offset:0
    ds_read_u16 v64, v64 offset:0
    v_mfma_f32_16x16x32_bf16 v[20:23], a[164:167], v[50:53], v[20:23]
    v_exp_f16_sdwa v243, v243 dst_sel:WORD_0 dst_unused:UNUSED_PRESERVE src0_sel:WORD_0
    v_mfma_f32_16x16x32_bf16 v[48:51], a[96:99], v[96:99], 0
    v_cvt_pk_bf16_f32 v42, v44, v45
    v_lshlrev_b32_sdwa v76, 1, v76 dst_sel:DWORD dst_unused:UNUSED_PAD src0_sel:DWORD src1_sel:WORD_1
    v_mfma_f32_16x16x32_bf16 v[48:51], a[100:103], v[100:103], v[48:51]
    ds_read_b128 v[116:119], v255 offset:16384
    ds_read_u16 v78, v78 offset:0
    v_mfma_f32_16x16x32_bf16 v[48:51], a[104:107], v[104:107], v[48:51]
    s_waitcnt lgkmcnt(8)
    v_or_b32 v58, v56, v57
    v_cvt_pk_bf16_f32 v43, v46, v47
    v_mfma_f32_16x16x32_bf16 v[52:55], a[116:119], v[104:107], 0
    v_exp_f16_sdwa v243, v243 dst_sel:WORD_1 dst_unused:UNUSED_PRESERVE src0_sel:WORD_1
    v_mfma_f32_16x16x32_bf16 v[52:55], a[112:115], v[100:103], v[52:55]
    ds_read_u16_d16_hi v73, v73 offset:0
    ds_read_u16_d16_hi v69, v69 offset:0
    v_mfma_f32_16x16x32_bf16 v[52:55], a[108:111], v[96:99], v[52:55]
    s_waitcnt lgkmcnt(7)
    ds_write_b128 v171, v[40:43] offset:2048
    v_mfma_f32_16x16x16_bf16 v[0:3], v[244:245], v[208:209], v[0:3]
    v_cvt_pk_bf16_f32 v32, v32, v33
    v_or_b32 v60, v60, v61
    v_pk_fma_f16 v243, v243, s50, s50
    v_mfma_f32_16x16x16_bf16 v[12:15], v[244:245], v[214:215], v[12:15]
    v_cvt_pk_bf16_f32 v33, v34, v35
    v_lshlrev_b32_sdwa v74, 1, v74 dst_sel:DWORD dst_unused:UNUSED_PAD src0_sel:DWORD src1_sel:WORD_1
    v_cvt_pk_bf16_f32 v35, v38, v39
    v_mfma_f32_16x16x16_bf16 v[4:7], v[244:245], v[210:211], v[4:7]
    ds_read_u16 v72, v72 offset:0
    ds_read2_b32 v[222:223], v225 offset0:40 offset1:60
    v_mfma_f32_16x16x16_bf16 v[16:19], v[244:245], v[216:217], v[16:19]
    v_lshlrev_b32_sdwa v77, 1, v77 dst_sel:DWORD dst_unused:UNUSED_PAD src0_sel:DWORD src1_sel:WORD_1
    v_rcp_f16_sdwa v243, v243 dst_sel:WORD_0 dst_unused:UNUSED_PRESERVE src0_sel:WORD_0
    v_mfma_f32_16x16x16_bf16 v[8:11], v[244:245], v[212:213], v[8:11]
    v_or_b32 v61, v62, v63
    v_or_b32 v67, v66, v67
    v_cvt_pk_bf16_f32 v27, v30, v31
    v_add_u32 v225, 1280, v225
    v_mfma_f32_16x16x32_bf16 v[0:3], a[168:171], v[58:61], v[0:3]
    ds_read_u16 v74, v74 offset:0
    v_lshlrev_b32_sdwa v79, 1, v79 dst_sel:DWORD dst_unused:UNUSED_PAD src0_sel:DWORD src1_sel:WORD_1
    v_mfma_f32_16x16x32_bf16 v[4:7], a[172:175], v[58:61], v[4:7]
    ds_read_u16_d16_hi v77, v77 offset:0
    ds_read2_b32 v[210:211], v225 offset0:40 offset1:60
    v_mfma_f32_16x16x32_bf16 v[8:11], a[176:179], v[58:61], v[8:11]
    v_rcp_f16_sdwa v243, v243 dst_sel:WORD_1 dst_unused:UNUSED_PRESERVE src0_sel:WORD_1
    v_mfma_f32_16x16x32_bf16 v[12:15], a[180:183], v[58:61], v[12:15]
    s_waitcnt lgkmcnt(6)
    ds_read2_b32 v[208:209], v225 offset0:0 offset1:20
    v_or_b32 v68, v68, v69
    v_mfma_f32_16x16x32_bf16 v[16:19], a[184:187], v[58:61], v[16:19]
    v_add_u32 v225, 1280, v225
    v_cvt_pk_bf16_f32 v26, v28, v29
    v_mfma_f32_16x16x32_bf16 v[20:23], a[188:191], v[58:61], v[20:23]
    ds_read_u16 v76, v76 offset:0
    ds_read_u16_d16_hi v75, v75 offset:0
    v_mfma_f32_16x16x32_bf16 v[56:59], a[120:123], v[96:99], 0
    ds_write_b128 v171, v[24:27] offset:0
    v_mfma_f32_16x16x32_bf16 v[56:59], a[124:127], v[100:103], v[56:59]
    v_fma_mix_f32 v70, v70, v243, 0 op_sel:[0,0,0] op_sel_hi:[0,1,0]
    v_fma_mix_f32 v71, v71, v243, 0 op_sel:[0,1,0] op_sel_hi:[0,1,0]
    v_mfma_f32_16x16x32_bf16 v[56:59], a[128:131], v[104:107], v[56:59]
    v_lshlrev_b32_sdwa v49, 1, v49 dst_sel:DWORD dst_unused:UNUSED_PAD src0_sel:DWORD src1_sel:WORD_1
    v_or_b32_e64 v66, v64, v65
    v_mfma_f32_16x16x32_bf16 v[60:63], a[140:143], v[104:107], 0
    ds_read_u16_d16_hi v79, v79 offset:0
    ds_read2_b32 v[212:213], v225 offset0:0 offset1:20
    v_mfma_f32_16x16x32_bf16 v[60:63], a[136:139], v[100:103], v[60:63]
    v_cvt_pk_bf16_f32 v69, v70, v71
    v_lshlrev_b32_sdwa v54, 1, v54 dst_sel:DWORD dst_unused:UNUSED_PAD src0_sel:DWORD src1_sel:WORD_1
    v_mfma_f32_16x16x32_bf16 v[60:63], a[132:135], v[96:99], v[60:63]
    v_lshlrev_b32_sdwa v56, 1, v56 dst_sel:DWORD dst_unused:UNUSED_PAD src0_sel:DWORD src1_sel:WORD_1
    v_lshlrev_b32_sdwa v52, 1, v52 dst_sel:DWORD dst_unused:UNUSED_PAD src0_sel:DWORD src1_sel:WORD_1
    v_mfma_f32_16x16x32_bf16 v[0:3], a[192:195], v[66:69], v[0:3]
    ds_read_u16 v54, v54 offset:0
    v_lshlrev_b32_sdwa v53, 1, v53 dst_sel:DWORD dst_unused:UNUSED_PAD src0_sel:DWORD src1_sel:WORD_1
    v_mfma_f32_16x16x32_bf16 v[4:7], a[196:199], v[66:69], v[4:7]
    ds_read2_b32 v[214:215], v225 offset0:40 offset1:60
    v_cvt_pk_bf16_f32 v34, v36, v37
    v_mfma_f32_16x16x32_bf16 v[8:11], a[200:203], v[66:69], v[8:11]
    ds_read_u16 v52, v52 offset:0
    v_mfma_f32_16x16x32_bf16 v[12:15], a[204:207], v[66:69], v[12:15]
    ds_read_u16 v56, v56 offset:0
    v_lshlrev_b32_sdwa v59, 1, v59 dst_sel:DWORD dst_unused:UNUSED_PAD src0_sel:DWORD src1_sel:WORD_1
    v_mfma_f32_16x16x32_bf16 v[16:19], a[208:211], v[66:69], v[16:19]
    ds_write_b128 v171, v[32:35] offset:1024
    v_mfma_f32_16x16x32_bf16 v[20:23], a[212:215], v[66:69], v[20:23]
    v_lshlrev_b32_sdwa v58, 1, v58 dst_sel:DWORD dst_unused:UNUSED_PAD src0_sel:DWORD src1_sel:WORD_1
    v_lshlrev_b32_sdwa v51, 1, v51 dst_sel:DWORD dst_unused:UNUSED_PAD src0_sel:DWORD src1_sel:WORD_1
    v_mfma_f32_16x16x32_bf16 v[64:67], a[0:3], v[108:111], 0
    v_add_u32_e64 v171, s96, v203
    v_lshlrev_b32_sdwa v48, 1, v48 dst_sel:DWORD dst_unused:UNUSED_PAD src0_sel:DWORD src1_sel:WORD_1
    v_mfma_f32_16x16x32_bf16 v[64:67], a[4:7], v[112:115], v[64:67]
    ds_read_u16 v48, v48 offset:0
    v_lshlrev_b32_sdwa v50, 1, v50 dst_sel:DWORD dst_unused:UNUSED_PAD src0_sel:DWORD src1_sel:WORD_1
    v_mfma_f32_16x16x32_bf16 v[64:67], a[8:11], v[116:119], v[64:67]
    ds_read_u16 v58, v58 offset:0
    ds_read_u16_d16_hi v53, v53 offset:0
    v_mfma_f32_16x16x32_bf16 v[68:71], a[20:23], v[116:119], 0
    v_lshlrev_b32_sdwa v61, 1, v61 dst_sel:DWORD dst_unused:UNUSED_PAD src0_sel:DWORD src1_sel:WORD_1
    v_lshlrev_b32_sdwa v57, 1, v57 dst_sel:DWORD dst_unused:UNUSED_PAD src0_sel:DWORD src1_sel:WORD_1
    v_mfma_f32_16x16x32_bf16 v[68:71], a[16:19], v[112:115], v[68:71]
    ds_write_b32 v191, v195
    v_mfma_f32_16x16x32_bf16 v[68:71], a[12:15], v[108:111], v[68:71]
    s_waitcnt lgkmcnt(7)
    ds_read_u16 v50, v50 offset:0
    v_lshlrev_b32_sdwa v55, 1, v55 dst_sel:DWORD dst_unused:UNUSED_PAD src0_sel:DWORD src1_sel:WORD_1
    v_cvt_pk_f16_f32 v242, v62, v63
    v_mfma_f32_16x16x16_bf16 v[24:27], v[244:245], v[220:221], 0
    v_lshlrev_b32_sdwa v64, 1, v64 dst_sel:DWORD dst_unused:UNUSED_PAD src0_sel:DWORD src1_sel:WORD_1
    v_or_b32 v76, v76, v77
    v_or_b32_e64 v75, v74, v75
    v_mfma_f32_16x16x16_bf16 v[40:43], v[244:245], v[212:213], 0
    ds_read_u16_d16_hi v55, v55 offset:0
    ds_read_u16_d16_hi v51, v51 offset:0
    v_mfma_f32_16x16x16_bf16 v[20:23], v[244:245], v[218:219], v[20:23]
    v_lshlrev_b32_sdwa v60, 1, v60 dst_sel:DWORD dst_unused:UNUSED_PAD src0_sel:DWORD src1_sel:WORD_1
    v_lshlrev_b32_sdwa v66, 1, v66 dst_sel:DWORD dst_unused:UNUSED_PAD src0_sel:DWORD src1_sel:WORD_1
    v_lshlrev_b32_sdwa v69, 1, v69 dst_sel:DWORD dst_unused:UNUSED_PAD src0_sel:DWORD src1_sel:WORD_1
    v_mfma_f32_16x16x16_bf16 v[32:35], v[244:245], v[208:209], 0
    v_lshlrev_b32_sdwa v68, 1, v68 dst_sel:DWORD dst_unused:UNUSED_PAD src0_sel:DWORD src1_sel:WORD_1
    v_or_b32 v77, v78, v79
    v_or_b32 v74, v72, v73
    v_mfma_f32_16x16x16_bf16 v[28:31], v[244:245], v[222:223], 0
    ds_read_u16_d16_hi v59, v59 offset:0
    v_lshlrev_b32_sdwa v70, 1, v70 dst_sel:DWORD dst_unused:UNUSED_PAD src0_sel:DWORD src1_sel:WORD_1
    v_mfma_f32_16x16x16_bf16 v[36:39], v[244:245], v[210:211], 0
    v_lshlrev_b32_sdwa v71, 1, v71 dst_sel:DWORD dst_unused:UNUSED_PAD src0_sel:DWORD src1_sel:WORD_1
    v_pk_fma_f16 v243, v242, v242, s48
    v_pk_mul_f16 v243, v242, v243 neg_lo:[1,0] neg_hi:[1,0]
    v_mfma_f32_16x16x16_bf16 v[44:47], v[244:245], v[214:215], 0
    ds_read_u16_d16_hi v49, v49 offset:0
    v_exp_f16_sdwa v243, v243 dst_sel:WORD_0 dst_unused:UNUSED_PRESERVE src0_sel:WORD_0
    v_mfma_f32_16x16x32_bf16 v[0:3], a[216:219], v[74:77], v[0:3]
    ds_read_u16 v68, v68 offset:0
    ds_read_u16_d16_hi v57, v57 offset:0
    v_mfma_f32_16x16x32_bf16 v[4:7], a[220:223], v[74:77], v[4:7]
    v_lshlrev_b32_sdwa v67, 1, v67 dst_sel:DWORD dst_unused:UNUSED_PAD src0_sel:DWORD src1_sel:WORD_1
    v_lshlrev_b32_sdwa v65, 1, v65 dst_sel:DWORD dst_unused:UNUSED_PAD src0_sel:DWORD src1_sel:WORD_1
    v_mfma_f32_16x16x32_bf16 v[8:11], a[224:227], v[74:77], v[8:11]
    v_exp_f16_sdwa v243, v243 dst_sel:WORD_1 dst_unused:UNUSED_PRESERVE src0_sel:WORD_1
    v_mfma_f32_16x16x32_bf16 v[12:15], a[228:231], v[74:77], v[12:15]
    s_waitcnt lgkmcnt(8)
    ds_read_u16_d16_hi v61, v61 offset:0
    v_or_b32 v52, v52, v53
    v_mfma_f32_16x16x32_bf16 v[16:19], a[232:235], v[74:77], v[16:19]
    ds_read_u16_d16_hi v69, v69 offset:0
    v_pk_fma_f16 v243, v243, s50, s50
    v_mfma_f32_16x16x32_bf16 v[20:23], a[236:239], v[74:77], v[20:23]
    v_rcp_f16_sdwa v243, v243 dst_sel:WORD_0 dst_unused:UNUSED_PRESERVE src0_sel:WORD_0
    v_mfma_f32_16x16x32_bf16 v[72:75], a[24:27], v[108:111], 0
    ds_read_addtid_b32 v199 offset:5120
    ds_read_u16 v60, v60 offset:0
    v_mfma_f32_16x16x32_bf16 v[72:75], a[28:31], v[112:115], v[72:75]
    s_waitcnt lgkmcnt(9)
    ds_read_u16 v70, v70 offset:0
    v_or_b32 v53, v54, v55
    v_mfma_f32_16x16x32_bf16 v[72:75], a[32:35], v[116:119], v[72:75]
    v_rcp_f16_sdwa v243, v243 dst_sel:WORD_1 dst_unused:UNUSED_PRESERVE src0_sel:WORD_1
    v_mfma_f32_16x16x32_bf16 v[76:79], a[44:47], v[116:119], 0
    s_waitcnt lgkmcnt(7)
    v_or_b32 v51, v50, v51
    v_or_b32_e64 v50, v48, v49
    v_mfma_f32_16x16x32_bf16 v[76:79], a[40:43], v[112:115], v[76:79]
    ds_read_u16 v64, v64 offset:0
    ds_read_u16_d16_hi v71, v71 offset:0
    v_mfma_f32_16x16x32_bf16 v[76:79], a[36:39], v[108:111], v[76:79]
    v_fma_mix_f32 v62, v62, v243, 0 op_sel:[0,0,0] op_sel_hi:[0,1,0]
    v_lshlrev_b32_sdwa v72, 1, v72 dst_sel:DWORD dst_unused:UNUSED_PAD src0_sel:DWORD src1_sel:WORD_1
    v_mfma_f32_16x16x32_bf16 v[0:3], a[240:243], v[50:53], v[0:3]
    v_or_b32_e64 v59, v58, v59
    v_lshlrev_b32_sdwa v74, 1, v74 dst_sel:DWORD dst_unused:UNUSED_PAD src0_sel:DWORD src1_sel:WORD_1
    v_mfma_f32_16x16x32_bf16 v[4:7], a[244:247], v[50:53], v[4:7]
    ds_read_u16_d16_hi v67, v67 offset:0
    ds_read_u16_d16_hi v65, v65 offset:0
    v_mfma_f32_16x16x32_bf16 v[8:11], a[248:251], v[50:53], v[8:11]
    v_lshlrev_b32_sdwa v79, 1, v79 dst_sel:DWORD dst_unused:UNUSED_PAD src0_sel:DWORD src1_sel:WORD_1
    v_lshlrev_b32_sdwa v75, 1, v75 dst_sel:DWORD dst_unused:UNUSED_PAD src0_sel:DWORD src1_sel:WORD_1
    v_mfma_f32_16x16x32_bf16 v[12:15], a[252:255], v[50:53], v[12:15]
    s_waitcnt lgkmcnt(6)
    v_lshlrev_b32_sdwa v73, 1, v73 dst_sel:DWORD dst_unused:UNUSED_PAD src0_sel:DWORD src1_sel:WORD_1
    v_cmp_lt_u32 vcc, v199, v195
    v_mfma_f32_16x16x32_bf16 v[16:19], v[226:229], v[50:53], v[16:19]
    ds_read_u16_d16_hi v75, v75 offset:0
    v_lshlrev_b32_sdwa v78, 1, v78 dst_sel:DWORD dst_unused:UNUSED_PAD src0_sel:DWORD src1_sel:WORD_1
    v_mfma_f32_16x16x32_bf16 v[20:23], v[230:233], v[50:53], v[20:23]
    s_waitcnt lgkmcnt(6)
    ds_read_u16 v66, v66 offset:0
    v_or_b32 v60, v60, v61
    v_mfma_f32_16x16x32_bf16 v[48:51], a[48:51], v[108:111], 0
    v_fma_mix_f32 v63, v63, v243, 0 op_sel:[0,1,0] op_sel_hi:[0,1,0]
    v_lshlrev_b32_sdwa v76, 1, v76 dst_sel:DWORD dst_unused:UNUSED_PAD src0_sel:DWORD src1_sel:WORD_1
    v_mfma_f32_16x16x32_bf16 v[48:51], a[52:55], v[112:115], v[48:51]
    ds_read_u16 v78, v78 offset:0
    v_or_b32_e64 v58, v56, v57
    v_mfma_f32_16x16x32_bf16 v[48:51], a[56:59], v[116:119], v[48:51]
    ds_read_u16 v72, v72 offset:0
    v_cvt_pk_bf16_f32 v61, v62, v63
    v_mfma_f32_16x16x32_bf16 v[52:55], a[68:71], v[116:119], 0
    ds_read_u16_d16_hi v79, v79 offset:0
    v_or_b32_e64 v68, v68, v69
    v_mfma_f32_16x16x32_bf16 v[52:55], a[64:67], v[112:115], v[52:55]
    s_cbranch_vccnz L_retry3
L_back3:
    v_mfma_f32_16x16x32_bf16 v[52:55], a[60:63], v[108:111], v[52:55]
    s_nop 0
    ds_read_u16_d16_hi v73, v73 offset:0
    v_lshlrev_b32_sdwa v77, 1, v77 dst_sel:DWORD dst_unused:UNUSED_PAD src0_sel:DWORD src1_sel:WORD_1
    v_mfma_f32_16x16x32_bf16 v[0:3], v[234:237], v[58:61], v[0:3]
    ds_read_u16 v76, v76 offset:0
    v_lshlrev_b32_sdwa v49, 1, v49 dst_sel:DWORD dst_unused:UNUSED_PAD src0_sel:DWORD src1_sel:WORD_1
    v_mfma_f32_16x16x32_bf16 v[4:7], v[238:241], v[58:61], v[4:7]
    v_lshlrev_b32_sdwa v51, 1, v51 dst_sel:DWORD dst_unused:UNUSED_PAD src0_sel:DWORD src1_sel:WORD_1
    v_lshlrev_b32_sdwa v50, 1, v50 dst_sel:DWORD dst_unused:UNUSED_PAD src0_sel:DWORD src1_sel:WORD_1
    v_mfma_f32_16x16x32_bf16 v[8:11], v[80:83], v[58:61], v[8:11]
    ds_read_u16_d16_hi v49, v49 offset:0
    v_cvt_pk_f16_f32 v242, v54, v55
    v_mfma_f32_16x16x32_bf16 v[12:15], v[84:87], v[58:61], v[12:15]
    ds_read_u16_d16_hi v77, v77 offset:0
    v_cvt_pk_bf16_f32 v0, v0, v1
    v_mfma_f32_16x16x32_bf16 v[16:19], v[88:91], v[58:61], v[16:19]
    v_cvt_pk_bf16_f32 v1, v2, v3
    v_lshlrev_b32_sdwa v52, 1, v52 dst_sel:DWORD dst_unused:UNUSED_PAD src0_sel:DWORD src1_sel:WORD_1
    v_mfma_f32_16x16x32_bf16 v[20:23], v[92:95], v[58:61], v[20:23]
    s_waitcnt lgkmcnt(7)
    v_lshlrev_b32_sdwa v48, 1, v48 dst_sel:DWORD dst_unused:UNUSED_PAD src0_sel:DWORD src1_sel:WORD_1
    v_or_b32 v67, v66, v67
    v_mfma_f32_16x16x32_bf16 v[56:59], a[72:75], v[108:111], 0
    ds_read_u16 v74, v74 offset:0
    v_cvt_pk_bf16_f32 v2, v4, v5
    v_mfma_f32_16x16x32_bf16 v[56:59], a[76:79], v[112:115], v[56:59]
    ds_read_b128 v[220:223], v171 offset:1024
    ds_read_b128 v[208:211], v171 offset:2048
    v_mfma_f32_16x16x32_bf16 v[56:59], a[80:83], v[116:119], v[56:59]
    ds_read_u16 v50, v50 offset:0
    v_lshlrev_b32_sdwa v53, 1, v53 dst_sel:DWORD dst_unused:UNUSED_PAD src0_sel:DWORD src1_sel:WORD_1
    v_mfma_f32_16x16x32_bf16 v[60:63], a[92:95], v[116:119], 0
    v_or_b32 v69, v70, v71
    v_or_b32 v66, v64, v65
    v_mfma_f32_16x16x32_bf16 v[60:63], a[88:91], v[112:115], v[60:63]
    ds_read_b128 v[216:219], v171 offset:0
    v_pk_fma_f16 v243, v242, v242, s48
    v_mfma_f32_16x16x32_bf16 v[60:63], a[84:87], v[108:111], v[60:63]
    ds_read_u16_d16_hi v53, v53 offset:0
    v_lshlrev_b32_sdwa v57, 1, v57 dst_sel:DWORD dst_unused:UNUSED_PAD src0_sel:DWORD src1_sel:WORD_1
    v_mfma_f32_16x16x32_bf16 v[24:27], a[144:147], v[66:69], v[24:27]
    ds_read_u16 v52, v52 offset:0
    v_cvt_pk_bf16_f32 v3, v6, v7
    v_mfma_f32_16x16x32_bf16 v[28:31], a[148:151], v[66:69], v[28:31]
    buffer_store_dwordx4 v[0:3], v187, s[20:23], s44 offen offset:0 sc1
    v_lshlrev_b32_sdwa v56, 1, v56 dst_sel:DWORD dst_unused:UNUSED_PAD src0_sel:DWORD src1_sel:WORD_1
    v_lshlrev_b32_sdwa v58, 1, v58 dst_sel:DWORD dst_unused:UNUSED_PAD src0_sel:DWORD src1_sel:WORD_1
    v_pk_mul_f16 v243, v242, v243 neg_lo:[1,0] neg_hi:[1,0]
    v_mfma_f32_16x16x32_bf16 v[32:35], a[152:155], v[66:69], v[32:35]
    ds_read_u16_d16_hi v51, v51 offset:0
    ds_read_u16 v48, v48 offset:0
    v_mfma_f32_16x16x32_bf16 v[36:39], a[156:159], v[66:69], v[36:39]
    s_waitcnt lgkmcnt(8)
    v_lshlrev_b32_sdwa v59, 1, v59 dst_sel:DWORD dst_unused:UNUSED_PAD src0_sel:DWORD src1_sel:WORD_1
    v_or_b32 v75, v74, v75
    v_mfma_f32_16x16x32_bf16 v[40:43], a[160:163], v[66:69], v[40:43]
    v_exp_f16_sdwa v243, v243 dst_sel:WORD_0 dst_unused:UNUSED_PRESERVE src0_sel:WORD_0
    v_mfma_f32_16x16x32_bf16 v[44:47], a[164:167], v[66:69], v[44:47]
    ds_read_u16 v56, v56 offset:0
    v_or_b32_e64 v74, v72, v73
    v_mfma_f32_16x16x32_bf16 v[64:67], a[96:99], v[108:111], 0
    ds_read_u16_d16_hi v57, v57 offset:0
    v_or_b32_e64 v76, v76, v77
    v_mfma_f32_16x16x32_bf16 v[64:67], a[100:103], v[112:115], v[64:67]
    v_exp_f16_sdwa v243, v243 dst_sel:WORD_1 dst_unused:UNUSED_PRESERVE src0_sel:WORD_1
    v_mfma_f32_16x16x32_bf16 v[64:67], a[104:107], v[116:119], v[64:67]
    ds_read_u16_d16_hi v59, v59 offset:0
    v_lshlrev_b32_sdwa v62, 1, v62 dst_sel:DWORD dst_unused:UNUSED_PAD src0_sel:DWORD src1_sel:WORD_1
    v_mfma_f32_16x16x32_bf16 v[68:71], a[116:119], v[116:119], 0
    ds_read_u16 v58, v58 offset:0
    v_or_b32_e64 v77, v78, v79
    v_mfma_f32_16x16x32_bf16 v[68:71], a[112:115], v[112:115], v[68:71]
    v_lshlrev_b32_sdwa v61, 1, v61 dst_sel:DWORD dst_unused:UNUSED_PAD src0_sel:DWORD src1_sel:WORD_1
    v_pk_fma_f16 v243, v243, s50, s50
    v_mfma_f32_16x16x32_bf16 v[68:71], a[108:111], v[108:111], v[68:71]
    v_lshlrev_b32_sdwa v65, 1, v65 dst_sel:DWORD dst_unused:UNUSED_PAD src0_sel:DWORD src1_sel:WORD_1
    v_lshlrev_b32_sdwa v60, 1, v60 dst_sel:DWORD dst_unused:UNUSED_PAD src0_sel:DWORD src1_sel:WORD_1
    v_mfma_f32_16x16x32_bf16 v[24:27], a[168:171], v[74:77], v[24:27]
    ds_read_u16 v62, v62 offset:0
    ds_read_u16 v60, v60 offset:0
    v_mfma_f32_16x16x32_bf16 v[28:31], a[172:175], v[74:77], v[28:31]
    v_rcp_f16_sdwa v243, v243 dst_sel:WORD_0 dst_unused:UNUSED_PRESERVE src0_sel:WORD_0
    v_mfma_f32_16x16x32_bf16 v[32:35], a[176:179], v[74:77], v[32:35]
    s_waitcnt lgkmcnt(6)
    ds_read_u16_d16_hi v61, v61 offset:0
    v_or_b32 v52, v52, v53
    v_lshlrev_b32_sdwa v68, 1, v68 dst_sel:DWORD dst_unused:UNUSED_PAD src0_sel:DWORD src1_sel:WORD_1
    v_mfma_f32_16x16x16_bf16 v[24:27], v[244:245], v[216:217], v[24:27]
    v_lshlrev_b32_sdwa v69, 1, v69 dst_sel:DWORD dst_unused:UNUSED_PAD src0_sel:DWORD src1_sel:WORD_1
    v_lshlrev_b32_sdwa v66, 1, v66 dst_sel:DWORD dst_unused:UNUSED_PAD src0_sel:DWORD src1_sel:WORD_1
    v_or_b32_e64 v51, v50, v51
    v_mfma_f32_16x16x16_bf16 v[32:35], v[244:245], v[220:221], v[32:35]
    ds_read_u16 v68, v68 offset:0
    v_lshlrev_b32_sdwa v63, 1, v63 dst_sel:DWORD dst_unused:UNUSED_PAD src0_sel:DWORD src1_sel:WORD_1
    v_mfma_f32_16x16x16_bf16 v[28:31], v[244:245], v[218:219], v[28:31]
    v_cvt_pk_bf16_f32 v8, v8, v9
    v_or_b32_e64 v50, v48, v49
    v_rcp_f16_sdwa v243, v243 dst_sel:WORD_1 dst_unused:UNUSED_PRESERVE src0_sel:WORD_1
    v_mfma_f32_16x16x32_bf16 v[36:39], a[180:183], v[74:77], v[36:39]
    ds_read_u16_d16_hi v69, v69 offset:0
    ds_read_u16_d16_hi v65, v65 offset:0
    v_mfma_f32_16x16x32_bf16 v[40:43], a[184:187], v[74:77], v[40:43]
    v_fma_mix_f32 v54, v54, v243, 0 op_sel:[0,0,0] op_sel_hi:[0,1,0]
    v_lshlrev_b32_sdwa v64, 1, v64 dst_sel:DWORD dst_unused:UNUSED_PAD src0_sel:DWORD src1_sel:WORD_1
    v_mfma_f32_16x16x32_bf16 v[44:47], a[188:191], v[74:77], v[44:47]
    v_lshlrev_b32_sdwa v67, 1, v67 dst_sel:DWORD dst_unused:UNUSED_PAD src0_sel:DWORD src1_sel:WORD_1
    v_cvt_pk_bf16_f32 v9, v10, v11
    v_mfma_f32_16x16x32_bf16 v[72:75], a[120:123], v[108:111], 0
    ds_read_u16_d16_hi v67, v67 offset:0
    v_cvt_pk_bf16_f32 v16, v16, v17
    v_mfma_f32_16x16x32_bf16 v[72:75], a[124:127], v[112:115], v[72:75]
    ds_read_u16_d16_hi v63, v63 offset:0
    v_mfma_f32_16x16x32_bf16 v[72:75], a[128:131], v[116:119], v[72:75]
    ds_read_u16 v66, v66 offset:0
    v_fma_mix_f32 v55, v55, v243, 0 op_sel:[0,1,0] op_sel_hi:[0,1,0]
    v_mfma_f32_16x16x32_bf16 v[76:79], a[140:143], v[116:119], 0
    ds_read_u16 v64, v64 offset:0
    v_cvt_pk_bf16_f32 v53, v54, v55
    v_mfma_f32_16x16x32_bf16 v[76:79], a[136:139], v[112:115], v[76:79]
    v_cvt_pk_bf16_f32 v10, v12, v13
    v_lshlrev_b32_sdwa v70, 1, v70 dst_sel:DWORD dst_unused:UNUSED_PAD src0_sel:DWORD src1_sel:WORD_1
    v_mfma_f32_16x16x32_bf16 v[76:79], a[132:135], v[108:111], v[76:79]
    s_waitcnt lgkmcnt(7)
    v_cvt_pk_bf16_f32 v11, v14, v15
    v_lshlrev_b32_sdwa v71, 1, v71 dst_sel:DWORD dst_unused:UNUSED_PAD src0_sel:DWORD src1_sel:WORD_1
    v_or_b32 v59, v58, v59
    v_mfma_f32_16x16x16_bf16 v[36:39], v[244:245], v[222:223], v[36:39]
    ds_read_u16 v70, v70 offset:0
    ds_read_u16_d16_hi v71, v71 offset:0
    v_mfma_f32_16x16x16_bf16 v[44:47], v[244:245], v[210:211], v[44:47]
    buffer_store_dwordx4 v[8:11], v187, s[20:23], s44 offen offset:64 sc1
    v_lshlrev_b32_sdwa v77, 1, v77 dst_sel:DWORD dst_unused:UNUSED_PAD src0_sel:DWORD src1_sel:WORD_1
    v_lshlrev_b32_sdwa v74, 1, v74 dst_sel:DWORD dst_unused:UNUSED_PAD src0_sel:DWORD src1_sel:WORD_1
    v_or_b32_e64 v58, v56, v57
    v_mfma_f32_16x16x16_bf16 v[40:43], v[244:245], v[208:209], v[40:43]
    ds_read_u16_d16_hi v77, v77 offset:0
    v_or_b32_e64 v60, v60, v61
    v_lshlrev_b32_sdwa v75, 1, v75 dst_sel:DWORD dst_unused:UNUSED_PAD src0_sel:DWORD src1_sel:WORD_1
    v_mfma_f32_16x16x32_bf16 v[24:27], a[192:195], v[50:53], v[24:27]
    v_lshlrev_b32_sdwa v73, 1, v73 dst_sel:DWORD dst_unused:UNUSED_PAD src0_sel:DWORD src1_sel:WORD_1
    v_lshlrev_b32_sdwa v72, 1, v72 dst_sel:DWORD dst_unused:UNUSED_PAD src0_sel:DWORD src1_sel:WORD_1
    v_mfma_f32_16x16x32_bf16 v[28:31], a[196:199], v[50:53], v[28:31]
    ds_read_u16 v74, v74 offset:0
    v_lshlrev_b32_sdwa v76, 1, v76 dst_sel:DWORD dst_unused:UNUSED_PAD src0_sel:DWORD src1_sel:WORD_1
    v_mfma_f32_16x16x32_bf16 v[32:35], a[200:203], v[50:53], v[32:35]
    ds_read_u16 v76, v76 offset:0
    ds_read_u16 v72, v72 offset:0
    v_mfma_f32_16x16x32_bf16 v[36:39], a[204:207], v[50:53], v[36:39]
    s_waitcnt lgkmcnt(7)
    v_cvt_pk_f16_f32 v242, v78, v79
    v_or_b32 v67, v66, v67
    v_mfma_f32_16x16x32_bf16 v[40:43], a[208:211], v[50:53], v[40:43]
    v_pk_fma_f16 v243, v242, v242, s48
    v_or_b32_e64 v61, v62, v63
    v_mfma_f32_16x16x32_bf16 v[44:47], a[212:215], v[50:53], v[44:47]
    ds_read_u16_d16_hi v73, v73 offset:0
    v_mfma_f32_16x16x32_bf16 v[24:27], a[216:219], v[58:61], v[24:27]
    ds_read_u16_d16_hi v75, v75 offset:0
    v_or_b32_e64 v68, v68, v69
    v_mfma_f32_16x16x32_bf16 v[28:31], a[220:223], v[58:61], v[28:31]
    s_waitcnt lgkmcnt(6)
    v_or_b32 v69, v70, v71
    v_mfma_f32_16x16x32_bf16 v[32:35], a[224:227], v[58:61], v[32:35]
    v_or_b32_e64 v66, v64, v65
    v_pk_mul_f16 v243, v242, v243 neg_lo:[1,0] neg_hi:[1,0]
    v_mfma_f32_16x16x32_bf16 v[36:39], a[228:231], v[58:61], v[36:39]
    v_exp_f16_sdwa v243, v243 dst_sel:WORD_0 dst_unused:UNUSED_PRESERVE src0_sel:WORD_0
    v_mfma_f32_16x16x32_bf16 v[40:43], a[232:235], v[58:61], v[40:43]
    v_exp_f16_sdwa v243, v243 dst_sel:WORD_1 dst_unused:UNUSED_PRESERVE src0_sel:WORD_1
    v_mfma_f32_16x16x32_bf16 v[44:47], a[236:239], v[58:61], v[44:47]
    v_pk_fma_f16 v243, v243, s50, s50
    v_mfma_f32_16x16x32_bf16 v[24:27], a[240:243], v[66:69], v[24:27]
    v_rcp_f16_sdwa v243, v243 dst_sel:WORD_0 dst_unused:UNUSED_PRESERVE src0_sel:WORD_0
    v_mfma_f32_16x16x32_bf16 v[28:31], a[244:247], v[66:69], v[28:31]
    v_rcp_f16_sdwa v243, v243 dst_sel:WORD_1 dst_unused:UNUSED_PRESERVE src0_sel:WORD_1
    v_mfma_f32_16x16x32_bf16 v[32:35], a[248:251], v[66:69], v[32:35]
    s_waitcnt lgkmcnt(3)
    v_or_b32 v76, v76, v77
    v_fma_mix_f32 v79, v79, v243, 0 op_sel:[0,1,0] op_sel_hi:[0,1,0]
    v_mfma_f32_16x16x32_bf16 v[36:39], a[252:255], v[66:69], v[36:39]
    v_fma_mix_f32 v78, v78, v243, 0 op_sel:[0,0,0] op_sel_hi:[0,1,0]
    v_cvt_pk_bf16_f32 v77, v78, v79
    v_mfma_f32_16x16x32_bf16 v[40:43], v[226:229], v[66:69], v[40:43]
    s_waitcnt lgkmcnt(0)
    v_or_b32 v75, v74, v75
    v_or_b32_e64 v74, v72, v73
    v_mfma_f32_16x16x32_bf16 v[44:47], v[230:233], v[66:69], v[44:47]
    s_nop 0
    v_mfma_f32_16x16x32_bf16 v[24:27], v[234:237], v[74:77], v[24:27]
    s_nop 0
    v_cvt_pk_bf16_f32 v17, v18, v19
    v_mfma_f32_16x16x32_bf16 v[28:31], v[238:241], v[74:77], v[28:31]
    v_xor_b32 v255, 800, v255
    v_cvt_pk_bf16_f32 v18, v20, v21
    v_mfma_f32_16x16x32_bf16 v[32:35], v[80:83], v[74:77], v[32:35]
    v_cvt_pk_bf16_f32 v19, v22, v23
    v_mfma_f32_16x16x32_bf16 v[36:39], v[84:87], v[74:77], v[36:39]
    s_nop 0
    v_cvt_pk_bf16_f32 v24, v24, v25
    v_cvt_pk_bf16_f32 v25, v26, v27
    v_mfma_f32_16x16x32_bf16 v[40:43], v[88:91], v[74:77], v[40:43]
    s_nop 0
    v_cvt_pk_bf16_f32 v26, v28, v29
    v_cvt_pk_bf16_f32 v27, v30, v31
    v_mfma_f32_16x16x32_bf16 v[44:47], v[92:95], v[74:77], v[44:47]
    buffer_store_dwordx4 v[16:19], v187, s[20:23], s44 offen offset:128 sc1
    buffer_store_dwordx4 v[24:27], v187, s[20:23], s47 offen offset:0 sc1
    v_cvt_pk_bf16_f32 v32, v32, v33
    v_cvt_pk_bf16_f32 v33, v34, v35
    v_cvt_pk_bf16_f32 v35, v38, v39
    v_cvt_pk_bf16_f32 v34, v36, v37
    v_cvt_pk_bf16_f32 v40, v40, v41
    v_cvt_pk_bf16_f32 v41, v42, v43
    v_cvt_pk_bf16_f32 v42, v44, v45
    v_cvt_pk_bf16_f32 v43, v46, v47
    buffer_store_dwordx4 v[40:43], v187, s[20:23], s47 offen offset:128 sc1
    buffer_store_dwordx4 v[32:35], v187, s[20:23], s47 offen offset:64 sc1
L_end:
    s_endpgm
L_retry0:
    s_cselect_b32 s61, 1, 0
L_spin0:
    ds_read_addtid_b32 v199 offset:5120
    s_add_u32 s7, s7, 1
    s_waitcnt lgkmcnt(0)
    v_cmp_lt_u32 vcc, v199, v195
    s_cmp_ge_u32 s7, 0x400000
    s_cbranch_scc1 L_out0
    s_cbranch_vccnz L_spin0
L_out0:
    s_cmp_eq_u32 s61, 1
    s_branch L_back0
L_retry1:
    s_cselect_b32 s61, 1, 0
L_spin1:
    ds_read_addtid_b32 v199 offset:5120
    s_add_u32 s7, s7, 1
    s_waitcnt lgkmcnt(0)
    v_cmp_lt_u32 vcc, v199, v195
    s_cmp_ge_u32 s7, 0x400000
    s_cbranch_scc1 L_out1
    s_cbranch_vccnz L_spin1
L_out1:
    s_cmp_eq_u32 s61, 1
    s_branch L_back1
L_retry2:
    s_cselect_b32 s61, 1, 0
L_spin2:
    ds_read_addtid_b32 v199 offset:5120
    s_add_u32 s7, s7, 1
    s_waitcnt lgkmcnt(0)
    v_cmp_lt_u32 vcc, v199, v195
    s_cmp_ge_u32 s7, 0x400000
    s_cbranch_scc1 L_out2
    s_cbranch_vccnz L_spin2
L_out2:
    s_cmp_eq_u32 s61, 1
    s_branch L_back2
L_retry3:
    s_cselect_b32 s61, 1, 0
L_spin3:
    ds_read_addtid_b32 v199 offset:5120
    s_add_u32 s7, s7, 1
    s_waitcnt lgkmcnt(0)
    v_cmp_lt_u32 vcc, v199, v195
    s_cmp_ge_u32 s7, 0x400000
    s_cbranch_scc1 L_out3
    s_cbranch_vccnz L_spin3
L_out3:
    s_cmp_eq_u32 s61, 1
    s_branch L_back3
L_retry4:
    s_cselect_b32 s61, 1, 0
L_spin4:
    ds_read_addtid_b32 v199 offset:5120
    s_add_u32 s7, s7, 1
    s_waitcnt lgkmcnt(0)
    v_cmp_lt_u32 vcc, v199, v195
    s_cmp_ge_u32 s7, 0x400000
    s_cbranch_scc1 L_out4
    s_cbranch_vccnz L_spin4
L_out4:
    s_cmp_eq_u32 s61, 1
    s_branch L_back4
L_retry5:
    s_cselect_b32 s61, 1, 0
L_spin5:
    ds_read_addtid_b32 v199 offset:5120
    s_add_u32 s7, s7, 1
    s_waitcnt lgkmcnt(0)
    v_cmp_lt_u32 vcc, v199, v195
    s_cmp_ge_u32 s7, 0x400000
    s_cbranch_scc1 L_out5
    s_cbranch_vccnz L_spin5
L_out5:
    s_cmp_eq_u32 s61, 1
    s_branch L_back5
L_retry6:
    s_cselect_b32 s61, 1, 0
L_spin6:
    ds_read_addtid_b32 v199 offset:5120
    s_add_u32 s7, s7, 1
    s_waitcnt lgkmcnt(0)
    v_cmp_lt_u32 vcc, v199, v195
    s_cmp_ge_u32 s7, 0x400000
    s_cbranch_scc1 L_out6
    s_cbranch_vccnz L_spin6
L_out6:
    s_cmp_eq_u32 s61, 1
    s_branch L_back6
L_fin:
L_slow:
    s_waitcnt vmcnt(0) lgkmcnt(0)
    s_barrier
    s_mov_b32 s16, s4
    s_and_b32 s17, s5, 0xffff
    s_mov_b32 s18, 50331648
    s_mov_b32 s19, 0x00020000
    s_lshl_b32 s56, s40, 6
    v_lshrrev_b32 v0, 4, v203
    v_add_u32 v0, s56, v0
    v_lshlrev_b32 v2, 4, v0
    v_add_u32 v3, 73728, v2
    s_mov_b32 s56, 18
    s_mov_b32 s60, 0xffff0000
    s_waitcnt vmcnt(0) lgkmcnt(0)
    s_nop 11
L_s_w:
    buffer_load_dwordx4 v[8:11], v2, s[32:35], 0 offen
    buffer_load_dwordx4 v[12:15], v2, s[36:39], 0 offen
    s_waitcnt vmcnt(1)
    ds_write_b128 v2, v[8:11]
    s_waitcnt vmcnt(0)
    ds_write_b128 v3, v[12:15]
    v_add_u32 v2, 4096, v2
    v_add_u32 v3, 4096, v3
    s_sub_u32 s56, s56, 1
    s_waitcnt vmcnt(0) lgkmcnt(0)
    s_nop 11
    s_cmp_lg_u32 s56, 0
    s_cbranch_scc1 L_s_w
    v_mov_b32 v2, v0
    s_mov_b32 s56, 10
    v_mov_b32 v10, 163840
    s_waitcnt vmcnt(0) lgkmcnt(0)
    s_nop 11
L_s_c:
    v_lshlrev_b32 v3, 1, v2
    buffer_load_ushort v4, v3, s[28:31], 0 offen
    v_mul_u32_u24 v5, 683, v2
    v_lshrrev_b32 v5, 16, v5
    v_mul_u32_u24 v6, 96, v5
    v_sub_u32 v6, v2, v6
    v_mul_u32_u24 v7, 52, v5
    v_lshrrev_b32 v7, 8, v7
    v_mul_u32_u24 v8, 5, v7
    v_sub_u32 v8, v5, v8
    v_subrev_u32 v7, 1, v7
    v_subrev_u32 v8, 1, v8
    v_max_u32 v9, v7, v8
    v_cmp_gt_u32 vcc, 3, v9
    v_mul_u32_u24 v9, 3, v7
    v_add_u32 v9, v9, v8
    v_mul_u32_u24 v9, 96, v9
    v_add_u32 v9, v9, v6
    v_lshlrev_b32 v9, 1, v9
    v_cndmask_b32 v9, v10, v9, vcc
    buffer_load_ushort v11, v9, s[24:27], 0 offen
    s_waitcnt vmcnt(1)
    v_lshlrev_b32 v4, 16, v4
    s_waitcnt vmcnt(0)
    v_lshlrev_b32 v11, 16, v11
    v_add_f32 v4, v4, v11
    v_lshlrev_b32 v3, 2, v2
    v_add_u32 v3, 147456, v3
    ds_write_b32 v3, v4
    v_add_u32 v2, 256, v2
    s_sub_u32 s56, s56, 1
    s_waitcnt vmcnt(0) lgkmcnt(0)
    s_nop 11
    s_cmp_lg_u32 s56, 0
    s_cbranch_scc1 L_s_c
    s_barrier
    v_and_b32 v1, 63, v0
    v_lshrrev_b32 v3, 5, v1
    v_bfe_u32 v7, v1, 4, 1
    v_and_b32 v4, 15, v1
    v_add_u32 v4, s42, v4
    s_lshl_b32 s56, s40, 1
    s_add_u32 s56, s56, s41
    v_add_u32 v2, s56, v7
    v_bfe_u32 v6, v1, 2, 2
    v_and_b32 v5, 3, v1
    v_lshl_add_u32 v8, v3, 3, v6
    v_mul_u32_u24 v8, 768, v8
    v_lshl_add_u32 v8, v7, 5, v8
    v_lshl_add_u32 v8, v5, 3, v8
    v_lshl_add_u32 v9, v3, 2, v6
    v_mul_u32_u24 v9, 192, v9
    v_lshl_add_u32 v9, v7, 5, v9
    v_and_b32 v10, 1, v5
    v_lshl_add_u32 v9, v10, 4, v9
    v_lshrrev_b32 v10, 1, v5
    v_lshl_add_u32 v9, v10, 3, v9
    v_add_u32 v9, 73728, v9
    v_lshlrev_b32 v11, 4, v3
    s_mov_b32 s57, 8
    s_mov_b32 s61, 0xbdd2d3e8
    v_mov_b32 v15, 0xc0135761
    s_waitcnt vmcnt(0) lgkmcnt(0)
    s_nop 11
L_s_tile:
    v_mov_b64 v[16:17], 0
    v_mov_b64 v[18:19], 0
    v_mov_b64 v[20:21], 0
    v_mov_b64 v[22:23], 0
    v_mov_b64 v[24:25], 0
    v_mov_b64 v[26:27], 0
    v_mov_b64 v[28:29], 0
    v_mov_b64 v[30:31], 0
    v_mov_b64 v[32:33], 0
    v_mov_b64 v[34:35], 0
    v_mov_b64 v[36:37], 0
    v_mov_b64 v[38:39], 0
    v_mov_b64 v[40:41], 0
    v_mov_b64 v[42:43], 0
    v_mov_b64 v[44:45], 0
    v_mov_b64 v[46:47], 0
    v_mov_b64 v[48:49], 0
    v_mov_b64 v[50:51], 0
    v_mov_b64 v[52:53], 0
    v_mov_b64 v[54:55], 0
    v_mov_b64 v[56:57], 0
    v_mov_b64 v[58:59], 0
    v_mov_b64 v[60:61], 0
    v_mov_b64 v[62:63], 0
    v_lshlrev_b32 v10, 5, v3
    v_add_u32 v10, 147456, v10
    s_mov_b32 s58, -2
    s_waitcnt vmcnt(0) lgkmcnt(0)
    s_nop 11
L_s_ti:
    s_mov_b32 s59, -2
L_s_tj:
    v_add_u32 v12, s59, v4
    v_add_u32 v13, s58, v2
    v_max_u32 v14, v12, v13
    v_cmp_gt_u32 vcc, 512, v14
    v_lshl_add_u32 v12, v13, 9, v12
    v_mul_u32_u24 v12, 192, v12
    v_add_u32 v12, v12, v11
    v_mov_b32 v13, 0x7f000000
    v_cndmask_b32 v12, v13, v12, vcc
    buffer_load_dwordx4 v[64:67], v12, s[16:19], 0 offen offset:0
    buffer_load_dwordx4 v[68:71], v12, s[16:19], 0 offen offset:32
    buffer_load_dwordx4 v[72:75], v12, s[16:19], 0 offen offset:64
    buffer_load_dwordx4 v[76:79], v12, s[16:19], 0 offen offset:96
    buffer_load_dwordx4 v[80:83], v12, s[16:19], 0 offen offset:128
    buffer_load_dwordx4 v[84:87], v12, s[16:19], 0 offen offset:160
    ds_read_b128 v[88:91], v10 offset:0
    ds_read_b128 v[92:95], v10 offset:16
    s_waitcnt vmcnt(5)
    v_lshlrev_b32 v13, 16, v64
    s_waitcnt lgkmcnt(1)
    v_fmac_f32 v16, v13, v88
    v_and_b32 v13, s60, v64
    v_fmac_f32 v17, v13, v89
    v_lshlrev_b32 v13, 16, v65
    v_fmac_f32 v18, v13, v90
    v_and_b32 v13, s60, v65
    v_fmac_f32 v19, v13, v91
    v_lshlrev_b32 v13, 16, v66
    s_waitcnt lgkmcnt(0)
    v_fmac_f32 v20, v13, v92
    v_and_b32 v13, s60, v66
    v_fmac_f32 v21, v13, v93
    v_lshlrev_b32 v13, 16, v67
    v_fmac_f32 v22, v13, v94
    v_and_b32 v13, s60, v67
    v_fmac_f32 v23, v13, v95
    ds_read_b128 v[88:91], v10 offset:64
    ds_read_b128 v[92:95], v10 offset:80
    s_waitcnt vmcnt(4)
    v_lshlrev_b32 v13, 16, v68
    s_waitcnt lgkmcnt(1)
    v_fmac_f32 v24, v13, v88
    v_and_b32 v13, s60, v68
    v_fmac_f32 v25, v13, v89
    v_lshlrev_b32 v13, 16, v69
    v_fmac_f32 v26, v13, v90
    v_and_b32 v13, s60, v69
    v_fmac_f32 v27, v13, v91
    v_lshlrev_b32 v13, 16, v70
    s_waitcnt lgkmcnt(0)
    v_fmac_f32 v28, v13, v92
    v_and_b32 v13, s60, v70
    v_fmac_f32 v29, v13, v93
    v_lshlrev_b32 v13, 16, v71
    v_fmac_f32 v30, v13, v94
    v_and_b32 v13, s60, v71
    v_fmac_f32 v31, v13, v95
    ds_read_b128 v[88:91], v10 offset:128
    ds_read_b128 v[92:95], v10 offset:144
    s_waitcnt vmcnt(3)
    v_lshlrev_b32 v13, 16, v72
    s_waitcnt lgkmcnt(1)
    v_fmac_f32 v32, v13, v88
    v_and_b32 v13, s60, v72
    v_fmac_f32 v33, v13, v89
    v_lshlrev_b32 v13, 16, v73
    v_fmac_f32 v34, v13, v90
    v_and_b32 v13, s60, v73
    v_fmac_f32 v35, v13, v91
    v_lshlrev_b32 v13, 16, v74
    s_waitcnt lgkmcnt(0)
    v_fmac_f32 v36, v13, v92
    v_and_b32 v13, s60, v74
    v_fmac_f32 v37, v13, v93
    v_lshlrev_b32 v13, 16, v75
    v_fmac_f32 v38, v13, v94
    v_and_b32 v13, s60, v75
    v_fmac_f32 v39, v13, v95
    ds_read_b128 v[88:91], v10 offset:192
    ds_read_b128 v[92:95], v10 offset:208
    s_waitcnt vmcnt(2)
    v_lshlrev_b32 v13, 16, v76
    s_waitcnt lgkmcnt(1)
    v_fmac_f32 v40, v13, v88
    v_and_b32 v13, s60, v76
    v_fmac_f32 v41, v13, v89
    v_lshlrev_b32 v13, 16, v77
    v_fmac_f32 v42, v13, v90
    v_and_b32 v13, s60, v77
    v_fmac_f32 v43, v13, v91
    v_lshlrev_b32 v13, 16, v78
    s_waitcnt lgkmcnt(0)
    v_fmac_f32 v44, v13, v92
    v_and_b32 v13, s60, v78
    v_fmac_f32 v45, v13, v93
    v_lshlrev_b32 v13, 16, v79
    v_fmac_f32 v46, v13, v94
    v_and_b32 v13, s60, v79
    v_fmac_f32 v47, v13, v95
    ds_read_b128 v[88:91], v10 offset:256
    ds_read_b128 v[92:95], v10 offset:272
    s_waitcnt vmcnt(1)
    v_lshlrev_b32 v13, 16, v80
    s_waitcnt lgkmcnt(1)
    v_fmac_f32 v48, v13, v88
    v_and_b32 v13, s60, v80
    v_fmac_f32 v49, v13, v89
    v_lshlrev_b32 v13, 16, v81
    v_fmac_f32 v50, v13, v90
    v_and_b32 v13, s60, v81
    v_fmac_f32 v51, v13, v91
    v_lshlrev_b32 v13, 16, v82
    s_waitcnt lgkmcnt(0)
    v_fmac_f32 v52, v13, v92
    v_and_b32 v13, s60, v82
    v_fmac_f32 v53, v13, v93
    v_lshlrev_b32 v13, 16, v83
    v_fmac_f32 v54, v13, v94
    v_and_b32 v13, s60, v83
    v_fmac_f32 v55, v13, v95
    ds_read_b128 v[88:91], v10 offset:320
    ds_read_b128 v[92:95], v10 offset:336
    s_waitcnt vmcnt(0)
    v_lshlrev_b32 v13, 16, v84
    s_waitcnt lgkmcnt(1)
    v_fmac_f32 v56, v13, v88
    v_and_b32 v13, s60, v84
    v_fmac_f32 v57, v13, v89
    v_lshlrev_b32 v13, 16, v85
    v_fmac_f32 v58, v13, v90
    v_and_b32 v13, s60, v85
    v_fmac_f32 v59, v13, v91
    v_lshlrev_b32 v13, 16, v86
    s_waitcnt lgkmcnt(0)
    v_fmac_f32 v60, v13, v92
    v_and_b32 v13, s60, v86
    v_fmac_f32 v61, v13, v93
    v_lshlrev_b32 v13, 16, v87
    v_fmac_f32 v62, v13, v94
    v_and_b32 v13, s60, v87
    v_fmac_f32 v63, v13, v95
    v_add_u32 v10, 384, v10
    s_add_i32 s59, s59, 1
    s_waitcnt vmcnt(0) lgkmcnt(0)
    s_nop 11
    s_cmp_lt_i32 s59, 3
    s_cbranch_scc1 L_s_tj
    s_add_i32 s58, s58, 1
    s_cmp_lt_i32 s58, 3
    s_cbranch_scc1 L_s_ti
    v_mov_b32 v12, v16
    v_add_f32 v12, v12, v17
    v_add_f32 v12, v12, v18
    v_add_f32 v12, v12, v19
    v_add_f32 v12, v12, v20
    v_add_f32 v12, v12, v21
    v_add_f32 v12, v12, v22
    v_add_f32 v12, v12, v23
    v_add_f32 v12, v12, v24
    v_add_f32 v12, v12, v25
    v_add_f32 v12, v12, v26
    v_add_f32 v12, v12, v27
    v_add_f32 v12, v12, v28
    v_add_f32 v12, v12, v29
    v_add_f32 v12, v12, v30
    v_add_f32 v12, v12, v31
    v_add_f32 v12, v12, v32
    v_add_f32 v12, v12, v33
    v_add_f32 v12, v12, v34
    v_add_f32 v12, v12, v35
    v_add_f32 v12, v12, v36
    v_add_f32 v12, v12, v37
    v_add_f32 v12, v12, v38
    v_add_f32 v12, v12, v39
    v_add_f32 v12, v12, v40
    v_add_f32 v12, v12, v41
    v_add_f32 v12, v12, v42
    v_add_f32 v12, v12, v43
    v_add_f32 v12, v12, v44
    v_add_f32 v12, v12, v45
    v_add_f32 v12, v12, v46
    v_add_f32 v12, v12, v47
    v_add_f32 v12, v12, v48
    v_add_f32 v12, v12, v49
    v_add_f32 v12, v12, v50
    v_add_f32 v12, v12, v51
    v_add_f32 v12, v12, v52
    v_add_f32 v12, v12, v53
    v_add_f32 v12, v12, v54
    v_add_f32 v12, v12, v55
    v_add_f32 v12, v12, v56
    v_add_f32 v12, v12, v57
    v_add_f32 v12, v12, v58
    v_add_f32 v12, v12, v59
    v_add_f32 v12, v12, v60
    v_add_f32 v12, v12, v61
    v_add_f32 v12, v12, v62
    v_add_f32 v12, v12, v63
    v_mov_b32 v13, v12
    s_nop 1
    v_permlane32_swap_b32 v12, v13
    s_nop 1
    v_add_f32 v12, v12, v13
    v_mul_f32 v12, s52, v12
    v_sub_f32 v16, v16, v12
    v_sub_f32 v17, v17, v12
    v_sub_f32 v18, v18, v12
    v_sub_f32 v19, v19, v12
    v_sub_f32 v20, v20, v12
    v_sub_f32 v21, v21, v12
    v_sub_f32 v22, v22, v12
    v_sub_f32 v23, v23, v12
    v_sub_f32 v24, v24, v12
    v_sub_f32 v25, v25, v12
    v_sub_f32 v26, v26, v12
    v_sub_f32 v27, v27, v12
    v_sub_f32 v28, v28, v12
    v_sub_f32 v29, v29, v12
    v_sub_f32 v30, v30, v12
    v_sub_f32 v31, v31, v12
    v_sub_f32 v32, v32, v12
    v_sub_f32 v33, v33, v12
    v_sub_f32 v34, v34, v12
    v_sub_f32 v35, v35, v12
    v_sub_f32 v36, v36, v12
    v_sub_f32 v37, v37, v12
    v_sub_f32 v38, v38, v12
    v_sub_f32 v39, v39, v12
    v_sub_f32 v40, v40, v12
    v_sub_f32 v41, v41, v12
    v_sub_f32 v42, v42, v12
    v_sub_f32 v43, v43, v12
    v_sub_f32 v44, v44, v12
    v_sub_f32 v45, v45, v12
    v_sub_f32 v46, v46, v12
    v_sub_f32 v47, v47, v12
    v_sub_f32 v48, v48, v12
    v_sub_f32 v49, v49, v12
    v_sub_f32 v50, v50, v12
    v_sub_f32 v51, v51, v12
    v_sub_f32 v52, v52, v12
    v_sub_f32 v53, v53, v12
    v_sub_f32 v54, v54, v12
    v_sub_f32 v55, v55, v12
    v_sub_f32 v56, v56, v12
    v_sub_f32 v57, v57, v12
    v_sub_f32 v58, v58, v12
    v_sub_f32 v59, v59, v12
    v_sub_f32 v60, v60, v12
    v_sub_f32 v61, v61, v12
    v_sub_f32 v62, v62, v12
    v_sub_f32 v63, v63, v12
    v_mul_f32 v12, v16, v16
    v_fmac_f32 v12, v17, v17
    v_fmac_f32 v12, v18, v18
    v_fmac_f32 v12, v19, v19
    v_fmac_f32 v12, v20, v20
    v_fmac_f32 v12, v21, v21
    v_fmac_f32 v12, v22, v22
    v_fmac_f32 v12, v23, v23
    v_fmac_f32 v12, v24, v24
    v_fmac_f32 v12, v25, v25
    v_fmac_f32 v12, v26, v26
    v_fmac_f32 v12, v27, v27
    v_fmac_f32 v12, v28, v28
    v_fmac_f32 v12, v29, v29
    v_fmac_f32 v12, v30, v30
    v_fmac_f32 v12, v31, v31
    v_fmac_f32 v12, v32, v32
    v_fmac_f32 v12, v33, v33
    v_fmac_f32 v12, v34, v34
    v_fmac_f32 v12, v35, v35
    v_fmac_f32 v12, v36, v36
    v_fmac_f32 v12, v37, v37
    v_fmac_f32 v12, v38, v38
    v_fmac_f32 v12, v39, v39
    v_fmac_f32 v12, v40, v40
    v_fmac_f32 v12, v41, v41
    v_fmac_f32 v12, v42, v42
    v_fmac_f32 v12, v43, v43
    v_fmac_f32 v12, v44, v44
    v_fmac_f32 v12, v45, v45
    v_fmac_f32 v12, v46, v46
    v_fmac_f32 v12, v47, v47
    v_fmac_f32 v12, v48, v48
    v_fmac_f32 v12, v49, v49
    v_fmac_f32 v12, v50, v50
    v_fmac_f32 v12, v51, v51
    v_fmac_f32 v12, v52, v52
    v_fmac_f32 v12, v53, v53
    v_fmac_f32 v12, v54, v54
    v_fmac_f32 v12, v55, v55
    v_fmac_f32 v12, v56, v56
    v_fmac_f32 v12, v57, v57
    v_fmac_f32 v12, v58, v58
    v_fmac_f32 v12, v59, v59
    v_fmac_f32 v12, v60, v60
    v_fmac_f32 v12, v61, v61
    v_fmac_f32 v12, v62, v62
    v_fmac_f32 v12, v63, v63
    v_mov_b32 v13, v12
    s_nop 1
    v_permlane32_swap_b32 v12, v13
    s_nop 1
    v_add_f32 v12, v12, v13
    v_mul_f32 v12, s52, v12
    v_add_f32 v12, s51, v12
    v_rsq_f32 v12, v12
    s_nop 0
    v_mul_f32 v16, v16, v12
    v_mul_f32 v17, v17, v12
    v_mul_f32 v18, v18, v12
    v_mul_f32 v19, v19, v12
    v_mul_f32 v20, v20, v12
    v_mul_f32 v21, v21, v12
    v_mul_f32 v22, v22, v12
    v_mul_f32 v23, v23, v12
    v_mul_f32 v24, v24, v12
    v_mul_f32 v25, v25, v12
    v_mul_f32 v26, v26, v12
    v_mul_f32 v27, v27, v12
    v_mul_f32 v28, v28, v12
    v_mul_f32 v29, v29, v12
    v_mul_f32 v30, v30, v12
    v_mul_f32 v31, v31, v12
    v_mul_f32 v32, v32, v12
    v_mul_f32 v33, v33, v12
    v_mul_f32 v34, v34, v12
    v_mul_f32 v35, v35, v12
    v_mul_f32 v36, v36, v12
    v_mul_f32 v37, v37, v12
    v_mul_f32 v38, v38, v12
    v_mul_f32 v39, v39, v12
    v_mul_f32 v40, v40, v12
    v_mul_f32 v41, v41, v12
    v_mul_f32 v42, v42, v12
    v_mul_f32 v43, v43, v12
    v_mul_f32 v44, v44, v12
    v_mul_f32 v45, v45, v12
    v_mul_f32 v46, v46, v12
    v_mul_f32 v47, v47, v12
    v_mul_f32 v48, v48, v12
    v_mul_f32 v49, v49, v12
    v_mul_f32 v50, v50, v12
    v_mul_f32 v51, v51, v12
    v_mul_f32 v52, v52, v12
    v_mul_f32 v53, v53, v12
    v_mul_f32 v54, v54, v12
    v_mul_f32 v55, v55, v12
    v_mul_f32 v56, v56, v12
    v_mul_f32 v57, v57, v12
    v_mul_f32 v58, v58, v12
    v_mul_f32 v59, v59, v12
    v_mul_f32 v60, v60, v12
    v_mul_f32 v61, v61, v12
    v_mul_f32 v62, v62, v12
    v_mul_f32 v63, v63, v12
    v_cvt_pk_bf16_f32 v64, v16, v17
    v_cvt_pk_bf16_f32 v65, v18, v19
    v_cvt_pk_bf16_f32 v66, v20, v21
    v_cvt_pk_bf16_f32 v67, v22, v23
    v_cvt_pk_bf16_f32 v68, v24, v25
    v_cvt_pk_bf16_f32 v69, v26, v27
    v_cvt_pk_bf16_f32 v70, v28, v29
    v_cvt_pk_bf16_f32 v71, v30, v31
    v_cvt_pk_bf16_f32 v72, v32, v33
    v_cvt_pk_bf16_f32 v73, v34, v35
    v_cvt_pk_bf16_f32 v74, v36, v37
    v_cvt_pk_bf16_f32 v75, v38, v39
    v_cvt_pk_bf16_f32 v76, v40, v41
    v_cvt_pk_bf16_f32 v77, v42, v43
    v_cvt_pk_bf16_f32 v78, v44, v45
    v_cvt_pk_bf16_f32 v79, v46, v47
    v_cvt_pk_bf16_f32 v80, v48, v49
    v_cvt_pk_bf16_f32 v81, v50, v51
    v_cvt_pk_bf16_f32 v82, v52, v53
    v_cvt_pk_bf16_f32 v83, v54, v55
    v_cvt_pk_bf16_f32 v84, v56, v57
    v_cvt_pk_bf16_f32 v85, v58, v59
    v_cvt_pk_bf16_f32 v86, v60, v61
    v_cvt_pk_bf16_f32 v87, v62, v63
    v_mov_b64 v[16:17], 0
    v_mov_b64 v[18:19], 0
    v_mov_b64 v[20:21], 0
    v_mov_b64 v[22:23], 0
    v_mov_b64 v[24:25], 0
    v_mov_b64 v[26:27], 0
    v_mov_b64 v[28:29], 0
    v_mov_b64 v[30:31], 0
    v_mov_b64 v[32:33], 0
    v_mov_b64 v[34:35], 0
    v_mov_b64 v[36:37], 0
    v_mov_b64 v[38:39], 0
    v_mov_b64 v[40:41], 0
    v_mov_b64 v[42:43], 0
    v_mov_b64 v[44:45], 0
    v_mov_b64 v[46:47], 0
    v_mov_b64 v[48:49], 0
    v_mov_b64 v[50:51], 0
    v_mov_b64 v[52:53], 0
    v_mov_b64 v[54:55], 0
    v_mov_b64 v[56:57], 0
    v_mov_b64 v[58:59], 0
    v_mov_b64 v[60:61], 0
    v_mov_b64 v[62:63], 0
    v_mov_b32 v12, v8
    v_mov_b32 v13, v9
    s_mov_b32 s58, 12
    s_waitcnt vmcnt(0) lgkmcnt(0)
    s_nop 11
L_s_blk:
    v_add_u32 v5, 36864, v12
    ds_read_b64_tr_b16 v[136:137], v12 offset:0
    ds_read_b64_tr_b16 v[138:139], v12 offset:3072
    ds_read_b64_tr_b16 v[140:141], v12 offset:12288
    ds_read_b64_tr_b16 v[142:143], v12 offset:15360
    ds_read_b64_tr_b16 v[144:145], v12 offset:24576
    ds_read_b64_tr_b16 v[146:147], v12 offset:27648
    ds_read_b64_tr_b16 v[148:149], v5 offset:0
    ds_read_b64_tr_b16 v[150:151], v5 offset:3072
    ds_read_b64_tr_b16 v[152:153], v5 offset:12288
    ds_read_b64_tr_b16 v[154:155], v5 offset:15360
    ds_read_b64_tr_b16 v[156:157], v5 offset:24576
    ds_read_b64_tr_b16 v[158:159], v5 offset:27648
    s_waitcnt lgkmcnt(10)
    v_mfma_f32_32x32x16_bf16 v[120:135], v[136:139], v[64:67], 0
    s_waitcnt lgkmcnt(8)
    v_mfma_f32_32x32x16_bf16 v[120:135], v[140:143], v[68:71], v[120:135]
    s_waitcnt lgkmcnt(6)
    v_mfma_f32_32x32x16_bf16 v[120:135], v[144:147], v[72:75], v[120:135]
    s_waitcnt lgkmcnt(4)
    v_mfma_f32_32x32x16_bf16 v[120:135], v[148:151], v[76:79], v[120:135]
    s_waitcnt lgkmcnt(2)
    v_mfma_f32_32x32x16_bf16 v[120:135], v[152:155], v[80:83], v[120:135]
    s_waitcnt lgkmcnt(0)
    v_mfma_f32_32x32x16_bf16 v[120:135], v[156:159], v[84:87], v[120:135]
    s_nop 11
    v_mul_f32 v168, v120, v120
    v_fma_f32 v168, v168, s61, v15
    v_mul_f32 v168, v168, v120
    v_exp_f32 v168, v168
    s_nop 0
    v_add_f32 v168, 1.0, v168
    v_rcp_f32 v168, v168
    s_nop 0
    v_mul_f32 v120, v120, v168
    v_mul_f32 v168, v121, v121
    v_fma_f32 v168, v168, s61, v15
    v_mul_f32 v168, v168, v121
    v_exp_f32 v168, v168
    s_nop 0
    v_add_f32 v168, 1.0, v168
    v_rcp_f32 v168, v168
    s_nop 0
    v_mul_f32 v121, v121, v168
    v_mul_f32 v168, v122, v122
    v_fma_f32 v168, v168, s61, v15
    v_mul_f32 v168, v168, v122
    v_exp_f32 v168, v168
    s_nop 0
    v_add_f32 v168, 1.0, v168
    v_rcp_f32 v168, v168
    s_nop 0
    v_mul_f32 v122, v122, v168
    v_mul_f32 v168, v123, v123
    v_fma_f32 v168, v168, s61, v15
    v_mul_f32 v168, v168, v123
    v_exp_f32 v168, v168
    s_nop 0
    v_add_f32 v168, 1.0, v168
    v_rcp_f32 v168, v168
    s_nop 0
    v_mul_f32 v123, v123, v168
    v_mul_f32 v168, v124, v124
    v_fma_f32 v168, v168, s61, v15
    v_mul_f32 v168, v168, v124
    v_exp_f32 v168, v168
    s_nop 0
    v_add_f32 v168, 1.0, v168
    v_rcp_f32 v168, v168
    s_nop 0
    v_mul_f32 v124, v124, v168
    v_mul_f32 v168, v125, v125
    v_fma_f32 v168, v168, s61, v15
    v_mul_f32 v168, v168, v125
    v_exp_f32 v168, v168
    s_nop 0
    v_add_f32 v168, 1.0, v168
    v_rcp_f32 v168, v168
    s_nop 0
    v_mul_f32 v125, v125, v168
    v_mul_f32 v168, v126, v126
    v_fma_f32 v168, v168, s61, v15
    v_mul_f32 v168, v168, v126
    v_exp_f32 v168, v168
    s_nop 0
    v_add_f32 v168, 1.0, v168
    v_rcp_f32 v168, v168
    s_nop 0
    v_mul_f32 v126, v126, v168
    v_mul_f32 v168, v127, v127
    v_fma_f32 v168, v168, s61, v15
    v_mul_f32 v168, v168, v127
    v_exp_f32 v168, v168
    s_nop 0
    v_add_f32 v168, 1.0, v168
    v_rcp_f32 v168, v168
    s_nop 0
    v_mul_f32 v127, v127, v168
    v_mul_f32 v168, v128, v128
    v_fma_f32 v168, v168, s61, v15
    v_mul_f32 v168, v168, v128
    v_exp_f32 v168, v168
    s_nop 0
    v_add_f32 v168, 1.0, v168
    v_rcp_f32 v168, v168
    s_nop 0
    v_mul_f32 v128, v128, v168
    v_mul_f32 v168, v129, v129
    v_fma_f32 v168, v168, s61, v15
    v_mul_f32 v168, v168, v129
    v_exp_f32 v168, v168
    s_nop 0
    v_add_f32 v168, 1.0, v168
    v_rcp_f32 v168, v168
    s_nop 0
    v_mul_f32 v129, v129, v168
    v_mul_f32 v168, v130, v130
    v_fma_f32 v168, v168, s61, v15
    v_mul_f32 v168, v168, v130
    v_exp_f32 v168, v168
    s_nop 0
    v_add_f32 v168, 1.0, v168
    v_rcp_f32 v168, v168
    s_nop 0
    v_mul_f32 v130, v130, v168
    v_mul_f32 v168, v131, v131
    v_fma_f32 v168, v168, s61, v15
    v_mul_f32 v168, v168, v131
    v_exp_f32 v168, v168
    s_nop 0
    v_add_f32 v168, 1.0, v168
    v_rcp_f32 v168, v168
    s_nop 0
    v_mul_f32 v131, v131, v168
    v_mul_f32 v168, v132, v132
    v_fma_f32 v168, v168, s61, v15
    v_mul_f32 v168, v168, v132
    v_exp_f32 v168, v168
    s_nop 0
    v_add_f32 v168, 1.0, v168
    v_rcp_f32 v168, v168
    s_nop 0
    v_mul_f32 v132, v132, v168
    v_mul_f32 v168, v133, v133
    v_fma_f32 v168, v168, s61, v15
    v_mul_f32 v168, v168, v133
    v_exp_f32 v168, v168
    s_nop 0
    v_add_f32 v168, 1.0, v168
    v_rcp_f32 v168, v168
    s_nop 0
    v_mul_f32 v133, v133, v168
    v_mul_f32 v168, v134, v134
    v_fma_f32 v168, v168, s61, v15
    v_mul_f32 v168, v168, v134
    v_exp_f32 v168, v168
    s_nop 0
    v_add_f32 v168, 1.0, v168
    v_rcp_f32 v168, v168
    s_nop 0
    v_mul_f32 v134, v134, v168
    v_mul_f32 v168, v135, v135
    v_fma_f32 v168, v168, s61, v15
    v_mul_f32 v168, v168, v135
    v_exp_f32 v168, v168
    s_nop 0
    v_add_f32 v168, 1.0, v168
    v_rcp_f32 v168, v168
    s_nop 0
    v_mul_f32 v135, v135, v168
    v_cvt_pk_bf16_f32 v160, v120, v121
    v_cvt_pk_bf16_f32 v161, v122, v123
    v_cvt_pk_bf16_f32 v162, v124, v125
    v_cvt_pk_bf16_f32 v163, v126, v127
    v_cvt_pk_bf16_f32 v164, v128, v129
    v_cvt_pk_bf16_f32 v165, v130, v131
    v_cvt_pk_bf16_f32 v166, v132, v133
    v_cvt_pk_bf16_f32 v167, v134, v135
    ds_read_b64_tr_b16 v[136:137], v13 offset:0
    ds_read_b64_tr_b16 v[138:139], v13 offset:1536
    ds_read_b64_tr_b16 v[140:141], v13 offset:64
    ds_read_b64_tr_b16 v[142:143], v13 offset:1600
    ds_read_b64_tr_b16 v[144:145], v13 offset:128
    ds_read_b64_tr_b16 v[146:147], v13 offset:1664
    ds_read_b64_tr_b16 v[148:149], v13 offset:3072
    ds_read_b64_tr_b16 v[150:151], v13 offset:4608
    ds_read_b64_tr_b16 v[152:153], v13 offset:3136
    ds_read_b64_tr_b16 v[154:155], v13 offset:4672
    ds_read_b64_tr_b16 v[156:157], v13 offset:3200
    ds_read_b64_tr_b16 v[158:159], v13 offset:4736
    s_waitcnt lgkmcnt(10)
    v_mfma_f32_32x32x16_bf16 v[16:31], v[136:139], v[160:163], v[16:31]
    s_waitcnt lgkmcnt(8)
    v_mfma_f32_32x32x16_bf16 v[32:47], v[140:143], v[160:163], v[32:47]
    s_waitcnt lgkmcnt(6)
    v_mfma_f32_32x32x16_bf16 v[48:63], v[144:147], v[160:163], v[48:63]
    s_waitcnt lgkmcnt(4)
    v_mfma_f32_32x32x16_bf16 v[16:31], v[148:151], v[164:167], v[16:31]
    s_waitcnt lgkmcnt(2)
    v_mfma_f32_32x32x16_bf16 v[32:47], v[152:155], v[164:167], v[32:47]
    s_waitcnt lgkmcnt(0)
    v_mfma_f32_32x32x16_bf16 v[48:63], v[156:159], v[164:167], v[48:63]
    v_add_u32 v12, 64, v12
    v_add_u32 v13, 6144, v13
    s_sub_u32 s58, s58, 1
    s_waitcnt vmcnt(0) lgkmcnt(0)
    s_nop 11
    s_cmp_lg_u32 s58, 0
    s_cbranch_scc1 L_s_blk
    v_lshl_add_u32 v14, v2, 9, v4
    v_mul_u32_u24 v14, 192, v14
    v_add_u32 v14, v14, v11
    buffer_load_dwordx4 v[136:139], v14, s[16:19], 0 offen offset:0
    buffer_load_dwordx4 v[140:143], v14, s[16:19], 0 offen offset:32
    buffer_load_dwordx4 v[144:147], v14, s[16:19], 0 offen offset:64
    buffer_load_dwordx4 v[148:151], v14, s[16:19], 0 offen offset:96
    buffer_load_dwordx4 v[152:155], v14, s[16:19], 0 offen offset:128
    buffer_load_dwordx4 v[156:159], v14, s[16:19], 0 offen offset:160
    s_waitcnt vmcnt(5)
    v_lshlrev_b32 v12, 16, v136
    v_add_f32 v16, v16, v12
    v_and_b32 v12, s60, v136
    v_add_f32 v17, v17, v12
    v_cvt_pk_bf16_f32 v64, v16, v17
    v_lshlrev_b32 v12, 16, v137
    v_add_f32 v18, v18, v12
    v_and_b32 v12, s60, v137
    v_add_f32 v19, v19, v12
    v_cvt_pk_bf16_f32 v65, v18, v19
    v_lshlrev_b32 v12, 16, v138
    v_add_f32 v20, v20, v12
    v_and_b32 v12, s60, v138
    v_add_f32 v21, v21, v12
    v_cvt_pk_bf16_f32 v66, v20, v21
    v_lshlrev_b32 v12, 16, v139
    v_add_f32 v22, v22, v12
    v_and_b32 v12, s60, v139
    v_add_f32 v23, v23, v12
    v_cvt_pk_bf16_f32 v67, v22, v23
    buffer_store_dwordx4 v[64:67], v14, s[20:23], 0 offen offset:0
    s_waitcnt vmcnt(5)
    v_lshlrev_b32 v12, 16, v140
    v_add_f32 v24, v24, v12
    v_and_b32 v12, s60, v140
    v_add_f32 v25, v25, v12
    v_cvt_pk_bf16_f32 v68, v24, v25
    v_lshlrev_b32 v12, 16, v141
    v_add_f32 v26, v26, v12
    v_and_b32 v12, s60, v141
    v_add_f32 v27, v27, v12
    v_cvt_pk_bf16_f32 v69, v26, v27
    v_lshlrev_b32 v12, 16, v142
    v_add_f32 v28, v28, v12
    v_and_b32 v12, s60, v142
    v_add_f32 v29, v29, v12
    v_cvt_pk_bf16_f32 v70, v28, v29
    v_lshlrev_b32 v12, 16, v143
    v_add_f32 v30, v30, v12
    v_and_b32 v12, s60, v143
    v_add_f32 v31, v31, v12
    v_cvt_pk_bf16_f32 v71, v30, v31
    buffer_store_dwordx4 v[68:71], v14, s[20:23], 0 offen offset:32
    s_waitcnt vmcnt(5)
    v_lshlrev_b32 v12, 16, v144
    v_add_f32 v32, v32, v12
    v_and_b32 v12, s60, v144
    v_add_f32 v33, v33, v12
    v_cvt_pk_bf16_f32 v72, v32, v33
    v_lshlrev_b32 v12, 16, v145
    v_add_f32 v34, v34, v12
    v_and_b32 v12, s60, v145
    v_add_f32 v35, v35, v12
    v_cvt_pk_bf16_f32 v73, v34, v35
    v_lshlrev_b32 v12, 16, v146
    v_add_f32 v36, v36, v12
    v_and_b32 v12, s60, v146
    v_add_f32 v37, v37, v12
    v_cvt_pk_bf16_f32 v74, v36, v37
    v_lshlrev_b32 v12, 16, v147
    v_add_f32 v38, v38, v12
    v_and_b32 v12, s60, v147
    v_add_f32 v39, v39, v12
    v_cvt_pk_bf16_f32 v75, v38, v39
    buffer_store_dwordx4 v[72:75], v14, s[20:23], 0 offen offset:64
    s_waitcnt vmcnt(5)
    v_lshlrev_b32 v12, 16, v148
    v_add_f32 v40, v40, v12
    v_and_b32 v12, s60, v148
    v_add_f32 v41, v41, v12
    v_cvt_pk_bf16_f32 v76, v40, v41
    v_lshlrev_b32 v12, 16, v149
    v_add_f32 v42, v42, v12
    v_and_b32 v12, s60, v149
    v_add_f32 v43, v43, v12
    v_cvt_pk_bf16_f32 v77, v42, v43
    v_lshlrev_b32 v12, 16, v150
    v_add_f32 v44, v44, v12
    v_and_b32 v12, s60, v150
    v_add_f32 v45, v45, v12
    v_cvt_pk_bf16_f32 v78, v44, v45
    v_lshlrev_b32 v12, 16, v151
    v_add_f32 v46, v46, v12
    v_and_b32 v12, s60, v151
    v_add_f32 v47, v47, v12
    v_cvt_pk_bf16_f32 v79, v46, v47
    buffer_store_dwordx4 v[76:79], v14, s[20:23], 0 offen offset:96
    s_waitcnt vmcnt(5)
    v_lshlrev_b32 v12, 16, v152
    v_add_f32 v48, v48, v12
    v_and_b32 v12, s60, v152
    v_add_f32 v49, v49, v12
    v_cvt_pk_bf16_f32 v80, v48, v49
    v_lshlrev_b32 v12, 16, v153
    v_add_f32 v50, v50, v12
    v_and_b32 v12, s60, v153
    v_add_f32 v51, v51, v12
    v_cvt_pk_bf16_f32 v81, v50, v51
    v_lshlrev_b32 v12, 16, v154
    v_add_f32 v52, v52, v12
    v_and_b32 v12, s60, v154
    v_add_f32 v53, v53, v12
    v_cvt_pk_bf16_f32 v82, v52, v53
    v_lshlrev_b32 v12, 16, v155
    v_add_f32 v54, v54, v12
    v_and_b32 v12, s60, v155
    v_add_f32 v55, v55, v12
    v_cvt_pk_bf16_f32 v83, v54, v55
    buffer_store_dwordx4 v[80:83], v14, s[20:23], 0 offen offset:128
    s_waitcnt vmcnt(5)
    v_lshlrev_b32 v12, 16, v156
    v_add_f32 v56, v56, v12
    v_and_b32 v12, s60, v156
    v_add_f32 v57, v57, v12
    v_cvt_pk_bf16_f32 v84, v56, v57
    v_lshlrev_b32 v12, 16, v157
    v_add_f32 v58, v58, v12
    v_and_b32 v12, s60, v157
    v_add_f32 v59, v59, v12
    v_cvt_pk_bf16_f32 v85, v58, v59
    v_lshlrev_b32 v12, 16, v158
    v_add_f32 v60, v60, v12
    v_and_b32 v12, s60, v158
    v_add_f32 v61, v61, v12
    v_cvt_pk_bf16_f32 v86, v60, v61
    v_lshlrev_b32 v12, 16, v159
    v_add_f32 v62, v62, v12
    v_and_b32 v12, s60, v159
    v_add_f32 v63, v63, v12
    v_cvt_pk_bf16_f32 v87, v62, v63
    buffer_store_dwordx4 v[84:87], v14, s[20:23], 0 offen offset:160
    v_add_u32 v2, 8, v2
    s_sub_u32 s57, s57, 1
    s_waitcnt vmcnt(0) lgkmcnt(0)
    s_nop 11
    s_cmp_lg_u32 s57, 0
    s_cbranch_scc1 L_s_tile
    s_endpgm
.section .rodata,"a"
.p2align 6
.amdhsa_kernel standalone__modern_conv_block_replknet__vision_kernel
  .amdhsa_next_free_vgpr 512
  .amdhsa_next_free_sgpr 102
  .amdhsa_accum_offset 256
  .amdhsa_group_segment_fixed_size 0
  .amdhsa_kernarg_size 64
  .amdhsa_user_sgpr_count 2
  .amdhsa_user_sgpr_kernarg_segment_ptr 1
  .amdhsa_system_sgpr_workgroup_id_x 1
  .amdhsa_float_denorm_mode_32 3
.end_amdhsa_kernel
```
